```python
import torch

def _softmax(x, axis=-1):
    return torch.softmax(x, dim=axis)
def _gelu(x):
    return torch.nn.functional.gelu(x, approximate="tanh")
def _silu(x):
    return torch.nn.functional.silu(x)
def _sigmoid(x):
    return torch.sigmoid(x)
def _layernorm(x, axis=-1, eps=1e-5):
    m = x.mean(dim=axis, keepdim=True)
    v = x.var(dim=axis, keepdim=True, unbiased=False)
    return (x - m) / torch.sqrt(v + eps)
def _scatter_add(tgt, idx, src, axis=0):
    return tgt.clone().index_add_(axis, idx, src)
def _segment_sum(src, seg, n):
    out = torch.zeros((n,) + src.shape[1:], dtype=src.dtype)
    return out.index_add_(0, seg, src)
def _pad(x, pw):
    flat = tuple(v for pair in reversed(pw) for v in pair)
    return torch.nn.functional.pad(x, flat)

kernel_name = 'gated_mix__mha_block__sliding_local_dilated__prompt'

def setup_inputs():

    _w = (lambda a: (lambda t: t.to(torch.bfloat16) if t.is_floating_point() else t)(torch.as_tensor(a)))
    def _A_setup():
        B, S, D, H = 1, 2048, 448, 16
        return {
            "x": _w((lambda *s: torch.randn(*s, dtype=torch.bfloat16) * 0.05)(B, S, D)),
            "wqkv": _w((lambda *s: torch.randn(*s, dtype=torch.bfloat16) * 1.6)(D, 3 * D)),
            "wo": _w((lambda *s: torch.randn(*s, dtype=torch.bfloat16) * 0.1)(D, D)),
        }
    _A_in = _A_setup()

    def _B_setup():
        B, S, D = 1, 2048, 448
        return {
            "x": _w((lambda *s: torch.randn(*s, dtype=torch.bfloat16) * 0.05)(B, S, D)),
            "wqkv": _w((lambda *s: torch.randn(*s, dtype=torch.bfloat16) * 1.6)(D, 3 * D)),
            "wo": _w((lambda *s: torch.randn(*s, dtype=torch.bfloat16) * 0.05)(D, D)),
        }
    _B_in = _B_setup()

    return {
        "A_x": _A_in["x"],
        "A_wqkv": _A_in["wqkv"],
        "A_wo": _A_in["wo"],
        "B_x": _B_in["x"],
        "B_wqkv": _B_in["wqkv"],
        "B_wo": _B_in["wo"],
        "gate_w": _w((lambda *s: torch.randn(*s, dtype=torch.bfloat16) * 0.05)(448) * 16.0),
    }

def reference(A_x, A_wqkv, A_wo, B_x, B_wqkv, B_wo, gate_w):
    def _A_ref(x, wqkv, wo):
        B, S, D = x.shape
        H = 16
        Dh = D // H
        qkv = (lambda x, *d: x.permute(*d))((x @ wqkv).reshape(B, S, 3, H, Dh), 2, 0, 3, 1, 4)
        q, k, v = qkv[0], qkv[1], qkv[2]
        scores = torch.einsum("bhqd,bhkd->bhqk", q, k) * (Dh ** -0.5)
        p = _softmax(scores, axis=-1)
        o = torch.einsum("bhqk,bhkd->bhqd", p, v)
        return (lambda x, *d: x.permute(*d))(o, 0, 2, 1, 3).reshape(B, S, D) @ wo

    def _B_ref(x, wqkv, wo):
        B, S, D = x.shape
        H = 16; Dh = D // H
        W, dil = 8, 2
        qkv = (lambda x, *d: x.permute(*d))((x @ wqkv).reshape(B, S, 3, H, Dh), 2, 0, 3, 1, 4)
        q, k, v = qkv[0], qkv[1], qkv[2]
        scale = Dh ** -0.5
        pos = torch.arange(S)
        off = torch.arange(W) * dil
        idx = pos[:, None] - off[None, :]
        mask = idx >= 0
        idx_c = torch.where(mask, idx, 0).reshape(-1)
        kg = k[:, :, idx_c, :].reshape(B, H, S, W, Dh)
        vg = v[:, :, idx_c, :].reshape(B, H, S, W, Dh)
        logits = torch.einsum("bhsd,bhswd->bhsw", q, kg) * scale
        logits = torch.where(mask[None, None, :, :], logits, -1e9)
        attn = _softmax(logits, axis=-1)
        o = torch.einsum("bhsw,bhswd->bhsd", attn, vg)
        return (lambda x, *d: x.permute(*d))(o, 0, 2, 1, 3).reshape(B, S, D) @ wo

    x = A_x
    g = _sigmoid((x * gate_w).sum(-1, keepdims=True))
    a = _A_ref(x, A_wqkv, A_wo)
    b = _B_ref(x, B_wqkv, B_wo)
    return g * a + (1 - g) * b
```

```asm
; @launch kernel=gated_mix__mha_block__sliding_local_dilated__prompt_kernel grid=(256,1,1) block=(832,1,1) lds=163840
.amdgcn_target "amdgcn-amd-amdhsa--gfx950"
.text
.globl gated_mix__mha_block__sliding_local_dilated__prompt_kernel
.p2align 8
.type gated_mix__mha_block__sliding_local_dilated__prompt_kernel,@function
gated_mix__mha_block__sliding_local_dilated__prompt_kernel:
    s_cmp_ge_u32 s2, 256
    s_cbranch_scc1 KF_END
    s_load_dwordx16 s[64:79], s[0:1], 0
    s_load_dwordx4 s[80:83], s[0:1], 64
    s_and_b32 s34, s2, 7
    s_lshr_b32 s35, s2, 3
    s_lshl_b32 s50, s34, 1
    s_and_b32 s42, s35, 1
    s_add_u32 s50, s50, s42
    s_lshr_b32 s51, s35, 1
    s_and_b32 s32, s34, 1
    s_lshl_b32 s32, s32, 3
    s_and_b32 s42, s35, 7
    s_add_u32 s32, s32, s42
    s_lshr_b32 s33, s34, 1
    s_lshl_b32 s33, s33, 2
    s_lshr_b32 s42, s35, 3
    s_add_u32 s33, s33, s42
    s_mov_b32 s53, 0
    v_lshrrev_b32 v1, 6, v0
    v_and_b32 v0, 63, v0
    v_readfirstlane_b32 s36, v1
    v_lshlrev_b32 v2, 4, v0
    s_add_u32 s40, s36, 8
    s_sub_u32 s41, s36, 5
    s_cmp_lt_u32 s36, 5
    s_cselect_b32 s36, s40, s41
    s_waitcnt lgkmcnt(0)
    s_mov_b32 s16, s64
    s_and_b32 s17, s65, 0xffff
    s_mov_b32 s18, 1835008
    s_mov_b32 s19, 0x00020000
    s_mov_b32 s24, s82
    s_and_b32 s25, s83, 0xffff
    s_mov_b32 s26, 17825792
    s_mov_b32 s27, 0x00020000
    s_cmp_ge_u32 s36, 12
    s_cbranch_scc1 KF_SYNC
    s_cmp_ge_u32 s36, 8
    s_cbranch_scc1 KF_LOADER
    s_lshl_b32 s40, s2, 3
    s_add_u32 s40, s40, s36
    s_mov_b32 s28, s66
    s_and_b32 s29, s67, 0xffff
    s_mov_b32 s30, 1204224
    s_mov_b32 s31, 0x00020000
    s_mul_i32 s41, s40, 588
    s_and_b32 s41, s41, 0xfffffff0
    s_mov_b32 exec_lo, 0xffffffff
    s_mov_b32 exec_hi, 0x1f
    buffer_load_dwordx4 v[120:123], v2, s[28:31], s41 offen
    s_mov_b32 s28, s64
    s_and_b32 s29, s65, 0xffff
    s_mov_b32 s30, 1835008
    s_mov_b32 s31, 0x00020000
    s_mul_i32 s41, s40, 896
    s_and_b32 s41, s41, 0xfffffff0
    s_mov_b32 exec_lo, 0xffffffff
    s_mov_b32 exec_hi, 0xffffff
    buffer_load_dwordx4 v[120:123], v2, s[28:31], s41 offen
    s_mov_b32 s28, s72
    s_and_b32 s29, s73, 0xffff
    s_mov_b32 s30, 1204224
    s_mov_b32 s31, 0x00020000
    s_mul_i32 s41, s40, 588
    s_and_b32 s41, s41, 0xfffffff0
    s_mov_b32 exec_lo, 0xffffffff
    s_mov_b32 exec_hi, 0x1f
    buffer_load_dwordx4 v[120:123], v2, s[28:31], s41 offen
    s_mov_b32 s28, s68
    s_and_b32 s29, s69, 0xffff
    s_mov_b32 s30, 401408
    s_mov_b32 s31, 0x00020000
    s_mul_i32 s41, s40, 196
    s_and_b32 s41, s41, 0xfffffff0
    s_mov_b32 exec_lo, 0x1fff
    s_mov_b32 exec_hi, 0x0
    buffer_load_dwordx4 v[120:123], v2, s[28:31], s41 offen
    s_mov_b32 s28, s74
    s_and_b32 s29, s75, 0xffff
    s_mov_b32 s30, 401408
    s_mov_b32 s31, 0x00020000
    s_mul_i32 s41, s40, 196
    s_and_b32 s41, s41, 0xfffffff0
    s_mov_b32 exec_lo, 0x1fff
    s_mov_b32 exec_hi, 0x0
    buffer_load_dwordx4 v[120:123], v2, s[28:31], s41 offen
    s_mov_b64 exec, -1
    s_and_b32 s37, s36, 3
    s_lshr_b32 s38, s36, 2
    v_and_b32 v1, 31, v0
    v_lshrrev_b32 v3, 5, v0
    v_bfe_u32 v4, v0, 1, 3
    v_lshlrev_b32 v5, 7, v1
    s_lshl_b32 s40, s37, 12
    v_add_u32 v5, s40, v5
    v_or_b32 v6, 0, v3
    v_xor_b32 v6, v6, v4
    v_lshl_add_u32 v24, v6, 4, v5
    v_add_u32 v28, 0x10000, v24
    v_or_b32 v6, 2, v3
    v_xor_b32 v6, v6, v4
    v_lshl_add_u32 v25, v6, 4, v5
    v_add_u32 v29, 0x10000, v25
    v_or_b32 v6, 4, v3
    v_xor_b32 v6, v6, v4
    v_lshl_add_u32 v26, v6, 4, v5
    v_add_u32 v30, 0x10000, v26
    v_or_b32 v6, 6, v3
    v_xor_b32 v6, v6, v4
    v_lshl_add_u32 v27, v6, 4, v5
    v_add_u32 v31, 0x10000, v27
    v_bfe_u32 v5, v0, 2, 2
    v_lshl_add_u32 v5, v3, 3, v5
    v_mul_u32_u24 v5, 192, v5
    v_bfe_u32 v6, v0, 4, 1
    v_lshl_add_u32 v5, v6, 5, v5
    v_and_b32 v7, 3, v0
    v_lshl_add_u32 v5, v7, 3, v5
    s_and_b32 s40, s33, 1
    s_lshl_b32 s40, s40, 3
    s_add_u32 s40, s40, 114688
    v_add_u32 v32, s40, v5
    v_cmp_eq_u32 vcc, 28, v1
    v_mov_b32 v33, 0
    v_mov_b32 v5, 0x3f803f80
    v_cndmask_b32 v33, v33, v5, vcc
    v_mov_b32 v34, 163712
    s_lshl_b32 s39, s51, 2
    s_add_u32 s39, s39, s37
    s_mul_i32 s42, s38, 6291456
    s_lshl_b32 s41, s32, 2
    s_add_u32 s41, s41, s37
    s_mul_i32 s43, s33, 3
    s_lshl_b32 s40, s39, 4
    s_add_u32 s40, s40, s50
    s_lshl_b32 s49, s40, 11
    s_mov_b32 s48, 1049335798
    s_lshl_b32 s40, s50, 18
    s_add_u32 s40, s40, 2097152
    s_add_u32 s20, s82, s40
    s_addc_u32 s21, s83, 0
    s_and_b32 s21, s21, 0xffff
    s_mov_b32 s22, 0x40000
    s_mov_b32 s23, 0x00020000
    s_lshl_b32 s40, s38, 13
    v_add_u32 v3, s40, v2
    v_add_u32 v4, 49152, v3
    s_lshl_b32 s40, s37, 11
    s_add_u32 s40, s40, 151552
    v_add_u32 v9, s40, v2
    s_cmp_eq_u32 s38, 0
    s_cbranch_scc0 KF_PASSB
    s_cmp_le_u32 s33, 4
    s_cbranch_scc1 KF_V0_qqq
    s_cmp_le_u32 s33, 5
    s_cbranch_scc1 KF_V0_qkk
    s_cmp_le_u32 s33, 9
    s_cbranch_scc1 KF_V0_kkk
    s_cmp_le_u32 s33, 10
    s_cbranch_scc1 KF_V0_kkv
    s_branch KF_V0_vvv
KF_V0_qqq:
    s_add_u32 s40, s43, 0
    s_and_b32 s40, s40, 15
    s_lshl_b32 s40, s40, 6
    s_add_u32 s40, s40, s41
    s_lshl_b32 s40, s40, 11
    s_add_u32 s44, s40, s42
    s_add_u32 s40, s43, 1
    s_and_b32 s40, s40, 15
    s_lshl_b32 s40, s40, 6
    s_add_u32 s40, s40, s41
    s_lshl_b32 s40, s40, 11
    s_add_u32 s45, s40, s42
    s_add_u32 s40, s43, 2
    s_and_b32 s40, s40, 15
    s_lshl_b32 s40, s40, 6
    s_add_u32 s40, s40, s41
    s_lshl_b32 s40, s40, 11
    s_add_u32 s46, s40, s42
    s_barrier
    ds_read_b128 v[36:39], v24 offset:0
    ds_read_b64_tr_b16 v[40:41], v32 offset:0
    ds_read_b64_tr_b16 v[42:43], v32 offset:768
    ds_read_b64_tr_b16 v[44:45], v32 offset:56
    ds_read_b64_tr_b16 v[46:47], v32 offset:824
    ds_read_b64_tr_b16 v[48:49], v32 offset:112
    ds_read_b64_tr_b16 v[50:51], v32 offset:880
    s_waitcnt lgkmcnt(0)
    v_mfma_f32_32x32x16_bf16 v[68:83], v[40:43], v[36:39], 0
    ds_read_b128 v[52:55], v25 offset:0
    ds_read_b64_tr_b16 v[56:57], v32 offset:3072
    ds_read_b64_tr_b16 v[58:59], v32 offset:3840
    ds_read_b64_tr_b16 v[60:61], v32 offset:3128
    v_mfma_f32_32x32x16_bf16 v[84:99], v[44:47], v[36:39], 0
    ds_read_b64_tr_b16 v[62:63], v32 offset:3896
    ds_read_b64_tr_b16 v[64:65], v32 offset:3184
    ds_read_b64_tr_b16 v[66:67], v32 offset:3952
    v_mfma_f32_32x32x16_bf16 v[100:115], v[48:51], v[36:39], 0
    s_waitcnt lgkmcnt(0)
    v_mfma_f32_32x32x16_bf16 v[68:83], v[56:59], v[52:55], v[68:83]
    ds_read_b128 v[36:39], v26 offset:0
    ds_read_b64_tr_b16 v[40:41], v32 offset:6144
    ds_read_b64_tr_b16 v[42:43], v32 offset:6912
    ds_read_b64_tr_b16 v[44:45], v32 offset:6200
    v_mfma_f32_32x32x16_bf16 v[84:99], v[60:63], v[52:55], v[84:99]
    ds_read_b64_tr_b16 v[46:47], v32 offset:6968
    ds_read_b64_tr_b16 v[48:49], v32 offset:6256
    ds_read_b64_tr_b16 v[50:51], v32 offset:7024
    v_mfma_f32_32x32x16_bf16 v[100:115], v[64:67], v[52:55], v[100:115]
    s_waitcnt lgkmcnt(0)
    v_mfma_f32_32x32x16_bf16 v[68:83], v[40:43], v[36:39], v[68:83]
    ds_read_b128 v[52:55], v27 offset:0
    ds_read_b64_tr_b16 v[56:57], v32 offset:9216
    ds_read_b64_tr_b16 v[58:59], v32 offset:9984
    ds_read_b64_tr_b16 v[60:61], v32 offset:9272
    v_mfma_f32_32x32x16_bf16 v[84:99], v[44:47], v[36:39], v[84:99]
    ds_read_b64_tr_b16 v[62:63], v32 offset:10040
    ds_read_b64_tr_b16 v[64:65], v32 offset:9328
    ds_read_b64_tr_b16 v[66:67], v32 offset:10096
    v_mfma_f32_32x32x16_bf16 v[100:115], v[48:51], v[36:39], v[100:115]
    s_waitcnt lgkmcnt(0)
    v_mfma_f32_32x32x16_bf16 v[68:83], v[56:59], v[52:55], v[68:83]
    s_barrier
    ds_read_b128 v[36:39], v24 offset:16384
    ds_read_b64_tr_b16 v[40:41], v32 offset:12288
    ds_read_b64_tr_b16 v[42:43], v32 offset:13056
    ds_read_b64_tr_b16 v[44:45], v32 offset:12344
    v_mfma_f32_32x32x16_bf16 v[84:99], v[60:63], v[52:55], v[84:99]
    ds_read_b64_tr_b16 v[46:47], v32 offset:13112
    ds_read_b64_tr_b16 v[48:49], v32 offset:12400
    ds_read_b64_tr_b16 v[50:51], v32 offset:13168
    v_mfma_f32_32x32x16_bf16 v[100:115], v[64:67], v[52:55], v[100:115]
    s_waitcnt lgkmcnt(0)
    v_mfma_f32_32x32x16_bf16 v[68:83], v[40:43], v[36:39], v[68:83]
    ds_read_b128 v[52:55], v25 offset:16384
    ds_read_b64_tr_b16 v[56:57], v32 offset:15360
    ds_read_b64_tr_b16 v[58:59], v32 offset:16128
    ds_read_b64_tr_b16 v[60:61], v32 offset:15416
    v_mfma_f32_32x32x16_bf16 v[84:99], v[44:47], v[36:39], v[84:99]
    ds_read_b64_tr_b16 v[62:63], v32 offset:16184
    ds_read_b64_tr_b16 v[64:65], v32 offset:15472
    ds_read_b64_tr_b16 v[66:67], v32 offset:16240
    v_mfma_f32_32x32x16_bf16 v[100:115], v[48:51], v[36:39], v[100:115]
    s_waitcnt lgkmcnt(0)
    v_mfma_f32_32x32x16_bf16 v[68:83], v[56:59], v[52:55], v[68:83]
    ds_read_b128 v[36:39], v26 offset:16384
    ds_read_b64_tr_b16 v[40:41], v32 offset:18432
    ds_read_b64_tr_b16 v[42:43], v32 offset:19200
    ds_read_b64_tr_b16 v[44:45], v32 offset:18488
    v_mfma_f32_32x32x16_bf16 v[84:99], v[60:63], v[52:55], v[84:99]
    ds_read_b64_tr_b16 v[46:47], v32 offset:19256
    ds_read_b64_tr_b16 v[48:49], v32 offset:18544
    ds_read_b64_tr_b16 v[50:51], v32 offset:19312
    v_mfma_f32_32x32x16_bf16 v[100:115], v[64:67], v[52:55], v[100:115]
    s_waitcnt lgkmcnt(0)
    v_mfma_f32_32x32x16_bf16 v[68:83], v[40:43], v[36:39], v[68:83]
    ds_read_b128 v[52:55], v27 offset:16384
    ds_read_b64_tr_b16 v[56:57], v32 offset:21504
    ds_read_b64_tr_b16 v[58:59], v32 offset:22272
    ds_read_b64_tr_b16 v[60:61], v32 offset:21560
    v_mfma_f32_32x32x16_bf16 v[84:99], v[44:47], v[36:39], v[84:99]
    ds_read_b64_tr_b16 v[62:63], v32 offset:22328
    ds_read_b64_tr_b16 v[64:65], v32 offset:21616
    ds_read_b64_tr_b16 v[66:67], v32 offset:22384
    v_mfma_f32_32x32x16_bf16 v[100:115], v[48:51], v[36:39], v[100:115]
    s_waitcnt lgkmcnt(0)
    v_mfma_f32_32x32x16_bf16 v[68:83], v[56:59], v[52:55], v[68:83]
    s_barrier
    ds_read_b128 v[36:39], v24 offset:32768
    ds_read_b64_tr_b16 v[40:41], v32 offset:24576
    ds_read_b64_tr_b16 v[42:43], v32 offset:25344
    ds_read_b64_tr_b16 v[44:45], v32 offset:24632
    v_mfma_f32_32x32x16_bf16 v[84:99], v[60:63], v[52:55], v[84:99]
    ds_read_b64_tr_b16 v[46:47], v32 offset:25400
    ds_read_b64_tr_b16 v[48:49], v32 offset:24688
    ds_read_b64_tr_b16 v[50:51], v32 offset:25456
    v_mfma_f32_32x32x16_bf16 v[100:115], v[64:67], v[52:55], v[100:115]
    s_waitcnt lgkmcnt(0)
    v_mfma_f32_32x32x16_bf16 v[68:83], v[40:43], v[36:39], v[68:83]
    ds_read_b128 v[52:55], v25 offset:32768
    ds_read_b64_tr_b16 v[56:57], v32 offset:27648
    ds_read_b64_tr_b16 v[58:59], v32 offset:28416
    ds_read_b64_tr_b16 v[60:61], v32 offset:27704
    v_mfma_f32_32x32x16_bf16 v[84:99], v[44:47], v[36:39], v[84:99]
    ds_read_b64_tr_b16 v[62:63], v32 offset:28472
    ds_read_b64_tr_b16 v[64:65], v32 offset:27760
    ds_read_b64_tr_b16 v[66:67], v32 offset:28528
    v_mfma_f32_32x32x16_bf16 v[100:115], v[48:51], v[36:39], v[100:115]
    s_waitcnt lgkmcnt(0)
    v_mfma_f32_32x32x16_bf16 v[68:83], v[56:59], v[52:55], v[68:83]
    ds_read_b128 v[36:39], v26 offset:32768
    ds_read_b64_tr_b16 v[40:41], v32 offset:30720
    ds_read_b64_tr_b16 v[42:43], v32 offset:31488
    ds_read_b64_tr_b16 v[44:45], v32 offset:30776
    v_mfma_f32_32x32x16_bf16 v[84:99], v[60:63], v[52:55], v[84:99]
    ds_read_b64_tr_b16 v[46:47], v32 offset:31544
    ds_read_b64_tr_b16 v[48:49], v32 offset:30832
    ds_read_b64_tr_b16 v[50:51], v32 offset:31600
    v_mfma_f32_32x32x16_bf16 v[100:115], v[64:67], v[52:55], v[100:115]
    s_waitcnt lgkmcnt(0)
    v_mfma_f32_32x32x16_bf16 v[68:83], v[40:43], v[36:39], v[68:83]
    ds_read_b128 v[52:55], v27 offset:32768
    ds_read_b64_tr_b16 v[56:57], v32 offset:33792
    ds_read_b64_tr_b16 v[58:59], v32 offset:34560
    ds_read_b64_tr_b16 v[60:61], v32 offset:33848
    v_mfma_f32_32x32x16_bf16 v[84:99], v[44:47], v[36:39], v[84:99]
    ds_read_b64_tr_b16 v[62:63], v32 offset:34616
    ds_read_b64_tr_b16 v[64:65], v32 offset:33904
    ds_read_b64_tr_b16 v[66:67], v32 offset:34672
    v_mfma_f32_32x32x16_bf16 v[100:115], v[48:51], v[36:39], v[100:115]
    s_waitcnt lgkmcnt(0)
    v_mfma_f32_32x32x16_bf16 v[68:83], v[56:59], v[52:55], v[68:83]
    s_barrier
    ds_read_b128 v[36:39], v24 offset:49152
    ds_read_b64_tr_b16 v[40:41], v32 offset:0
    ds_read_b64_tr_b16 v[42:43], v32 offset:768
    ds_read_b64_tr_b16 v[44:45], v32 offset:56
    v_mfma_f32_32x32x16_bf16 v[84:99], v[60:63], v[52:55], v[84:99]
    ds_read_b64_tr_b16 v[46:47], v32 offset:824
    ds_read_b64_tr_b16 v[48:49], v32 offset:112
    ds_read_b64_tr_b16 v[50:51], v32 offset:880
    v_mfma_f32_32x32x16_bf16 v[100:115], v[64:67], v[52:55], v[100:115]
    s_waitcnt lgkmcnt(0)
    v_mfma_f32_32x32x16_bf16 v[68:83], v[40:43], v[36:39], v[68:83]
    ds_read_b128 v[52:55], v25 offset:49152
    ds_read_b64_tr_b16 v[56:57], v32 offset:3072
    ds_read_b64_tr_b16 v[58:59], v32 offset:3840
    ds_read_b64_tr_b16 v[60:61], v32 offset:3128
    v_mfma_f32_32x32x16_bf16 v[84:99], v[44:47], v[36:39], v[84:99]
    ds_read_b64_tr_b16 v[62:63], v32 offset:3896
    ds_read_b64_tr_b16 v[64:65], v32 offset:3184
    ds_read_b64_tr_b16 v[66:67], v32 offset:3952
    v_mfma_f32_32x32x16_bf16 v[100:115], v[48:51], v[36:39], v[100:115]
    s_waitcnt lgkmcnt(0)
    v_mfma_f32_32x32x16_bf16 v[68:83], v[56:59], v[52:55], v[68:83]
    ds_read_b128 v[36:39], v26 offset:49152
    ds_read_b64_tr_b16 v[40:41], v32 offset:6144
    ds_read_b64_tr_b16 v[42:43], v32 offset:6912
    ds_read_b64_tr_b16 v[44:45], v32 offset:6200
    v_mfma_f32_32x32x16_bf16 v[84:99], v[60:63], v[52:55], v[84:99]
    ds_read_b64_tr_b16 v[46:47], v32 offset:6968
    ds_read_b64_tr_b16 v[48:49], v32 offset:6256
    ds_read_b64_tr_b16 v[50:51], v32 offset:7024
    v_mfma_f32_32x32x16_bf16 v[100:115], v[64:67], v[52:55], v[100:115]
    s_waitcnt lgkmcnt(0)
    v_mfma_f32_32x32x16_bf16 v[68:83], v[40:43], v[36:39], v[68:83]
    ds_read_b128 v[52:55], v27 offset:49152
    ds_read_b64_tr_b16 v[56:57], v32 offset:9216
    ds_read_b64_tr_b16 v[58:59], v32 offset:9984
    ds_read_b64_tr_b16 v[60:61], v32 offset:9272
    v_mfma_f32_32x32x16_bf16 v[84:99], v[44:47], v[36:39], v[84:99]
    ds_read_b64_tr_b16 v[62:63], v32 offset:10040
    ds_read_b64_tr_b16 v[64:65], v32 offset:9328
    ds_read_b64_tr_b16 v[66:67], v32 offset:10096
    v_mfma_f32_32x32x16_bf16 v[100:115], v[48:51], v[36:39], v[100:115]
    s_waitcnt lgkmcnt(0)
    v_mfma_f32_32x32x16_bf16 v[68:83], v[56:59], v[52:55], v[68:83]
    s_barrier
    ds_read_b128 v[36:39], v28 offset:0
    ds_read_b64_tr_b16 v[40:41], v32 offset:12288
    ds_read_b64_tr_b16 v[42:43], v32 offset:13056
    ds_read_b64_tr_b16 v[44:45], v32 offset:12344
    v_mfma_f32_32x32x16_bf16 v[84:99], v[60:63], v[52:55], v[84:99]
    ds_read_b64_tr_b16 v[46:47], v32 offset:13112
    ds_read_b64_tr_b16 v[48:49], v32 offset:12400
    ds_read_b64_tr_b16 v[50:51], v32 offset:13168
    v_mfma_f32_32x32x16_bf16 v[100:115], v[64:67], v[52:55], v[100:115]
    s_waitcnt lgkmcnt(0)
    v_mfma_f32_32x32x16_bf16 v[68:83], v[40:43], v[36:39], v[68:83]
    ds_read_b128 v[52:55], v29 offset:0
    ds_read_b64_tr_b16 v[56:57], v32 offset:15360
    ds_read_b64_tr_b16 v[58:59], v32 offset:16128
    ds_read_b64_tr_b16 v[60:61], v32 offset:15416
    v_mfma_f32_32x32x16_bf16 v[84:99], v[44:47], v[36:39], v[84:99]
    ds_read_b64_tr_b16 v[62:63], v32 offset:16184
    ds_read_b64_tr_b16 v[64:65], v32 offset:15472
    ds_read_b64_tr_b16 v[66:67], v32 offset:16240
    v_mfma_f32_32x32x16_bf16 v[100:115], v[48:51], v[36:39], v[100:115]
    s_waitcnt lgkmcnt(0)
    v_mfma_f32_32x32x16_bf16 v[68:83], v[56:59], v[52:55], v[68:83]
    ds_read_b128 v[36:39], v30 offset:0
    ds_read_b64_tr_b16 v[40:41], v32 offset:18432
    ds_read_b64_tr_b16 v[42:43], v32 offset:19200
    ds_read_b64_tr_b16 v[44:45], v32 offset:18488
    v_mfma_f32_32x32x16_bf16 v[84:99], v[60:63], v[52:55], v[84:99]
    ds_read_b64_tr_b16 v[46:47], v32 offset:19256
    ds_read_b64_tr_b16 v[48:49], v32 offset:18544
    ds_read_b64_tr_b16 v[50:51], v32 offset:19312
    v_mfma_f32_32x32x16_bf16 v[100:115], v[64:67], v[52:55], v[100:115]
    s_waitcnt lgkmcnt(0)
    v_mfma_f32_32x32x16_bf16 v[68:83], v[40:43], v[36:39], v[68:83]
    ds_read_b128 v[52:55], v31 offset:0
    ds_read_b64_tr_b16 v[56:57], v32 offset:21504
    ds_read_b64_tr_b16 v[58:59], v32 offset:22272
    ds_read_b64_tr_b16 v[60:61], v32 offset:21560
    v_mfma_f32_32x32x16_bf16 v[84:99], v[44:47], v[36:39], v[84:99]
    ds_read_b64_tr_b16 v[62:63], v32 offset:22328
    ds_read_b64_tr_b16 v[64:65], v32 offset:21616
    ds_read_b64_tr_b16 v[66:67], v32 offset:22384
    v_mfma_f32_32x32x16_bf16 v[100:115], v[48:51], v[36:39], v[100:115]
    s_waitcnt lgkmcnt(0)
    v_mfma_f32_32x32x16_bf16 v[68:83], v[56:59], v[52:55], v[68:83]
    s_barrier
    ds_read_b128 v[36:39], v28 offset:16384
    ds_read_b64_tr_b16 v[40:41], v32 offset:24576
    ds_read_b64_tr_b16 v[42:43], v32 offset:25344
    ds_read_b64_tr_b16 v[44:45], v32 offset:24632
    v_mfma_f32_32x32x16_bf16 v[84:99], v[60:63], v[52:55], v[84:99]
    ds_read_b64_tr_b16 v[46:47], v32 offset:25400
    ds_read_b64_tr_b16 v[48:49], v32 offset:24688
    ds_read_b64_tr_b16 v[50:51], v32 offset:25456
    v_mfma_f32_32x32x16_bf16 v[100:115], v[64:67], v[52:55], v[100:115]
    s_waitcnt lgkmcnt(0)
    v_mfma_f32_32x32x16_bf16 v[68:83], v[40:43], v[36:39], v[68:83]
    ds_read_b128 v[52:55], v29 offset:16384
    ds_read_b64_tr_b16 v[56:57], v32 offset:27648
    ds_read_b64_tr_b16 v[58:59], v32 offset:28416
    ds_read_b64_tr_b16 v[60:61], v32 offset:27704
    v_mfma_f32_32x32x16_bf16 v[84:99], v[44:47], v[36:39], v[84:99]
    ds_read_b64_tr_b16 v[62:63], v32 offset:28472
    ds_read_b64_tr_b16 v[64:65], v32 offset:27760
    ds_read_b64_tr_b16 v[66:67], v32 offset:28528
    v_mfma_f32_32x32x16_bf16 v[100:115], v[48:51], v[36:39], v[100:115]
    s_waitcnt lgkmcnt(0)
    v_mfma_f32_32x32x16_bf16 v[68:83], v[56:59], v[52:55], v[68:83]
    ds_read_b128 v[36:39], v30 offset:16384
    ds_read_b64_tr_b16 v[40:41], v32 offset:30720
    ds_read_b64_tr_b16 v[42:43], v32 offset:31488
    ds_read_b64_tr_b16 v[44:45], v32 offset:30776
    v_mfma_f32_32x32x16_bf16 v[84:99], v[60:63], v[52:55], v[84:99]
    ds_read_b64_tr_b16 v[46:47], v32 offset:31544
    ds_read_b64_tr_b16 v[48:49], v32 offset:30832
    ds_read_b64_tr_b16 v[50:51], v32 offset:31600
    v_mfma_f32_32x32x16_bf16 v[100:115], v[64:67], v[52:55], v[100:115]
    s_waitcnt lgkmcnt(0)
    v_mfma_f32_32x32x16_bf16 v[68:83], v[40:43], v[36:39], v[68:83]
    ds_read_b128 v[52:55], v31 offset:16384
    ds_read_b64_tr_b16 v[56:57], v32 offset:33792
    ds_read_b64_tr_b16 v[58:59], v32 offset:34560
    ds_read_b64_tr_b16 v[60:61], v32 offset:33848
    v_mfma_f32_32x32x16_bf16 v[84:99], v[44:47], v[36:39], v[84:99]
    ds_read_b64_tr_b16 v[62:63], v32 offset:34616
    ds_read_b64_tr_b16 v[64:65], v32 offset:33904
    ds_read_b64_tr_b16 v[66:67], v32 offset:34672
    v_mfma_f32_32x32x16_bf16 v[100:115], v[48:51], v[36:39], v[100:115]
    s_waitcnt lgkmcnt(0)
    v_mfma_f32_32x32x16_bf16 v[68:83], v[56:59], v[52:55], v[68:83]
    s_barrier
    ds_read_b128 v[36:39], v28 offset:32768
    ds_read_b64_tr_b16 v[40:41], v32 offset:0
    ds_read_b64_tr_b16 v[42:43], v32 offset:768
    ds_read_b64_tr_b16 v[44:45], v32 offset:56
    v_mfma_f32_32x32x16_bf16 v[84:99], v[60:63], v[52:55], v[84:99]
    ds_read_b64_tr_b16 v[46:47], v32 offset:824
    ds_read_b64_tr_b16 v[48:49], v32 offset:112
    ds_read_b64_tr_b16 v[50:51], v32 offset:880
    v_mfma_f32_32x32x16_bf16 v[100:115], v[64:67], v[52:55], v[100:115]
    s_waitcnt lgkmcnt(0)
    v_mfma_f32_32x32x16_bf16 v[68:83], v[40:43], v[36:39], v[68:83]
    ds_read_b128 v[52:55], v29 offset:32768
    ds_read_b64_tr_b16 v[56:57], v32 offset:3072
    ds_read_b64_tr_b16 v[58:59], v32 offset:3840
    ds_read_b64_tr_b16 v[60:61], v32 offset:3128
    v_mfma_f32_32x32x16_bf16 v[84:99], v[44:47], v[36:39], v[84:99]
    ds_read_b64_tr_b16 v[62:63], v32 offset:3896
    ds_read_b64_tr_b16 v[64:65], v32 offset:3184
    ds_read_b64_tr_b16 v[66:67], v32 offset:3952
    v_mfma_f32_32x32x16_bf16 v[100:115], v[48:51], v[36:39], v[100:115]
    s_waitcnt lgkmcnt(0)
    v_mfma_f32_32x32x16_bf16 v[68:83], v[56:59], v[52:55], v[68:83]
    ds_read_b128 v[36:39], v30 offset:32768
    ds_read_b64_tr_b16 v[40:41], v32 offset:6144
    ds_read_b64_tr_b16 v[42:43], v32 offset:6912
    ds_read_b64_tr_b16 v[44:45], v32 offset:6200
    v_mfma_f32_32x32x16_bf16 v[84:99], v[60:63], v[52:55], v[84:99]
    ds_read_b64_tr_b16 v[46:47], v32 offset:6968
    ds_read_b64_tr_b16 v[48:49], v32 offset:6256
    ds_read_b64_tr_b16 v[50:51], v32 offset:7024
    v_mfma_f32_32x32x16_bf16 v[100:115], v[64:67], v[52:55], v[100:115]
    s_waitcnt lgkmcnt(0)
    v_mfma_f32_32x32x16_bf16 v[68:83], v[40:43], v[36:39], v[68:83]
    ds_read_b128 v[52:55], v31 offset:32768
    ds_read_b64_tr_b16 v[56:57], v32 offset:9216
    ds_read_b64_tr_b16 v[58:59], v32 offset:9984
    ds_read_b64_tr_b16 v[60:61], v32 offset:9272
    v_mfma_f32_32x32x16_bf16 v[84:99], v[44:47], v[36:39], v[84:99]
    ds_read_b64_tr_b16 v[62:63], v32 offset:10040
    ds_read_b64_tr_b16 v[64:65], v32 offset:9328
    ds_read_b64_tr_b16 v[66:67], v32 offset:10096
    v_mfma_f32_32x32x16_bf16 v[100:115], v[48:51], v[36:39], v[100:115]
    s_waitcnt lgkmcnt(0)
    v_mfma_f32_32x32x16_bf16 v[68:83], v[56:59], v[52:55], v[68:83]
    v_mfma_f32_32x32x16_bf16 v[84:99], v[60:63], v[52:55], v[84:99]
    v_mfma_f32_32x32x16_bf16 v[100:115], v[64:67], v[52:55], v[100:115]
    s_barrier
    s_nop 10
    v_mul_f32 v100, s48, v100
    v_mul_f32 v101, s48, v101
    v_mul_f32 v102, s48, v102
    v_mul_f32 v103, s48, v103
    v_mul_f32 v104, s48, v104
    v_mul_f32 v105, s48, v105
    v_mul_f32 v106, s48, v106
    v_mul_f32 v107, s48, v107
    v_mul_f32 v108, s48, v108
    v_mul_f32 v109, s48, v109
    v_mul_f32 v110, s48, v110
    v_mul_f32 v111, s48, v111
    v_mul_f32 v112, s48, v112
    v_mul_f32 v113, s48, v113
    v_mul_f32 v114, s48, v114
    v_mul_f32 v115, s48, v115
    v_cvt_pk_bf16_f32 v100, v100, v101
    v_cvt_pk_bf16_f32 v101, v102, v103
    v_cvt_pk_bf16_f32 v102, v104, v105
    v_cvt_pk_bf16_f32 v103, v106, v107
    v_cvt_pk_bf16_f32 v104, v108, v109
    v_cvt_pk_bf16_f32 v105, v110, v111
    v_cvt_pk_bf16_f32 v106, v112, v113
    v_cvt_pk_bf16_f32 v107, v114, v115
    s_mov_b32 exec_lo, 0
    v_mov_b32 v106, 0
    v_mov_b32 v107, 0
    s_mov_b64 exec, -1
    buffer_store_dwordx4 v[100:103], v2, s[24:27], s46 offen sc1
    buffer_store_dwordx4 v[104:107], v2, s[24:27], s46 offen offset:1024 sc1
    v_mul_f32 v84, s48, v84
    v_mul_f32 v85, s48, v85
    v_mul_f32 v86, s48, v86
    v_mul_f32 v87, s48, v87
    v_mul_f32 v88, s48, v88
    v_mul_f32 v89, s48, v89
    v_mul_f32 v90, s48, v90
    v_mul_f32 v91, s48, v91
    v_mul_f32 v92, s48, v92
    v_mul_f32 v93, s48, v93
    v_mul_f32 v94, s48, v94
    v_mul_f32 v95, s48, v95
    v_mul_f32 v96, s48, v96
    v_mul_f32 v97, s48, v97
    v_mul_f32 v98, s48, v98
    v_mul_f32 v99, s48, v99
    v_cvt_pk_bf16_f32 v84, v84, v85
    v_cvt_pk_bf16_f32 v85, v86, v87
    v_cvt_pk_bf16_f32 v86, v88, v89
    v_cvt_pk_bf16_f32 v87, v90, v91
    v_cvt_pk_bf16_f32 v88, v92, v93
    v_cvt_pk_bf16_f32 v89, v94, v95
    v_cvt_pk_bf16_f32 v90, v96, v97
    v_cvt_pk_bf16_f32 v91, v98, v99
    s_mov_b32 exec_lo, 0
    v_mov_b32 v90, 0
    v_mov_b32 v91, 0
    s_mov_b64 exec, -1
    buffer_store_dwordx4 v[84:87], v2, s[24:27], s45 offen sc1
    buffer_store_dwordx4 v[88:91], v2, s[24:27], s45 offen offset:1024 sc1
    v_mul_f32 v68, s48, v68
    v_mul_f32 v69, s48, v69
    v_mul_f32 v70, s48, v70
    v_mul_f32 v71, s48, v71
    v_mul_f32 v72, s48, v72
    v_mul_f32 v73, s48, v73
    v_mul_f32 v74, s48, v74
    v_mul_f32 v75, s48, v75
    v_mul_f32 v76, s48, v76
    v_mul_f32 v77, s48, v77
    v_mul_f32 v78, s48, v78
    v_mul_f32 v79, s48, v79
    v_mul_f32 v80, s48, v80
    v_mul_f32 v81, s48, v81
    v_mul_f32 v82, s48, v82
    v_mul_f32 v83, s48, v83
    v_cvt_pk_bf16_f32 v68, v68, v69
    v_cvt_pk_bf16_f32 v69, v70, v71
    v_cvt_pk_bf16_f32 v70, v72, v73
    v_cvt_pk_bf16_f32 v71, v74, v75
    v_cvt_pk_bf16_f32 v72, v76, v77
    v_cvt_pk_bf16_f32 v73, v78, v79
    v_cvt_pk_bf16_f32 v74, v80, v81
    v_cvt_pk_bf16_f32 v75, v82, v83
    s_mov_b32 exec_lo, 0
    v_mov_b32 v74, 0
    v_mov_b32 v75, 0
    s_mov_b64 exec, -1
    buffer_store_dwordx4 v[68:71], v2, s[24:27], s44 offen sc1
    buffer_store_dwordx4 v[72:75], v2, s[24:27], s44 offen offset:1024 sc1
    s_branch KF_EPI0
KF_V0_qkk:
    s_add_u32 s40, s43, 0
    s_and_b32 s40, s40, 15
    s_lshl_b32 s40, s40, 6
    s_add_u32 s40, s40, s41
    s_lshl_b32 s40, s40, 11
    s_add_u32 s44, s40, s42
    s_add_u32 s40, s43, 1
    s_and_b32 s40, s40, 15
    s_lshl_b32 s40, s40, 6
    s_add_u32 s40, s40, s41
    s_lshl_b32 s40, s40, 12
    s_add_u32 s40, s40, s42
    s_add_u32 s45, s40, 2097152
    s_add_u32 s40, s43, 2
    s_and_b32 s40, s40, 15
    s_lshl_b32 s40, s40, 6
    s_add_u32 s40, s40, s41
    s_lshl_b32 s40, s40, 12
    s_add_u32 s40, s40, s42
    s_add_u32 s46, s40, 2097152
    s_barrier
    ds_read_b128 v[36:39], v24 offset:0
    ds_read_b64_tr_b16 v[40:41], v32 offset:0
    ds_read_b64_tr_b16 v[42:43], v32 offset:768
    ds_read_b64_tr_b16 v[44:45], v32 offset:56
    ds_read_b64_tr_b16 v[46:47], v32 offset:824
    ds_read_b64_tr_b16 v[48:49], v32 offset:112
    ds_read_b64_tr_b16 v[50:51], v32 offset:880
    s_waitcnt lgkmcnt(0)
    v_mfma_f32_32x32x16_bf16 v[68:83], v[40:43], v[36:39], 0
    ds_read_b128 v[52:55], v25 offset:0
    ds_read_b64_tr_b16 v[56:57], v32 offset:3072
    ds_read_b64_tr_b16 v[58:59], v32 offset:3840
    ds_read_b64_tr_b16 v[60:61], v32 offset:3128
    v_mfma_f32_32x32x16_bf16 v[84:99], v[44:47], v[36:39], 0
    ds_read_b64_tr_b16 v[62:63], v32 offset:3896
    ds_read_b64_tr_b16 v[64:65], v32 offset:3184
    ds_read_b64_tr_b16 v[66:67], v32 offset:3952
    v_mfma_f32_32x32x16_bf16 v[100:115], v[48:51], v[36:39], 0
    s_waitcnt lgkmcnt(0)
    v_mfma_f32_32x32x16_bf16 v[68:83], v[56:59], v[52:55], v[68:83]
    ds_read_b128 v[36:39], v26 offset:0
    ds_read_b64_tr_b16 v[40:41], v32 offset:6144
    ds_read_b64_tr_b16 v[42:43], v32 offset:6912
    ds_read_b64_tr_b16 v[44:45], v32 offset:6200
    v_mfma_f32_32x32x16_bf16 v[84:99], v[60:63], v[52:55], v[84:99]
    ds_read_b64_tr_b16 v[46:47], v32 offset:6968
    ds_read_b64_tr_b16 v[48:49], v32 offset:6256
    ds_read_b64_tr_b16 v[50:51], v32 offset:7024
    v_mfma_f32_32x32x16_bf16 v[100:115], v[64:67], v[52:55], v[100:115]
    s_waitcnt lgkmcnt(0)
    v_mfma_f32_32x32x16_bf16 v[68:83], v[40:43], v[36:39], v[68:83]
    ds_read_b128 v[52:55], v27 offset:0
    ds_read_b64_tr_b16 v[56:57], v32 offset:9216
    ds_read_b64_tr_b16 v[58:59], v32 offset:9984
    ds_read_b64_tr_b16 v[60:61], v32 offset:9272
    v_mfma_f32_32x32x16_bf16 v[84:99], v[44:47], v[36:39], v[84:99]
    ds_read_b64_tr_b16 v[62:63], v32 offset:10040
    ds_read_b64_tr_b16 v[64:65], v32 offset:9328
    ds_read_b64_tr_b16 v[66:67], v32 offset:10096
    v_mfma_f32_32x32x16_bf16 v[100:115], v[48:51], v[36:39], v[100:115]
    s_waitcnt lgkmcnt(0)
    v_mfma_f32_32x32x16_bf16 v[68:83], v[56:59], v[52:55], v[68:83]
    s_barrier
    ds_read_b128 v[36:39], v24 offset:16384
    ds_read_b64_tr_b16 v[40:41], v32 offset:12288
    ds_read_b64_tr_b16 v[42:43], v32 offset:13056
    ds_read_b64_tr_b16 v[44:45], v32 offset:12344
    v_mfma_f32_32x32x16_bf16 v[84:99], v[60:63], v[52:55], v[84:99]
    ds_read_b64_tr_b16 v[46:47], v32 offset:13112
    ds_read_b64_tr_b16 v[48:49], v32 offset:12400
    ds_read_b64_tr_b16 v[50:51], v32 offset:13168
    v_mfma_f32_32x32x16_bf16 v[100:115], v[64:67], v[52:55], v[100:115]
    s_waitcnt lgkmcnt(0)
    v_mfma_f32_32x32x16_bf16 v[68:83], v[40:43], v[36:39], v[68:83]
    ds_read_b128 v[52:55], v25 offset:16384
    ds_read_b64_tr_b16 v[56:57], v32 offset:15360
    ds_read_b64_tr_b16 v[58:59], v32 offset:16128
    ds_read_b64_tr_b16 v[60:61], v32 offset:15416
    v_mfma_f32_32x32x16_bf16 v[84:99], v[44:47], v[36:39], v[84:99]
    ds_read_b64_tr_b16 v[62:63], v32 offset:16184
    ds_read_b64_tr_b16 v[64:65], v32 offset:15472
    ds_read_b64_tr_b16 v[66:67], v32 offset:16240
    v_mfma_f32_32x32x16_bf16 v[100:115], v[48:51], v[36:39], v[100:115]
    s_waitcnt lgkmcnt(0)
    v_mfma_f32_32x32x16_bf16 v[68:83], v[56:59], v[52:55], v[68:83]
    ds_read_b128 v[36:39], v26 offset:16384
    ds_read_b64_tr_b16 v[40:41], v32 offset:18432
    ds_read_b64_tr_b16 v[42:43], v32 offset:19200
    ds_read_b64_tr_b16 v[44:45], v32 offset:18488
    v_mfma_f32_32x32x16_bf16 v[84:99], v[60:63], v[52:55], v[84:99]
    ds_read_b64_tr_b16 v[46:47], v32 offset:19256
    ds_read_b64_tr_b16 v[48:49], v32 offset:18544
    ds_read_b64_tr_b16 v[50:51], v32 offset:19312
    v_mfma_f32_32x32x16_bf16 v[100:115], v[64:67], v[52:55], v[100:115]
    s_waitcnt lgkmcnt(0)
    v_mfma_f32_32x32x16_bf16 v[68:83], v[40:43], v[36:39], v[68:83]
    ds_read_b128 v[52:55], v27 offset:16384
    ds_read_b64_tr_b16 v[56:57], v32 offset:21504
    ds_read_b64_tr_b16 v[58:59], v32 offset:22272
    ds_read_b64_tr_b16 v[60:61], v32 offset:21560
    v_mfma_f32_32x32x16_bf16 v[84:99], v[44:47], v[36:39], v[84:99]
    ds_read_b64_tr_b16 v[62:63], v32 offset:22328
    ds_read_b64_tr_b16 v[64:65], v32 offset:21616
    ds_read_b64_tr_b16 v[66:67], v32 offset:22384
    v_mfma_f32_32x32x16_bf16 v[100:115], v[48:51], v[36:39], v[100:115]
    s_waitcnt lgkmcnt(0)
    v_mfma_f32_32x32x16_bf16 v[68:83], v[56:59], v[52:55], v[68:83]
    s_barrier
    ds_read_b128 v[36:39], v24 offset:32768
    ds_read_b64_tr_b16 v[40:41], v32 offset:24576
    ds_read_b64_tr_b16 v[42:43], v32 offset:25344
    ds_read_b64_tr_b16 v[44:45], v32 offset:24632
    v_mfma_f32_32x32x16_bf16 v[84:99], v[60:63], v[52:55], v[84:99]
    ds_read_b64_tr_b16 v[46:47], v32 offset:25400
    ds_read_b64_tr_b16 v[48:49], v32 offset:24688
    ds_read_b64_tr_b16 v[50:51], v32 offset:25456
    v_mfma_f32_32x32x16_bf16 v[100:115], v[64:67], v[52:55], v[100:115]
    s_waitcnt lgkmcnt(0)
    v_mfma_f32_32x32x16_bf16 v[68:83], v[40:43], v[36:39], v[68:83]
    ds_read_b128 v[52:55], v25 offset:32768
    ds_read_b64_tr_b16 v[56:57], v32 offset:27648
    ds_read_b64_tr_b16 v[58:59], v32 offset:28416
    ds_read_b64_tr_b16 v[60:61], v32 offset:27704
    v_mfma_f32_32x32x16_bf16 v[84:99], v[44:47], v[36:39], v[84:99]
    ds_read_b64_tr_b16 v[62:63], v32 offset:28472
    ds_read_b64_tr_b16 v[64:65], v32 offset:27760
    ds_read_b64_tr_b16 v[66:67], v32 offset:28528
    v_mfma_f32_32x32x16_bf16 v[100:115], v[48:51], v[36:39], v[100:115]
    s_waitcnt lgkmcnt(0)
    v_mfma_f32_32x32x16_bf16 v[68:83], v[56:59], v[52:55], v[68:83]
    ds_read_b128 v[36:39], v26 offset:32768
    ds_read_b64_tr_b16 v[40:41], v32 offset:30720
    ds_read_b64_tr_b16 v[42:43], v32 offset:31488
    ds_read_b64_tr_b16 v[44:45], v32 offset:30776
    v_mfma_f32_32x32x16_bf16 v[84:99], v[60:63], v[52:55], v[84:99]
    ds_read_b64_tr_b16 v[46:47], v32 offset:31544
    ds_read_b64_tr_b16 v[48:49], v32 offset:30832
    ds_read_b64_tr_b16 v[50:51], v32 offset:31600
    v_mfma_f32_32x32x16_bf16 v[100:115], v[64:67], v[52:55], v[100:115]
    s_waitcnt lgkmcnt(0)
    v_mfma_f32_32x32x16_bf16 v[68:83], v[40:43], v[36:39], v[68:83]
    ds_read_b128 v[52:55], v27 offset:32768
    ds_read_b64_tr_b16 v[56:57], v32 offset:33792
    ds_read_b64_tr_b16 v[58:59], v32 offset:34560
    ds_read_b64_tr_b16 v[60:61], v32 offset:33848
    v_mfma_f32_32x32x16_bf16 v[84:99], v[44:47], v[36:39], v[84:99]
    ds_read_b64_tr_b16 v[62:63], v32 offset:34616
    ds_read_b64_tr_b16 v[64:65], v32 offset:33904
    ds_read_b64_tr_b16 v[66:67], v32 offset:34672
    v_mfma_f32_32x32x16_bf16 v[100:115], v[48:51], v[36:39], v[100:115]
    s_waitcnt lgkmcnt(0)
    v_mfma_f32_32x32x16_bf16 v[68:83], v[56:59], v[52:55], v[68:83]
    s_barrier
    ds_read_b128 v[36:39], v24 offset:49152
    ds_read_b64_tr_b16 v[40:41], v32 offset:0
    ds_read_b64_tr_b16 v[42:43], v32 offset:768
    ds_read_b64_tr_b16 v[44:45], v32 offset:56
    v_mfma_f32_32x32x16_bf16 v[84:99], v[60:63], v[52:55], v[84:99]
    ds_read_b64_tr_b16 v[46:47], v32 offset:824
    ds_read_b64_tr_b16 v[48:49], v32 offset:112
    ds_read_b64_tr_b16 v[50:51], v32 offset:880
    v_mfma_f32_32x32x16_bf16 v[100:115], v[64:67], v[52:55], v[100:115]
    s_waitcnt lgkmcnt(0)
    v_mfma_f32_32x32x16_bf16 v[68:83], v[40:43], v[36:39], v[68:83]
    ds_read_b128 v[52:55], v25 offset:49152
    ds_read_b64_tr_b16 v[56:57], v32 offset:3072
    ds_read_b64_tr_b16 v[58:59], v32 offset:3840
    ds_read_b64_tr_b16 v[60:61], v32 offset:3128
    v_mfma_f32_32x32x16_bf16 v[84:99], v[44:47], v[36:39], v[84:99]
    ds_read_b64_tr_b16 v[62:63], v32 offset:3896
    ds_read_b64_tr_b16 v[64:65], v32 offset:3184
    ds_read_b64_tr_b16 v[66:67], v32 offset:3952
    v_mfma_f32_32x32x16_bf16 v[100:115], v[48:51], v[36:39], v[100:115]
    s_waitcnt lgkmcnt(0)
    v_mfma_f32_32x32x16_bf16 v[68:83], v[56:59], v[52:55], v[68:83]
    ds_read_b128 v[36:39], v26 offset:49152
    ds_read_b64_tr_b16 v[40:41], v32 offset:6144
    ds_read_b64_tr_b16 v[42:43], v32 offset:6912
    ds_read_b64_tr_b16 v[44:45], v32 offset:6200
    v_mfma_f32_32x32x16_bf16 v[84:99], v[60:63], v[52:55], v[84:99]
    ds_read_b64_tr_b16 v[46:47], v32 offset:6968
    ds_read_b64_tr_b16 v[48:49], v32 offset:6256
    ds_read_b64_tr_b16 v[50:51], v32 offset:7024
    v_mfma_f32_32x32x16_bf16 v[100:115], v[64:67], v[52:55], v[100:115]
    s_waitcnt lgkmcnt(0)
    v_mfma_f32_32x32x16_bf16 v[68:83], v[40:43], v[36:39], v[68:83]
    ds_read_b128 v[52:55], v27 offset:49152
    ds_read_b64_tr_b16 v[56:57], v32 offset:9216
    ds_read_b64_tr_b16 v[58:59], v32 offset:9984
    ds_read_b64_tr_b16 v[60:61], v32 offset:9272
    v_mfma_f32_32x32x16_bf16 v[84:99], v[44:47], v[36:39], v[84:99]
    ds_read_b64_tr_b16 v[62:63], v32 offset:10040
    ds_read_b64_tr_b16 v[64:65], v32 offset:9328
    ds_read_b64_tr_b16 v[66:67], v32 offset:10096
    v_mfma_f32_32x32x16_bf16 v[100:115], v[48:51], v[36:39], v[100:115]
    s_waitcnt lgkmcnt(0)
    v_mfma_f32_32x32x16_bf16 v[68:83], v[56:59], v[52:55], v[68:83]
    s_barrier
    ds_read_b128 v[36:39], v28 offset:0
    ds_read_b64_tr_b16 v[40:41], v32 offset:12288
    ds_read_b64_tr_b16 v[42:43], v32 offset:13056
    ds_read_b64_tr_b16 v[44:45], v32 offset:12344
    v_mfma_f32_32x32x16_bf16 v[84:99], v[60:63], v[52:55], v[84:99]
    ds_read_b64_tr_b16 v[46:47], v32 offset:13112
    ds_read_b64_tr_b16 v[48:49], v32 offset:12400
    ds_read_b64_tr_b16 v[50:51], v32 offset:13168
    v_mfma_f32_32x32x16_bf16 v[100:115], v[64:67], v[52:55], v[100:115]
    s_waitcnt lgkmcnt(0)
    v_mfma_f32_32x32x16_bf16 v[68:83], v[40:43], v[36:39], v[68:83]
    ds_read_b128 v[52:55], v29 offset:0
    ds_read_b64_tr_b16 v[56:57], v32 offset:15360
    ds_read_b64_tr_b16 v[58:59], v32 offset:16128
    ds_read_b64_tr_b16 v[60:61], v32 offset:15416
    v_mfma_f32_32x32x16_bf16 v[84:99], v[44:47], v[36:39], v[84:99]
    ds_read_b64_tr_b16 v[62:63], v32 offset:16184
    ds_read_b64_tr_b16 v[64:65], v32 offset:15472
    ds_read_b64_tr_b16 v[66:67], v32 offset:16240
    v_mfma_f32_32x32x16_bf16 v[100:115], v[48:51], v[36:39], v[100:115]
    s_waitcnt lgkmcnt(0)
    v_mfma_f32_32x32x16_bf16 v[68:83], v[56:59], v[52:55], v[68:83]
    ds_read_b128 v[36:39], v30 offset:0
    ds_read_b64_tr_b16 v[40:41], v32 offset:18432
    ds_read_b64_tr_b16 v[42:43], v32 offset:19200
    ds_read_b64_tr_b16 v[44:45], v32 offset:18488
    v_mfma_f32_32x32x16_bf16 v[84:99], v[60:63], v[52:55], v[84:99]
    ds_read_b64_tr_b16 v[46:47], v32 offset:19256
    ds_read_b64_tr_b16 v[48:49], v32 offset:18544
    ds_read_b64_tr_b16 v[50:51], v32 offset:19312
    v_mfma_f32_32x32x16_bf16 v[100:115], v[64:67], v[52:55], v[100:115]
    s_waitcnt lgkmcnt(0)
    v_mfma_f32_32x32x16_bf16 v[68:83], v[40:43], v[36:39], v[68:83]
    ds_read_b128 v[52:55], v31 offset:0
    ds_read_b64_tr_b16 v[56:57], v32 offset:21504
    ds_read_b64_tr_b16 v[58:59], v32 offset:22272
    ds_read_b64_tr_b16 v[60:61], v32 offset:21560
    v_mfma_f32_32x32x16_bf16 v[84:99], v[44:47], v[36:39], v[84:99]
    ds_read_b64_tr_b16 v[62:63], v32 offset:22328
    ds_read_b64_tr_b16 v[64:65], v32 offset:21616
    ds_read_b64_tr_b16 v[66:67], v32 offset:22384
    v_mfma_f32_32x32x16_bf16 v[100:115], v[48:51], v[36:39], v[100:115]
    s_waitcnt lgkmcnt(0)
    v_mfma_f32_32x32x16_bf16 v[68:83], v[56:59], v[52:55], v[68:83]
    s_barrier
    ds_read_b128 v[36:39], v28 offset:16384
    ds_read_b64_tr_b16 v[40:41], v32 offset:24576
    ds_read_b64_tr_b16 v[42:43], v32 offset:25344
    ds_read_b64_tr_b16 v[44:45], v32 offset:24632
    v_mfma_f32_32x32x16_bf16 v[84:99], v[60:63], v[52:55], v[84:99]
    ds_read_b64_tr_b16 v[46:47], v32 offset:25400
    ds_read_b64_tr_b16 v[48:49], v32 offset:24688
    ds_read_b64_tr_b16 v[50:51], v32 offset:25456
    v_mfma_f32_32x32x16_bf16 v[100:115], v[64:67], v[52:55], v[100:115]
    s_waitcnt lgkmcnt(0)
    v_mfma_f32_32x32x16_bf16 v[68:83], v[40:43], v[36:39], v[68:83]
    ds_read_b128 v[52:55], v29 offset:16384
    ds_read_b64_tr_b16 v[56:57], v32 offset:27648
    ds_read_b64_tr_b16 v[58:59], v32 offset:28416
    ds_read_b64_tr_b16 v[60:61], v32 offset:27704
    v_mfma_f32_32x32x16_bf16 v[84:99], v[44:47], v[36:39], v[84:99]
    ds_read_b64_tr_b16 v[62:63], v32 offset:28472
    ds_read_b64_tr_b16 v[64:65], v32 offset:27760
    ds_read_b64_tr_b16 v[66:67], v32 offset:28528
    v_mfma_f32_32x32x16_bf16 v[100:115], v[48:51], v[36:39], v[100:115]
    s_waitcnt lgkmcnt(0)
    v_mfma_f32_32x32x16_bf16 v[68:83], v[56:59], v[52:55], v[68:83]
    ds_read_b128 v[36:39], v30 offset:16384
    ds_read_b64_tr_b16 v[40:41], v32 offset:30720
    ds_read_b64_tr_b16 v[42:43], v32 offset:31488
    ds_read_b64_tr_b16 v[44:45], v32 offset:30776
    v_mfma_f32_32x32x16_bf16 v[84:99], v[60:63], v[52:55], v[84:99]
    ds_read_b64_tr_b16 v[46:47], v32 offset:31544
    ds_read_b64_tr_b16 v[48:49], v32 offset:30832
    ds_read_b64_tr_b16 v[50:51], v32 offset:31600
    v_mfma_f32_32x32x16_bf16 v[100:115], v[64:67], v[52:55], v[100:115]
    s_waitcnt lgkmcnt(0)
    v_mfma_f32_32x32x16_bf16 v[68:83], v[40:43], v[36:39], v[68:83]
    ds_read_b128 v[52:55], v31 offset:16384
    ds_read_b64_tr_b16 v[56:57], v32 offset:33792
    ds_read_b64_tr_b16 v[58:59], v32 offset:34560
    ds_read_b64_tr_b16 v[60:61], v32 offset:33848
    v_mfma_f32_32x32x16_bf16 v[84:99], v[44:47], v[36:39], v[84:99]
    ds_read_b64_tr_b16 v[62:63], v32 offset:34616
    ds_read_b64_tr_b16 v[64:65], v32 offset:33904
    ds_read_b64_tr_b16 v[66:67], v32 offset:34672
    v_mfma_f32_32x32x16_bf16 v[100:115], v[48:51], v[36:39], v[100:115]
    s_waitcnt lgkmcnt(0)
    v_mfma_f32_32x32x16_bf16 v[68:83], v[56:59], v[52:55], v[68:83]
    s_barrier
    ds_read_b128 v[36:39], v28 offset:32768
    ds_read_b64_tr_b16 v[40:41], v32 offset:0
    ds_read_b64_tr_b16 v[42:43], v32 offset:768
    ds_read_b64_tr_b16 v[44:45], v32 offset:56
    v_mfma_f32_32x32x16_bf16 v[84:99], v[60:63], v[52:55], v[84:99]
    ds_read_b64_tr_b16 v[46:47], v32 offset:824
    ds_read_b64_tr_b16 v[48:49], v32 offset:112
    ds_read_b64_tr_b16 v[50:51], v32 offset:880
    v_mfma_f32_32x32x16_bf16 v[100:115], v[64:67], v[52:55], v[100:115]
    s_waitcnt lgkmcnt(0)
    v_mfma_f32_32x32x16_bf16 v[68:83], v[40:43], v[36:39], v[68:83]
    ds_read_b128 v[52:55], v29 offset:32768
    ds_read_b64_tr_b16 v[56:57], v32 offset:3072
    ds_read_b64_tr_b16 v[58:59], v32 offset:3840
    ds_read_b64_tr_b16 v[60:61], v32 offset:3128
    v_mfma_f32_32x32x16_bf16 v[84:99], v[44:47], v[36:39], v[84:99]
    ds_read_b64_tr_b16 v[62:63], v32 offset:3896
    ds_read_b64_tr_b16 v[64:65], v32 offset:3184
    ds_read_b64_tr_b16 v[66:67], v32 offset:3952
    v_mfma_f32_32x32x16_bf16 v[100:115], v[48:51], v[36:39], v[100:115]
    s_waitcnt lgkmcnt(0)
    v_mfma_f32_32x32x16_bf16 v[68:83], v[56:59], v[52:55], v[68:83]
    ds_read_b128 v[36:39], v30 offset:32768
    ds_read_b64_tr_b16 v[40:41], v32 offset:6144
    ds_read_b64_tr_b16 v[42:43], v32 offset:6912
    ds_read_b64_tr_b16 v[44:45], v32 offset:6200
    v_mfma_f32_32x32x16_bf16 v[84:99], v[60:63], v[52:55], v[84:99]
    ds_read_b64_tr_b16 v[46:47], v32 offset:6968
    ds_read_b64_tr_b16 v[48:49], v32 offset:6256
    ds_read_b64_tr_b16 v[50:51], v32 offset:7024
    v_mfma_f32_32x32x16_bf16 v[100:115], v[64:67], v[52:55], v[100:115]
    s_waitcnt lgkmcnt(0)
    v_mfma_f32_32x32x16_bf16 v[68:83], v[40:43], v[36:39], v[68:83]
    ds_read_b128 v[52:55], v31 offset:32768
    ds_read_b64_tr_b16 v[56:57], v32 offset:9216
    ds_read_b64_tr_b16 v[58:59], v32 offset:9984
    ds_read_b64_tr_b16 v[60:61], v32 offset:9272
    v_mfma_f32_32x32x16_bf16 v[84:99], v[44:47], v[36:39], v[84:99]
    ds_read_b64_tr_b16 v[62:63], v32 offset:10040
    ds_read_b64_tr_b16 v[64:65], v32 offset:9328
    ds_read_b64_tr_b16 v[66:67], v32 offset:10096
    v_mfma_f32_32x32x16_bf16 v[100:115], v[48:51], v[36:39], v[100:115]
    s_waitcnt lgkmcnt(0)
    v_mfma_f32_32x32x16_bf16 v[68:83], v[56:59], v[52:55], v[68:83]
    v_mfma_f32_32x32x16_bf16 v[84:99], v[60:63], v[52:55], v[84:99]
    v_mfma_f32_32x32x16_bf16 v[100:115], v[64:67], v[52:55], v[100:115]
    s_barrier
    s_nop 10
    v_cvt_pk_bf16_f32 v100, v100, v101
    v_cvt_pk_bf16_f32 v101, v102, v103
    v_cvt_pk_bf16_f32 v102, v104, v105
    v_cvt_pk_bf16_f32 v103, v106, v107
    v_cvt_pk_bf16_f32 v104, v108, v109
    v_cvt_pk_bf16_f32 v105, v110, v111
    v_cvt_pk_bf16_f32 v106, v112, v113
    v_cvt_pk_bf16_f32 v107, v114, v115
    s_mov_b32 exec_lo, 0
    v_mov_b32 v106, 0x3f803f80
    v_mov_b32 v107, 0x3f80
    s_mov_b64 exec, -1
    buffer_store_dwordx4 v[100:103], v2, s[24:27], s46 offen sc1
    buffer_store_dwordx4 v[104:107], v2, s[24:27], s46 offen offset:1024 sc1
    v_cvt_pk_bf16_f32 v84, v84, v85
    v_cvt_pk_bf16_f32 v85, v86, v87
    v_cvt_pk_bf16_f32 v86, v88, v89
    v_cvt_pk_bf16_f32 v87, v90, v91
    v_cvt_pk_bf16_f32 v88, v92, v93
    v_cvt_pk_bf16_f32 v89, v94, v95
    v_cvt_pk_bf16_f32 v90, v96, v97
    v_cvt_pk_bf16_f32 v91, v98, v99
    s_mov_b32 exec_lo, 0
    v_mov_b32 v90, 0x3f803f80
    v_mov_b32 v91, 0x3f80
    s_mov_b64 exec, -1
    buffer_store_dwordx4 v[84:87], v2, s[24:27], s45 offen sc1
    buffer_store_dwordx4 v[88:91], v2, s[24:27], s45 offen offset:1024 sc1
    v_mul_f32 v68, s48, v68
    v_mul_f32 v69, s48, v69
    v_mul_f32 v70, s48, v70
    v_mul_f32 v71, s48, v71
    v_mul_f32 v72, s48, v72
    v_mul_f32 v73, s48, v73
    v_mul_f32 v74, s48, v74
    v_mul_f32 v75, s48, v75
    v_mul_f32 v76, s48, v76
    v_mul_f32 v77, s48, v77
    v_mul_f32 v78, s48, v78
    v_mul_f32 v79, s48, v79
    v_mul_f32 v80, s48, v80
    v_mul_f32 v81, s48, v81
    v_mul_f32 v82, s48, v82
    v_mul_f32 v83, s48, v83
    v_cvt_pk_bf16_f32 v68, v68, v69
    v_cvt_pk_bf16_f32 v69, v70, v71
    v_cvt_pk_bf16_f32 v70, v72, v73
    v_cvt_pk_bf16_f32 v71, v74, v75
    v_cvt_pk_bf16_f32 v72, v76, v77
    v_cvt_pk_bf16_f32 v73, v78, v79
    v_cvt_pk_bf16_f32 v74, v80, v81
    v_cvt_pk_bf16_f32 v75, v82, v83
    s_mov_b32 exec_lo, 0
    v_mov_b32 v74, 0
    v_mov_b32 v75, 0
    s_mov_b64 exec, -1
    buffer_store_dwordx4 v[68:71], v2, s[24:27], s44 offen sc1
    buffer_store_dwordx4 v[72:75], v2, s[24:27], s44 offen offset:1024 sc1
    s_branch KF_EPI0
KF_V0_kkk:
    s_add_u32 s40, s43, 0
    s_and_b32 s40, s40, 15
    s_lshl_b32 s40, s40, 6
    s_add_u32 s40, s40, s41
    s_lshl_b32 s40, s40, 12
    s_add_u32 s40, s40, s42
    s_add_u32 s44, s40, 2097152
    s_add_u32 s40, s43, 1
    s_and_b32 s40, s40, 15
    s_lshl_b32 s40, s40, 6
    s_add_u32 s40, s40, s41
    s_lshl_b32 s40, s40, 12
    s_add_u32 s40, s40, s42
    s_add_u32 s45, s40, 2097152
    s_add_u32 s40, s43, 2
    s_and_b32 s40, s40, 15
    s_lshl_b32 s40, s40, 6
    s_add_u32 s40, s40, s41
    s_lshl_b32 s40, s40, 12
    s_add_u32 s40, s40, s42
    s_add_u32 s46, s40, 2097152
    s_barrier
    ds_read_b128 v[36:39], v24 offset:0
    ds_read_b64_tr_b16 v[40:41], v32 offset:0
    ds_read_b64_tr_b16 v[42:43], v32 offset:768
    ds_read_b64_tr_b16 v[44:45], v32 offset:56
    ds_read_b64_tr_b16 v[46:47], v32 offset:824
    ds_read_b64_tr_b16 v[48:49], v32 offset:112
    ds_read_b64_tr_b16 v[50:51], v32 offset:880
    s_waitcnt lgkmcnt(0)
    v_mfma_f32_32x32x16_bf16 v[68:83], v[40:43], v[36:39], 0
    ds_read_b128 v[52:55], v25 offset:0
    ds_read_b64_tr_b16 v[56:57], v32 offset:3072
    ds_read_b64_tr_b16 v[58:59], v32 offset:3840
    ds_read_b64_tr_b16 v[60:61], v32 offset:3128
    v_mfma_f32_32x32x16_bf16 v[84:99], v[44:47], v[36:39], 0
    ds_read_b64_tr_b16 v[62:63], v32 offset:3896
    ds_read_b64_tr_b16 v[64:65], v32 offset:3184
    ds_read_b64_tr_b16 v[66:67], v32 offset:3952
    v_mfma_f32_32x32x16_bf16 v[100:115], v[48:51], v[36:39], 0
    s_waitcnt lgkmcnt(0)
    v_mfma_f32_32x32x16_bf16 v[68:83], v[56:59], v[52:55], v[68:83]
    ds_read_b128 v[36:39], v26 offset:0
    ds_read_b64_tr_b16 v[40:41], v32 offset:6144
    ds_read_b64_tr_b16 v[42:43], v32 offset:6912
    ds_read_b64_tr_b16 v[44:45], v32 offset:6200
    v_mfma_f32_32x32x16_bf16 v[84:99], v[60:63], v[52:55], v[84:99]
    ds_read_b64_tr_b16 v[46:47], v32 offset:6968
    ds_read_b64_tr_b16 v[48:49], v32 offset:6256
    ds_read_b64_tr_b16 v[50:51], v32 offset:7024
    v_mfma_f32_32x32x16_bf16 v[100:115], v[64:67], v[52:55], v[100:115]
    s_waitcnt lgkmcnt(0)
    v_mfma_f32_32x32x16_bf16 v[68:83], v[40:43], v[36:39], v[68:83]
    ds_read_b128 v[52:55], v27 offset:0
    ds_read_b64_tr_b16 v[56:57], v32 offset:9216
    ds_read_b64_tr_b16 v[58:59], v32 offset:9984
    ds_read_b64_tr_b16 v[60:61], v32 offset:9272
    v_mfma_f32_32x32x16_bf16 v[84:99], v[44:47], v[36:39], v[84:99]
    ds_read_b64_tr_b16 v[62:63], v32 offset:10040
    ds_read_b64_tr_b16 v[64:65], v32 offset:9328
    ds_read_b64_tr_b16 v[66:67], v32 offset:10096
    v_mfma_f32_32x32x16_bf16 v[100:115], v[48:51], v[36:39], v[100:115]
    s_waitcnt lgkmcnt(0)
    v_mfma_f32_32x32x16_bf16 v[68:83], v[56:59], v[52:55], v[68:83]
    s_barrier
    ds_read_b128 v[36:39], v24 offset:16384
    ds_read_b64_tr_b16 v[40:41], v32 offset:12288
    ds_read_b64_tr_b16 v[42:43], v32 offset:13056
    ds_read_b64_tr_b16 v[44:45], v32 offset:12344
    v_mfma_f32_32x32x16_bf16 v[84:99], v[60:63], v[52:55], v[84:99]
    ds_read_b64_tr_b16 v[46:47], v32 offset:13112
    ds_read_b64_tr_b16 v[48:49], v32 offset:12400
    ds_read_b64_tr_b16 v[50:51], v32 offset:13168
    v_mfma_f32_32x32x16_bf16 v[100:115], v[64:67], v[52:55], v[100:115]
    s_waitcnt lgkmcnt(0)
    v_mfma_f32_32x32x16_bf16 v[68:83], v[40:43], v[36:39], v[68:83]
    ds_read_b128 v[52:55], v25 offset:16384
    ds_read_b64_tr_b16 v[56:57], v32 offset:15360
    ds_read_b64_tr_b16 v[58:59], v32 offset:16128
    ds_read_b64_tr_b16 v[60:61], v32 offset:15416
    v_mfma_f32_32x32x16_bf16 v[84:99], v[44:47], v[36:39], v[84:99]
    ds_read_b64_tr_b16 v[62:63], v32 offset:16184
    ds_read_b64_tr_b16 v[64:65], v32 offset:15472
    ds_read_b64_tr_b16 v[66:67], v32 offset:16240
    v_mfma_f32_32x32x16_bf16 v[100:115], v[48:51], v[36:39], v[100:115]
    s_waitcnt lgkmcnt(0)
    v_mfma_f32_32x32x16_bf16 v[68:83], v[56:59], v[52:55], v[68:83]
    ds_read_b128 v[36:39], v26 offset:16384
    ds_read_b64_tr_b16 v[40:41], v32 offset:18432
    ds_read_b64_tr_b16 v[42:43], v32 offset:19200
    ds_read_b64_tr_b16 v[44:45], v32 offset:18488
    v_mfma_f32_32x32x16_bf16 v[84:99], v[60:63], v[52:55], v[84:99]
    ds_read_b64_tr_b16 v[46:47], v32 offset:19256
    ds_read_b64_tr_b16 v[48:49], v32 offset:18544
    ds_read_b64_tr_b16 v[50:51], v32 offset:19312
    v_mfma_f32_32x32x16_bf16 v[100:115], v[64:67], v[52:55], v[100:115]
    s_waitcnt lgkmcnt(0)
    v_mfma_f32_32x32x16_bf16 v[68:83], v[40:43], v[36:39], v[68:83]
    ds_read_b128 v[52:55], v27 offset:16384
    ds_read_b64_tr_b16 v[56:57], v32 offset:21504
    ds_read_b64_tr_b16 v[58:59], v32 offset:22272
    ds_read_b64_tr_b16 v[60:61], v32 offset:21560
    v_mfma_f32_32x32x16_bf16 v[84:99], v[44:47], v[36:39], v[84:99]
    ds_read_b64_tr_b16 v[62:63], v32 offset:22328
    ds_read_b64_tr_b16 v[64:65], v32 offset:21616
    ds_read_b64_tr_b16 v[66:67], v32 offset:22384
    v_mfma_f32_32x32x16_bf16 v[100:115], v[48:51], v[36:39], v[100:115]
    s_waitcnt lgkmcnt(0)
    v_mfma_f32_32x32x16_bf16 v[68:83], v[56:59], v[52:55], v[68:83]
    s_barrier
    ds_read_b128 v[36:39], v24 offset:32768
    ds_read_b64_tr_b16 v[40:41], v32 offset:24576
    ds_read_b64_tr_b16 v[42:43], v32 offset:25344
    ds_read_b64_tr_b16 v[44:45], v32 offset:24632
    v_mfma_f32_32x32x16_bf16 v[84:99], v[60:63], v[52:55], v[84:99]
    ds_read_b64_tr_b16 v[46:47], v32 offset:25400
    ds_read_b64_tr_b16 v[48:49], v32 offset:24688
    ds_read_b64_tr_b16 v[50:51], v32 offset:25456
    v_mfma_f32_32x32x16_bf16 v[100:115], v[64:67], v[52:55], v[100:115]
    s_waitcnt lgkmcnt(0)
    v_mfma_f32_32x32x16_bf16 v[68:83], v[40:43], v[36:39], v[68:83]
    ds_read_b128 v[52:55], v25 offset:32768
    ds_read_b64_tr_b16 v[56:57], v32 offset:27648
    ds_read_b64_tr_b16 v[58:59], v32 offset:28416
    ds_read_b64_tr_b16 v[60:61], v32 offset:27704
    v_mfma_f32_32x32x16_bf16 v[84:99], v[44:47], v[36:39], v[84:99]
    ds_read_b64_tr_b16 v[62:63], v32 offset:28472
    ds_read_b64_tr_b16 v[64:65], v32 offset:27760
    ds_read_b64_tr_b16 v[66:67], v32 offset:28528
    v_mfma_f32_32x32x16_bf16 v[100:115], v[48:51], v[36:39], v[100:115]
    s_waitcnt lgkmcnt(0)
    v_mfma_f32_32x32x16_bf16 v[68:83], v[56:59], v[52:55], v[68:83]
    ds_read_b128 v[36:39], v26 offset:32768
    ds_read_b64_tr_b16 v[40:41], v32 offset:30720
    ds_read_b64_tr_b16 v[42:43], v32 offset:31488
    ds_read_b64_tr_b16 v[44:45], v32 offset:30776
    v_mfma_f32_32x32x16_bf16 v[84:99], v[60:63], v[52:55], v[84:99]
    ds_read_b64_tr_b16 v[46:47], v32 offset:31544
    ds_read_b64_tr_b16 v[48:49], v32 offset:30832
    ds_read_b64_tr_b16 v[50:51], v32 offset:31600
    v_mfma_f32_32x32x16_bf16 v[100:115], v[64:67], v[52:55], v[100:115]
    s_waitcnt lgkmcnt(0)
    v_mfma_f32_32x32x16_bf16 v[68:83], v[40:43], v[36:39], v[68:83]
    ds_read_b128 v[52:55], v27 offset:32768
    ds_read_b64_tr_b16 v[56:57], v32 offset:33792
    ds_read_b64_tr_b16 v[58:59], v32 offset:34560
    ds_read_b64_tr_b16 v[60:61], v32 offset:33848
    v_mfma_f32_32x32x16_bf16 v[84:99], v[44:47], v[36:39], v[84:99]
    ds_read_b64_tr_b16 v[62:63], v32 offset:34616
    ds_read_b64_tr_b16 v[64:65], v32 offset:33904
    ds_read_b64_tr_b16 v[66:67], v32 offset:34672
    v_mfma_f32_32x32x16_bf16 v[100:115], v[48:51], v[36:39], v[100:115]
    s_waitcnt lgkmcnt(0)
    v_mfma_f32_32x32x16_bf16 v[68:83], v[56:59], v[52:55], v[68:83]
    s_barrier
    ds_read_b128 v[36:39], v24 offset:49152
    ds_read_b64_tr_b16 v[40:41], v32 offset:0
    ds_read_b64_tr_b16 v[42:43], v32 offset:768
    ds_read_b64_tr_b16 v[44:45], v32 offset:56
    v_mfma_f32_32x32x16_bf16 v[84:99], v[60:63], v[52:55], v[84:99]
    ds_read_b64_tr_b16 v[46:47], v32 offset:824
    ds_read_b64_tr_b16 v[48:49], v32 offset:112
    ds_read_b64_tr_b16 v[50:51], v32 offset:880
    v_mfma_f32_32x32x16_bf16 v[100:115], v[64:67], v[52:55], v[100:115]
    s_waitcnt lgkmcnt(0)
    v_mfma_f32_32x32x16_bf16 v[68:83], v[40:43], v[36:39], v[68:83]
    ds_read_b128 v[52:55], v25 offset:49152
    ds_read_b64_tr_b16 v[56:57], v32 offset:3072
    ds_read_b64_tr_b16 v[58:59], v32 offset:3840
    ds_read_b64_tr_b16 v[60:61], v32 offset:3128
    v_mfma_f32_32x32x16_bf16 v[84:99], v[44:47], v[36:39], v[84:99]
    ds_read_b64_tr_b16 v[62:63], v32 offset:3896
    ds_read_b64_tr_b16 v[64:65], v32 offset:3184
    ds_read_b64_tr_b16 v[66:67], v32 offset:3952
    v_mfma_f32_32x32x16_bf16 v[100:115], v[48:51], v[36:39], v[100:115]
    s_waitcnt lgkmcnt(0)
    v_mfma_f32_32x32x16_bf16 v[68:83], v[56:59], v[52:55], v[68:83]
    ds_read_b128 v[36:39], v26 offset:49152
    ds_read_b64_tr_b16 v[40:41], v32 offset:6144
    ds_read_b64_tr_b16 v[42:43], v32 offset:6912
    ds_read_b64_tr_b16 v[44:45], v32 offset:6200
    v_mfma_f32_32x32x16_bf16 v[84:99], v[60:63], v[52:55], v[84:99]
    ds_read_b64_tr_b16 v[46:47], v32 offset:6968
    ds_read_b64_tr_b16 v[48:49], v32 offset:6256
    ds_read_b64_tr_b16 v[50:51], v32 offset:7024
    v_mfma_f32_32x32x16_bf16 v[100:115], v[64:67], v[52:55], v[100:115]
    s_waitcnt lgkmcnt(0)
    v_mfma_f32_32x32x16_bf16 v[68:83], v[40:43], v[36:39], v[68:83]
    ds_read_b128 v[52:55], v27 offset:49152
    ds_read_b64_tr_b16 v[56:57], v32 offset:9216
    ds_read_b64_tr_b16 v[58:59], v32 offset:9984
    ds_read_b64_tr_b16 v[60:61], v32 offset:9272
    v_mfma_f32_32x32x16_bf16 v[84:99], v[44:47], v[36:39], v[84:99]
    ds_read_b64_tr_b16 v[62:63], v32 offset:10040
    ds_read_b64_tr_b16 v[64:65], v32 offset:9328
    ds_read_b64_tr_b16 v[66:67], v32 offset:10096
    v_mfma_f32_32x32x16_bf16 v[100:115], v[48:51], v[36:39], v[100:115]
    s_waitcnt lgkmcnt(0)
    v_mfma_f32_32x32x16_bf16 v[68:83], v[56:59], v[52:55], v[68:83]
    s_barrier
    ds_read_b128 v[36:39], v28 offset:0
    ds_read_b64_tr_b16 v[40:41], v32 offset:12288
    ds_read_b64_tr_b16 v[42:43], v32 offset:13056
    ds_read_b64_tr_b16 v[44:45], v32 offset:12344
    v_mfma_f32_32x32x16_bf16 v[84:99], v[60:63], v[52:55], v[84:99]
    ds_read_b64_tr_b16 v[46:47], v32 offset:13112
    ds_read_b64_tr_b16 v[48:49], v32 offset:12400
    ds_read_b64_tr_b16 v[50:51], v32 offset:13168
    v_mfma_f32_32x32x16_bf16 v[100:115], v[64:67], v[52:55], v[100:115]
    s_waitcnt lgkmcnt(0)
    v_mfma_f32_32x32x16_bf16 v[68:83], v[40:43], v[36:39], v[68:83]
    ds_read_b128 v[52:55], v29 offset:0
    ds_read_b64_tr_b16 v[56:57], v32 offset:15360
    ds_read_b64_tr_b16 v[58:59], v32 offset:16128
    ds_read_b64_tr_b16 v[60:61], v32 offset:15416
    v_mfma_f32_32x32x16_bf16 v[84:99], v[44:47], v[36:39], v[84:99]
    ds_read_b64_tr_b16 v[62:63], v32 offset:16184
    ds_read_b64_tr_b16 v[64:65], v32 offset:15472
    ds_read_b64_tr_b16 v[66:67], v32 offset:16240
    v_mfma_f32_32x32x16_bf16 v[100:115], v[48:51], v[36:39], v[100:115]
    s_waitcnt lgkmcnt(0)
    v_mfma_f32_32x32x16_bf16 v[68:83], v[56:59], v[52:55], v[68:83]
    ds_read_b128 v[36:39], v30 offset:0
    ds_read_b64_tr_b16 v[40:41], v32 offset:18432
    ds_read_b64_tr_b16 v[42:43], v32 offset:19200
    ds_read_b64_tr_b16 v[44:45], v32 offset:18488
    v_mfma_f32_32x32x16_bf16 v[84:99], v[60:63], v[52:55], v[84:99]
    ds_read_b64_tr_b16 v[46:47], v32 offset:19256
    ds_read_b64_tr_b16 v[48:49], v32 offset:18544
    ds_read_b64_tr_b16 v[50:51], v32 offset:19312
    v_mfma_f32_32x32x16_bf16 v[100:115], v[64:67], v[52:55], v[100:115]
    s_waitcnt lgkmcnt(0)
    v_mfma_f32_32x32x16_bf16 v[68:83], v[40:43], v[36:39], v[68:83]
    ds_read_b128 v[52:55], v31 offset:0
    ds_read_b64_tr_b16 v[56:57], v32 offset:21504
    ds_read_b64_tr_b16 v[58:59], v32 offset:22272
    ds_read_b64_tr_b16 v[60:61], v32 offset:21560
    v_mfma_f32_32x32x16_bf16 v[84:99], v[44:47], v[36:39], v[84:99]
    ds_read_b64_tr_b16 v[62:63], v32 offset:22328
    ds_read_b64_tr_b16 v[64:65], v32 offset:21616
    ds_read_b64_tr_b16 v[66:67], v32 offset:22384
    v_mfma_f32_32x32x16_bf16 v[100:115], v[48:51], v[36:39], v[100:115]
    s_waitcnt lgkmcnt(0)
    v_mfma_f32_32x32x16_bf16 v[68:83], v[56:59], v[52:55], v[68:83]
    s_barrier
    ds_read_b128 v[36:39], v28 offset:16384
    ds_read_b64_tr_b16 v[40:41], v32 offset:24576
    ds_read_b64_tr_b16 v[42:43], v32 offset:25344
    ds_read_b64_tr_b16 v[44:45], v32 offset:24632
    v_mfma_f32_32x32x16_bf16 v[84:99], v[60:63], v[52:55], v[84:99]
    ds_read_b64_tr_b16 v[46:47], v32 offset:25400
    ds_read_b64_tr_b16 v[48:49], v32 offset:24688
    ds_read_b64_tr_b16 v[50:51], v32 offset:25456
    v_mfma_f32_32x32x16_bf16 v[100:115], v[64:67], v[52:55], v[100:115]
    s_waitcnt lgkmcnt(0)
    v_mfma_f32_32x32x16_bf16 v[68:83], v[40:43], v[36:39], v[68:83]
    ds_read_b128 v[52:55], v29 offset:16384
    ds_read_b64_tr_b16 v[56:57], v32 offset:27648
    ds_read_b64_tr_b16 v[58:59], v32 offset:28416
    ds_read_b64_tr_b16 v[60:61], v32 offset:27704
    v_mfma_f32_32x32x16_bf16 v[84:99], v[44:47], v[36:39], v[84:99]
    ds_read_b64_tr_b16 v[62:63], v32 offset:28472
    ds_read_b64_tr_b16 v[64:65], v32 offset:27760
    ds_read_b64_tr_b16 v[66:67], v32 offset:28528
    v_mfma_f32_32x32x16_bf16 v[100:115], v[48:51], v[36:39], v[100:115]
    s_waitcnt lgkmcnt(0)
    v_mfma_f32_32x32x16_bf16 v[68:83], v[56:59], v[52:55], v[68:83]
    ds_read_b128 v[36:39], v30 offset:16384
    ds_read_b64_tr_b16 v[40:41], v32 offset:30720
    ds_read_b64_tr_b16 v[42:43], v32 offset:31488
    ds_read_b64_tr_b16 v[44:45], v32 offset:30776
    v_mfma_f32_32x32x16_bf16 v[84:99], v[60:63], v[52:55], v[84:99]
    ds_read_b64_tr_b16 v[46:47], v32 offset:31544
    ds_read_b64_tr_b16 v[48:49], v32 offset:30832
    ds_read_b64_tr_b16 v[50:51], v32 offset:31600
    v_mfma_f32_32x32x16_bf16 v[100:115], v[64:67], v[52:55], v[100:115]
    s_waitcnt lgkmcnt(0)
    v_mfma_f32_32x32x16_bf16 v[68:83], v[40:43], v[36:39], v[68:83]
    ds_read_b128 v[52:55], v31 offset:16384
    ds_read_b64_tr_b16 v[56:57], v32 offset:33792
    ds_read_b64_tr_b16 v[58:59], v32 offset:34560
    ds_read_b64_tr_b16 v[60:61], v32 offset:33848
    v_mfma_f32_32x32x16_bf16 v[84:99], v[44:47], v[36:39], v[84:99]
    ds_read_b64_tr_b16 v[62:63], v32 offset:34616
    ds_read_b64_tr_b16 v[64:65], v32 offset:33904
    ds_read_b64_tr_b16 v[66:67], v32 offset:34672
    v_mfma_f32_32x32x16_bf16 v[100:115], v[48:51], v[36:39], v[100:115]
    s_waitcnt lgkmcnt(0)
    v_mfma_f32_32x32x16_bf16 v[68:83], v[56:59], v[52:55], v[68:83]
    s_barrier
    ds_read_b128 v[36:39], v28 offset:32768
    ds_read_b64_tr_b16 v[40:41], v32 offset:0
    ds_read_b64_tr_b16 v[42:43], v32 offset:768
    ds_read_b64_tr_b16 v[44:45], v32 offset:56
    v_mfma_f32_32x32x16_bf16 v[84:99], v[60:63], v[52:55], v[84:99]
    ds_read_b64_tr_b16 v[46:47], v32 offset:824
    ds_read_b64_tr_b16 v[48:49], v32 offset:112
    ds_read_b64_tr_b16 v[50:51], v32 offset:880
    v_mfma_f32_32x32x16_bf16 v[100:115], v[64:67], v[52:55], v[100:115]
    s_waitcnt lgkmcnt(0)
    v_mfma_f32_32x32x16_bf16 v[68:83], v[40:43], v[36:39], v[68:83]
    ds_read_b128 v[52:55], v29 offset:32768
    ds_read_b64_tr_b16 v[56:57], v32 offset:3072
    ds_read_b64_tr_b16 v[58:59], v32 offset:3840
    ds_read_b64_tr_b16 v[60:61], v32 offset:3128
    v_mfma_f32_32x32x16_bf16 v[84:99], v[44:47], v[36:39], v[84:99]
    ds_read_b64_tr_b16 v[62:63], v32 offset:3896
    ds_read_b64_tr_b16 v[64:65], v32 offset:3184
    ds_read_b64_tr_b16 v[66:67], v32 offset:3952
    v_mfma_f32_32x32x16_bf16 v[100:115], v[48:51], v[36:39], v[100:115]
    s_waitcnt lgkmcnt(0)
    v_mfma_f32_32x32x16_bf16 v[68:83], v[56:59], v[52:55], v[68:83]
    ds_read_b128 v[36:39], v30 offset:32768
    ds_read_b64_tr_b16 v[40:41], v32 offset:6144
    ds_read_b64_tr_b16 v[42:43], v32 offset:6912
    ds_read_b64_tr_b16 v[44:45], v32 offset:6200
    v_mfma_f32_32x32x16_bf16 v[84:99], v[60:63], v[52:55], v[84:99]
    ds_read_b64_tr_b16 v[46:47], v32 offset:6968
    ds_read_b64_tr_b16 v[48:49], v32 offset:6256
    ds_read_b64_tr_b16 v[50:51], v32 offset:7024
    v_mfma_f32_32x32x16_bf16 v[100:115], v[64:67], v[52:55], v[100:115]
    s_waitcnt lgkmcnt(0)
    v_mfma_f32_32x32x16_bf16 v[68:83], v[40:43], v[36:39], v[68:83]
    ds_read_b128 v[52:55], v31 offset:32768
    ds_read_b64_tr_b16 v[56:57], v32 offset:9216
    ds_read_b64_tr_b16 v[58:59], v32 offset:9984
    ds_read_b64_tr_b16 v[60:61], v32 offset:9272
    v_mfma_f32_32x32x16_bf16 v[84:99], v[44:47], v[36:39], v[84:99]
    ds_read_b64_tr_b16 v[62:63], v32 offset:10040
    ds_read_b64_tr_b16 v[64:65], v32 offset:9328
    ds_read_b64_tr_b16 v[66:67], v32 offset:10096
    v_mfma_f32_32x32x16_bf16 v[100:115], v[48:51], v[36:39], v[100:115]
    s_waitcnt lgkmcnt(0)
    v_mfma_f32_32x32x16_bf16 v[68:83], v[56:59], v[52:55], v[68:83]
    v_mfma_f32_32x32x16_bf16 v[84:99], v[60:63], v[52:55], v[84:99]
    v_mfma_f32_32x32x16_bf16 v[100:115], v[64:67], v[52:55], v[100:115]
    s_barrier
    s_nop 10
    v_cvt_pk_bf16_f32 v100, v100, v101
    v_cvt_pk_bf16_f32 v101, v102, v103
    v_cvt_pk_bf16_f32 v102, v104, v105
    v_cvt_pk_bf16_f32 v103, v106, v107
    v_cvt_pk_bf16_f32 v104, v108, v109
    v_cvt_pk_bf16_f32 v105, v110, v111
    v_cvt_pk_bf16_f32 v106, v112, v113
    v_cvt_pk_bf16_f32 v107, v114, v115
    s_mov_b32 exec_lo, 0
    v_mov_b32 v106, 0x3f803f80
    v_mov_b32 v107, 0x3f80
    s_mov_b64 exec, -1
    buffer_store_dwordx4 v[100:103], v2, s[24:27], s46 offen sc1
    buffer_store_dwordx4 v[104:107], v2, s[24:27], s46 offen offset:1024 sc1
    v_cvt_pk_bf16_f32 v84, v84, v85
    v_cvt_pk_bf16_f32 v85, v86, v87
    v_cvt_pk_bf16_f32 v86, v88, v89
    v_cvt_pk_bf16_f32 v87, v90, v91
    v_cvt_pk_bf16_f32 v88, v92, v93
    v_cvt_pk_bf16_f32 v89, v94, v95
    v_cvt_pk_bf16_f32 v90, v96, v97
    v_cvt_pk_bf16_f32 v91, v98, v99
    s_mov_b32 exec_lo, 0
    v_mov_b32 v90, 0x3f803f80
    v_mov_b32 v91, 0x3f80
    s_mov_b64 exec, -1
    buffer_store_dwordx4 v[84:87], v2, s[24:27], s45 offen sc1
    buffer_store_dwordx4 v[88:91], v2, s[24:27], s45 offen offset:1024 sc1
    v_cvt_pk_bf16_f32 v68, v68, v69
    v_cvt_pk_bf16_f32 v69, v70, v71
    v_cvt_pk_bf16_f32 v70, v72, v73
    v_cvt_pk_bf16_f32 v71, v74, v75
    v_cvt_pk_bf16_f32 v72, v76, v77
    v_cvt_pk_bf16_f32 v73, v78, v79
    v_cvt_pk_bf16_f32 v74, v80, v81
    v_cvt_pk_bf16_f32 v75, v82, v83
    s_mov_b32 exec_lo, 0
    v_mov_b32 v74, 0x3f803f80
    v_mov_b32 v75, 0x3f80
    s_mov_b64 exec, -1
    buffer_store_dwordx4 v[68:71], v2, s[24:27], s44 offen sc1
    buffer_store_dwordx4 v[72:75], v2, s[24:27], s44 offen offset:1024 sc1
    s_branch KF_EPI0
KF_V0_kkv:
    s_add_u32 s40, s43, 0
    s_and_b32 s40, s40, 15
    s_lshl_b32 s40, s40, 6
    s_add_u32 s40, s40, s41
    s_lshl_b32 s40, s40, 12
    s_add_u32 s40, s40, s42
    s_add_u32 s44, s40, 2097152
    s_add_u32 s40, s43, 1
    s_and_b32 s40, s40, 15
    s_lshl_b32 s40, s40, 6
    s_add_u32 s40, s40, s41
    s_lshl_b32 s40, s40, 12
    s_add_u32 s40, s40, s42
    s_add_u32 s45, s40, 2097152
    s_add_u32 s40, s43, 2
    s_and_b32 s40, s40, 15
    s_lshl_b32 s40, s40, 6
    s_add_u32 s40, s40, s41
    s_lshl_b32 s40, s40, 12
    s_add_u32 s40, s40, s42
    s_add_u32 s46, s40, 2099200
    s_barrier
    ds_read_b128 v[36:39], v24 offset:0
    ds_read_b64_tr_b16 v[40:41], v32 offset:0
    ds_read_b64_tr_b16 v[42:43], v32 offset:768
    ds_read_b64_tr_b16 v[44:45], v32 offset:56
    ds_read_b64_tr_b16 v[46:47], v32 offset:824
    ds_read_b64_tr_b16 v[48:49], v32 offset:112
    ds_read_b64_tr_b16 v[50:51], v32 offset:880
    s_waitcnt lgkmcnt(0)
    v_mfma_f32_32x32x16_bf16 v[68:83], v[40:43], v[36:39], 0
    ds_read_b128 v[52:55], v25 offset:0
    ds_read_b64_tr_b16 v[56:57], v32 offset:3072
    ds_read_b64_tr_b16 v[58:59], v32 offset:3840
    ds_read_b64_tr_b16 v[60:61], v32 offset:3128
    v_mfma_f32_32x32x16_bf16 v[84:99], v[44:47], v[36:39], 0
    ds_read_b64_tr_b16 v[62:63], v32 offset:3896
    ds_read_b64_tr_b16 v[64:65], v32 offset:3184
    ds_read_b64_tr_b16 v[66:67], v32 offset:3952
    v_mfma_f32_32x32x16_bf16 v[100:115], v[36:39], v[48:51], 0
    s_waitcnt lgkmcnt(0)
    v_mfma_f32_32x32x16_bf16 v[68:83], v[56:59], v[52:55], v[68:83]
    ds_read_b128 v[36:39], v26 offset:0
    ds_read_b64_tr_b16 v[40:41], v32 offset:6144
    ds_read_b64_tr_b16 v[42:43], v32 offset:6912
    ds_read_b64_tr_b16 v[44:45], v32 offset:6200
    v_mfma_f32_32x32x16_bf16 v[84:99], v[60:63], v[52:55], v[84:99]
    ds_read_b64_tr_b16 v[46:47], v32 offset:6968
    ds_read_b64_tr_b16 v[48:49], v32 offset:6256
    ds_read_b64_tr_b16 v[50:51], v32 offset:7024
    v_mfma_f32_32x32x16_bf16 v[100:115], v[52:55], v[64:67], v[100:115]
    s_waitcnt lgkmcnt(0)
    v_mfma_f32_32x32x16_bf16 v[68:83], v[40:43], v[36:39], v[68:83]
    ds_read_b128 v[52:55], v27 offset:0
    ds_read_b64_tr_b16 v[56:57], v32 offset:9216
    ds_read_b64_tr_b16 v[58:59], v32 offset:9984
    ds_read_b64_tr_b16 v[60:61], v32 offset:9272
    v_mfma_f32_32x32x16_bf16 v[84:99], v[44:47], v[36:39], v[84:99]
    ds_read_b64_tr_b16 v[62:63], v32 offset:10040
    ds_read_b64_tr_b16 v[64:65], v32 offset:9328
    ds_read_b64_tr_b16 v[66:67], v32 offset:10096
    v_mfma_f32_32x32x16_bf16 v[100:115], v[36:39], v[48:51], v[100:115]
    s_waitcnt lgkmcnt(0)
    v_mfma_f32_32x32x16_bf16 v[68:83], v[56:59], v[52:55], v[68:83]
    s_barrier
    ds_read_b128 v[36:39], v24 offset:16384
    ds_read_b64_tr_b16 v[40:41], v32 offset:12288
    ds_read_b64_tr_b16 v[42:43], v32 offset:13056
    ds_read_b64_tr_b16 v[44:45], v32 offset:12344
    v_mfma_f32_32x32x16_bf16 v[84:99], v[60:63], v[52:55], v[84:99]
    ds_read_b64_tr_b16 v[46:47], v32 offset:13112
    ds_read_b64_tr_b16 v[48:49], v32 offset:12400
    ds_read_b64_tr_b16 v[50:51], v32 offset:13168
    v_mfma_f32_32x32x16_bf16 v[100:115], v[52:55], v[64:67], v[100:115]
    s_waitcnt lgkmcnt(0)
    v_mfma_f32_32x32x16_bf16 v[68:83], v[40:43], v[36:39], v[68:83]
    ds_read_b128 v[52:55], v25 offset:16384
    ds_read_b64_tr_b16 v[56:57], v32 offset:15360
    ds_read_b64_tr_b16 v[58:59], v32 offset:16128
    ds_read_b64_tr_b16 v[60:61], v32 offset:15416
    v_mfma_f32_32x32x16_bf16 v[84:99], v[44:47], v[36:39], v[84:99]
    ds_read_b64_tr_b16 v[62:63], v32 offset:16184
    ds_read_b64_tr_b16 v[64:65], v32 offset:15472
    ds_read_b64_tr_b16 v[66:67], v32 offset:16240
    v_mfma_f32_32x32x16_bf16 v[100:115], v[36:39], v[48:51], v[100:115]
    s_waitcnt lgkmcnt(0)
    v_mfma_f32_32x32x16_bf16 v[68:83], v[56:59], v[52:55], v[68:83]
    ds_read_b128 v[36:39], v26 offset:16384
    ds_read_b64_tr_b16 v[40:41], v32 offset:18432
    ds_read_b64_tr_b16 v[42:43], v32 offset:19200
    ds_read_b64_tr_b16 v[44:45], v32 offset:18488
    v_mfma_f32_32x32x16_bf16 v[84:99], v[60:63], v[52:55], v[84:99]
    ds_read_b64_tr_b16 v[46:47], v32 offset:19256
    ds_read_b64_tr_b16 v[48:49], v32 offset:18544
    ds_read_b64_tr_b16 v[50:51], v32 offset:19312
    v_mfma_f32_32x32x16_bf16 v[100:115], v[52:55], v[64:67], v[100:115]
    s_waitcnt lgkmcnt(0)
    v_mfma_f32_32x32x16_bf16 v[68:83], v[40:43], v[36:39], v[68:83]
    ds_read_b128 v[52:55], v27 offset:16384
    ds_read_b64_tr_b16 v[56:57], v32 offset:21504
    ds_read_b64_tr_b16 v[58:59], v32 offset:22272
    ds_read_b64_tr_b16 v[60:61], v32 offset:21560
    v_mfma_f32_32x32x16_bf16 v[84:99], v[44:47], v[36:39], v[84:99]
    ds_read_b64_tr_b16 v[62:63], v32 offset:22328
    ds_read_b64_tr_b16 v[64:65], v32 offset:21616
    ds_read_b64_tr_b16 v[66:67], v32 offset:22384
    v_mfma_f32_32x32x16_bf16 v[100:115], v[36:39], v[48:51], v[100:115]
    s_waitcnt lgkmcnt(0)
    v_mfma_f32_32x32x16_bf16 v[68:83], v[56:59], v[52:55], v[68:83]
    s_barrier
    ds_read_b128 v[36:39], v24 offset:32768
    ds_read_b64_tr_b16 v[40:41], v32 offset:24576
    ds_read_b64_tr_b16 v[42:43], v32 offset:25344
    ds_read_b64_tr_b16 v[44:45], v32 offset:24632
    v_mfma_f32_32x32x16_bf16 v[84:99], v[60:63], v[52:55], v[84:99]
    ds_read_b64_tr_b16 v[46:47], v32 offset:25400
    ds_read_b64_tr_b16 v[48:49], v32 offset:24688
    ds_read_b64_tr_b16 v[50:51], v32 offset:25456
    v_mfma_f32_32x32x16_bf16 v[100:115], v[52:55], v[64:67], v[100:115]
    s_waitcnt lgkmcnt(0)
    v_mfma_f32_32x32x16_bf16 v[68:83], v[40:43], v[36:39], v[68:83]
    ds_read_b128 v[52:55], v25 offset:32768
    ds_read_b64_tr_b16 v[56:57], v32 offset:27648
    ds_read_b64_tr_b16 v[58:59], v32 offset:28416
    ds_read_b64_tr_b16 v[60:61], v32 offset:27704
    v_mfma_f32_32x32x16_bf16 v[84:99], v[44:47], v[36:39], v[84:99]
    ds_read_b64_tr_b16 v[62:63], v32 offset:28472
    ds_read_b64_tr_b16 v[64:65], v32 offset:27760
    ds_read_b64_tr_b16 v[66:67], v32 offset:28528
    v_mfma_f32_32x32x16_bf16 v[100:115], v[36:39], v[48:51], v[100:115]
    s_waitcnt lgkmcnt(0)
    v_mfma_f32_32x32x16_bf16 v[68:83], v[56:59], v[52:55], v[68:83]
    ds_read_b128 v[36:39], v26 offset:32768
    ds_read_b64_tr_b16 v[40:41], v32 offset:30720
    ds_read_b64_tr_b16 v[42:43], v32 offset:31488
    ds_read_b64_tr_b16 v[44:45], v32 offset:30776
    v_mfma_f32_32x32x16_bf16 v[84:99], v[60:63], v[52:55], v[84:99]
    ds_read_b64_tr_b16 v[46:47], v32 offset:31544
    ds_read_b64_tr_b16 v[48:49], v32 offset:30832
    ds_read_b64_tr_b16 v[50:51], v32 offset:31600
    v_mfma_f32_32x32x16_bf16 v[100:115], v[52:55], v[64:67], v[100:115]
    s_waitcnt lgkmcnt(0)
    v_mfma_f32_32x32x16_bf16 v[68:83], v[40:43], v[36:39], v[68:83]
    ds_read_b128 v[52:55], v27 offset:32768
    ds_read_b64_tr_b16 v[56:57], v32 offset:33792
    ds_read_b64_tr_b16 v[58:59], v32 offset:34560
    ds_read_b64_tr_b16 v[60:61], v32 offset:33848
    v_mfma_f32_32x32x16_bf16 v[84:99], v[44:47], v[36:39], v[84:99]
    ds_read_b64_tr_b16 v[62:63], v32 offset:34616
    ds_read_b64_tr_b16 v[64:65], v32 offset:33904
    ds_read_b64_tr_b16 v[66:67], v32 offset:34672
    v_mfma_f32_32x32x16_bf16 v[100:115], v[36:39], v[48:51], v[100:115]
    s_waitcnt lgkmcnt(0)
    v_mfma_f32_32x32x16_bf16 v[68:83], v[56:59], v[52:55], v[68:83]
    s_barrier
    ds_read_b128 v[36:39], v24 offset:49152
    ds_read_b64_tr_b16 v[40:41], v32 offset:0
    ds_read_b64_tr_b16 v[42:43], v32 offset:768
    ds_read_b64_tr_b16 v[44:45], v32 offset:56
    v_mfma_f32_32x32x16_bf16 v[84:99], v[60:63], v[52:55], v[84:99]
    ds_read_b64_tr_b16 v[46:47], v32 offset:824
    ds_read_b64_tr_b16 v[48:49], v32 offset:112
    ds_read_b64_tr_b16 v[50:51], v32 offset:880
    v_mfma_f32_32x32x16_bf16 v[100:115], v[52:55], v[64:67], v[100:115]
    s_waitcnt lgkmcnt(0)
    v_mfma_f32_32x32x16_bf16 v[68:83], v[40:43], v[36:39], v[68:83]
    ds_read_b128 v[52:55], v25 offset:49152
    ds_read_b64_tr_b16 v[56:57], v32 offset:3072
    ds_read_b64_tr_b16 v[58:59], v32 offset:3840
    ds_read_b64_tr_b16 v[60:61], v32 offset:3128
    v_mfma_f32_32x32x16_bf16 v[84:99], v[44:47], v[36:39], v[84:99]
    ds_read_b64_tr_b16 v[62:63], v32 offset:3896
    ds_read_b64_tr_b16 v[64:65], v32 offset:3184
    ds_read_b64_tr_b16 v[66:67], v32 offset:3952
    v_mfma_f32_32x32x16_bf16 v[100:115], v[36:39], v[48:51], v[100:115]
    s_waitcnt lgkmcnt(0)
    v_mfma_f32_32x32x16_bf16 v[68:83], v[56:59], v[52:55], v[68:83]
    ds_read_b128 v[36:39], v26 offset:49152
    ds_read_b64_tr_b16 v[40:41], v32 offset:6144
    ds_read_b64_tr_b16 v[42:43], v32 offset:6912
    ds_read_b64_tr_b16 v[44:45], v32 offset:6200
    v_mfma_f32_32x32x16_bf16 v[84:99], v[60:63], v[52:55], v[84:99]
    ds_read_b64_tr_b16 v[46:47], v32 offset:6968
    ds_read_b64_tr_b16 v[48:49], v32 offset:6256
    ds_read_b64_tr_b16 v[50:51], v32 offset:7024
    v_mfma_f32_32x32x16_bf16 v[100:115], v[52:55], v[64:67], v[100:115]
    s_waitcnt lgkmcnt(0)
    v_mfma_f32_32x32x16_bf16 v[68:83], v[40:43], v[36:39], v[68:83]
    ds_read_b128 v[52:55], v27 offset:49152
    ds_read_b64_tr_b16 v[56:57], v32 offset:9216
    ds_read_b64_tr_b16 v[58:59], v32 offset:9984
    ds_read_b64_tr_b16 v[60:61], v32 offset:9272
    v_mfma_f32_32x32x16_bf16 v[84:99], v[44:47], v[36:39], v[84:99]
    ds_read_b64_tr_b16 v[62:63], v32 offset:10040
    ds_read_b64_tr_b16 v[64:65], v32 offset:9328
    ds_read_b64_tr_b16 v[66:67], v32 offset:10096
    v_mfma_f32_32x32x16_bf16 v[100:115], v[36:39], v[48:51], v[100:115]
    s_waitcnt lgkmcnt(0)
    v_mfma_f32_32x32x16_bf16 v[68:83], v[56:59], v[52:55], v[68:83]
    s_barrier
    ds_read_b128 v[36:39], v28 offset:0
    ds_read_b64_tr_b16 v[40:41], v32 offset:12288
    ds_read_b64_tr_b16 v[42:43], v32 offset:13056
    ds_read_b64_tr_b16 v[44:45], v32 offset:12344
    v_mfma_f32_32x32x16_bf16 v[84:99], v[60:63], v[52:55], v[84:99]
    ds_read_b64_tr_b16 v[46:47], v32 offset:13112
    ds_read_b64_tr_b16 v[48:49], v32 offset:12400
    ds_read_b64_tr_b16 v[50:51], v32 offset:13168
    v_mfma_f32_32x32x16_bf16 v[100:115], v[52:55], v[64:67], v[100:115]
    s_waitcnt lgkmcnt(0)
    v_mfma_f32_32x32x16_bf16 v[68:83], v[40:43], v[36:39], v[68:83]
    ds_read_b128 v[52:55], v29 offset:0
    ds_read_b64_tr_b16 v[56:57], v32 offset:15360
    ds_read_b64_tr_b16 v[58:59], v32 offset:16128
    ds_read_b64_tr_b16 v[60:61], v32 offset:15416
    v_mfma_f32_32x32x16_bf16 v[84:99], v[44:47], v[36:39], v[84:99]
    ds_read_b64_tr_b16 v[62:63], v32 offset:16184
    ds_read_b64_tr_b16 v[64:65], v32 offset:15472
    ds_read_b64_tr_b16 v[66:67], v32 offset:16240
    v_mfma_f32_32x32x16_bf16 v[100:115], v[36:39], v[48:51], v[100:115]
    s_waitcnt lgkmcnt(0)
    v_mfma_f32_32x32x16_bf16 v[68:83], v[56:59], v[52:55], v[68:83]
    ds_read_b128 v[36:39], v30 offset:0
    ds_read_b64_tr_b16 v[40:41], v32 offset:18432
    ds_read_b64_tr_b16 v[42:43], v32 offset:19200
    ds_read_b64_tr_b16 v[44:45], v32 offset:18488
    v_mfma_f32_32x32x16_bf16 v[84:99], v[60:63], v[52:55], v[84:99]
    ds_read_b64_tr_b16 v[46:47], v32 offset:19256
    ds_read_b64_tr_b16 v[48:49], v32 offset:18544
    ds_read_b64_tr_b16 v[50:51], v32 offset:19312
    v_mfma_f32_32x32x16_bf16 v[100:115], v[52:55], v[64:67], v[100:115]
    s_waitcnt lgkmcnt(0)
    v_mfma_f32_32x32x16_bf16 v[68:83], v[40:43], v[36:39], v[68:83]
    ds_read_b128 v[52:55], v31 offset:0
    ds_read_b64_tr_b16 v[56:57], v32 offset:21504
    ds_read_b64_tr_b16 v[58:59], v32 offset:22272
    ds_read_b64_tr_b16 v[60:61], v32 offset:21560
    v_mfma_f32_32x32x16_bf16 v[84:99], v[44:47], v[36:39], v[84:99]
    ds_read_b64_tr_b16 v[62:63], v32 offset:22328
    ds_read_b64_tr_b16 v[64:65], v32 offset:21616
    ds_read_b64_tr_b16 v[66:67], v32 offset:22384
    v_mfma_f32_32x32x16_bf16 v[100:115], v[36:39], v[48:51], v[100:115]
    s_waitcnt lgkmcnt(0)
    v_mfma_f32_32x32x16_bf16 v[68:83], v[56:59], v[52:55], v[68:83]
    s_barrier
    ds_read_b128 v[36:39], v28 offset:16384
    ds_read_b64_tr_b16 v[40:41], v32 offset:24576
    ds_read_b64_tr_b16 v[42:43], v32 offset:25344
    ds_read_b64_tr_b16 v[44:45], v32 offset:24632
    v_mfma_f32_32x32x16_bf16 v[84:99], v[60:63], v[52:55], v[84:99]
    ds_read_b64_tr_b16 v[46:47], v32 offset:25400
    ds_read_b64_tr_b16 v[48:49], v32 offset:24688
    ds_read_b64_tr_b16 v[50:51], v32 offset:25456
    v_mfma_f32_32x32x16_bf16 v[100:115], v[52:55], v[64:67], v[100:115]
    s_waitcnt lgkmcnt(0)
    v_mfma_f32_32x32x16_bf16 v[68:83], v[40:43], v[36:39], v[68:83]
    ds_read_b128 v[52:55], v29 offset:16384
    ds_read_b64_tr_b16 v[56:57], v32 offset:27648
    ds_read_b64_tr_b16 v[58:59], v32 offset:28416
    ds_read_b64_tr_b16 v[60:61], v32 offset:27704
    v_mfma_f32_32x32x16_bf16 v[84:99], v[44:47], v[36:39], v[84:99]
    ds_read_b64_tr_b16 v[62:63], v32 offset:28472
    ds_read_b64_tr_b16 v[64:65], v32 offset:27760
    ds_read_b64_tr_b16 v[66:67], v32 offset:28528
    v_mfma_f32_32x32x16_bf16 v[100:115], v[36:39], v[48:51], v[100:115]
    s_waitcnt lgkmcnt(0)
    v_mfma_f32_32x32x16_bf16 v[68:83], v[56:59], v[52:55], v[68:83]
    ds_read_b128 v[36:39], v30 offset:16384
    ds_read_b64_tr_b16 v[40:41], v32 offset:30720
    ds_read_b64_tr_b16 v[42:43], v32 offset:31488
    ds_read_b64_tr_b16 v[44:45], v32 offset:30776
    v_mfma_f32_32x32x16_bf16 v[84:99], v[60:63], v[52:55], v[84:99]
    ds_read_b64_tr_b16 v[46:47], v32 offset:31544
    ds_read_b64_tr_b16 v[48:49], v32 offset:30832
    ds_read_b64_tr_b16 v[50:51], v32 offset:31600
    v_mfma_f32_32x32x16_bf16 v[100:115], v[52:55], v[64:67], v[100:115]
    s_waitcnt lgkmcnt(0)
    v_mfma_f32_32x32x16_bf16 v[68:83], v[40:43], v[36:39], v[68:83]
    ds_read_b128 v[52:55], v31 offset:16384
    ds_read_b64_tr_b16 v[56:57], v32 offset:33792
    ds_read_b64_tr_b16 v[58:59], v32 offset:34560
    ds_read_b64_tr_b16 v[60:61], v32 offset:33848
    v_mfma_f32_32x32x16_bf16 v[84:99], v[44:47], v[36:39], v[84:99]
    ds_read_b64_tr_b16 v[62:63], v32 offset:34616
    ds_read_b64_tr_b16 v[64:65], v32 offset:33904
    ds_read_b64_tr_b16 v[66:67], v32 offset:34672
    v_mfma_f32_32x32x16_bf16 v[100:115], v[36:39], v[48:51], v[100:115]
    s_waitcnt lgkmcnt(0)
    v_mfma_f32_32x32x16_bf16 v[68:83], v[56:59], v[52:55], v[68:83]
    s_barrier
    ds_read_b128 v[36:39], v28 offset:32768
    ds_read_b64_tr_b16 v[40:41], v32 offset:0
    ds_read_b64_tr_b16 v[42:43], v32 offset:768
    ds_read_b64_tr_b16 v[44:45], v32 offset:56
    v_mfma_f32_32x32x16_bf16 v[84:99], v[60:63], v[52:55], v[84:99]
    ds_read_b64_tr_b16 v[46:47], v32 offset:824
    ds_read_b64_tr_b16 v[48:49], v32 offset:112
    ds_read_b64_tr_b16 v[50:51], v32 offset:880
    v_mfma_f32_32x32x16_bf16 v[100:115], v[52:55], v[64:67], v[100:115]
    s_waitcnt lgkmcnt(0)
    v_mfma_f32_32x32x16_bf16 v[68:83], v[40:43], v[36:39], v[68:83]
    ds_read_b128 v[52:55], v29 offset:32768
    ds_read_b64_tr_b16 v[56:57], v32 offset:3072
    ds_read_b64_tr_b16 v[58:59], v32 offset:3840
    ds_read_b64_tr_b16 v[60:61], v32 offset:3128
    v_mfma_f32_32x32x16_bf16 v[84:99], v[44:47], v[36:39], v[84:99]
    ds_read_b64_tr_b16 v[62:63], v32 offset:3896
    ds_read_b64_tr_b16 v[64:65], v32 offset:3184
    ds_read_b64_tr_b16 v[66:67], v32 offset:3952
    v_mfma_f32_32x32x16_bf16 v[100:115], v[36:39], v[48:51], v[100:115]
    s_waitcnt lgkmcnt(0)
    v_mfma_f32_32x32x16_bf16 v[68:83], v[56:59], v[52:55], v[68:83]
    ds_read_b128 v[36:39], v30 offset:32768
    ds_read_b64_tr_b16 v[40:41], v32 offset:6144
    ds_read_b64_tr_b16 v[42:43], v32 offset:6912
    ds_read_b64_tr_b16 v[44:45], v32 offset:6200
    v_mfma_f32_32x32x16_bf16 v[84:99], v[60:63], v[52:55], v[84:99]
    ds_read_b64_tr_b16 v[46:47], v32 offset:6968
    ds_read_b64_tr_b16 v[48:49], v32 offset:6256
    ds_read_b64_tr_b16 v[50:51], v32 offset:7024
    v_mfma_f32_32x32x16_bf16 v[100:115], v[52:55], v[64:67], v[100:115]
    s_waitcnt lgkmcnt(0)
    v_mfma_f32_32x32x16_bf16 v[68:83], v[40:43], v[36:39], v[68:83]
    ds_read_b128 v[52:55], v31 offset:32768
    ds_read_b64_tr_b16 v[56:57], v32 offset:9216
    ds_read_b64_tr_b16 v[58:59], v32 offset:9984
    ds_read_b64_tr_b16 v[60:61], v32 offset:9272
    v_mfma_f32_32x32x16_bf16 v[84:99], v[44:47], v[36:39], v[84:99]
    ds_read_b64_tr_b16 v[62:63], v32 offset:10040
    ds_read_b64_tr_b16 v[64:65], v32 offset:9328
    ds_read_b64_tr_b16 v[66:67], v32 offset:10096
    v_mfma_f32_32x32x16_bf16 v[100:115], v[36:39], v[48:51], v[100:115]
    s_waitcnt lgkmcnt(0)
    v_mfma_f32_32x32x16_bf16 v[68:83], v[56:59], v[52:55], v[68:83]
    v_mfma_f32_32x32x16_bf16 v[84:99], v[60:63], v[52:55], v[84:99]
    v_mfma_f32_32x32x16_bf16 v[100:115], v[52:55], v[64:67], v[100:115]
    s_barrier
    s_nop 10
    v_cvt_pk_bf16_f32 v100, v100, v101
    v_cvt_pk_bf16_f32 v101, v102, v103
    v_cvt_pk_bf16_f32 v102, v104, v105
    v_cvt_pk_bf16_f32 v103, v106, v107
    v_cvt_pk_bf16_f32 v104, v108, v109
    v_cvt_pk_bf16_f32 v105, v110, v111
    v_cvt_pk_bf16_f32 v106, v112, v113
    v_cvt_pk_bf16_f32 v107, v114, v115
    s_mov_b32 exec_lo, 0xf0000000
    s_mov_b32 exec_hi, 0xf0000000
    v_mov_b32 v100, v33
    v_mov_b32 v101, v33
    v_mov_b32 v102, v33
    v_mov_b32 v103, v33
    v_mov_b32 v104, v33
    v_mov_b32 v105, v33
    v_mov_b32 v106, v33
    v_mov_b32 v107, v33
    s_mov_b64 exec, -1
    buffer_store_dwordx4 v[100:103], v2, s[24:27], s46 offen sc1
    buffer_store_dwordx4 v[104:107], v2, s[24:27], s46 offen offset:1024 sc1
    v_cvt_pk_bf16_f32 v84, v84, v85
    v_cvt_pk_bf16_f32 v85, v86, v87
    v_cvt_pk_bf16_f32 v86, v88, v89
    v_cvt_pk_bf16_f32 v87, v90, v91
    v_cvt_pk_bf16_f32 v88, v92, v93
    v_cvt_pk_bf16_f32 v89, v94, v95
    v_cvt_pk_bf16_f32 v90, v96, v97
    v_cvt_pk_bf16_f32 v91, v98, v99
    s_mov_b32 exec_lo, 0
    v_mov_b32 v90, 0x3f803f80
    v_mov_b32 v91, 0x3f80
    s_mov_b64 exec, -1
    buffer_store_dwordx4 v[84:87], v2, s[24:27], s45 offen sc1
    buffer_store_dwordx4 v[88:91], v2, s[24:27], s45 offen offset:1024 sc1
    v_cvt_pk_bf16_f32 v68, v68, v69
    v_cvt_pk_bf16_f32 v69, v70, v71
    v_cvt_pk_bf16_f32 v70, v72, v73
    v_cvt_pk_bf16_f32 v71, v74, v75
    v_cvt_pk_bf16_f32 v72, v76, v77
    v_cvt_pk_bf16_f32 v73, v78, v79
    v_cvt_pk_bf16_f32 v74, v80, v81
    v_cvt_pk_bf16_f32 v75, v82, v83
    s_mov_b32 exec_lo, 0
    v_mov_b32 v74, 0x3f803f80
    v_mov_b32 v75, 0x3f80
    s_mov_b64 exec, -1
    buffer_store_dwordx4 v[68:71], v2, s[24:27], s44 offen sc1
    buffer_store_dwordx4 v[72:75], v2, s[24:27], s44 offen offset:1024 sc1
    s_branch KF_EPI0
KF_V0_vvv:
    s_add_u32 s40, s43, 0
    s_and_b32 s40, s40, 15
    s_lshl_b32 s40, s40, 6
    s_add_u32 s40, s40, s41
    s_lshl_b32 s40, s40, 12
    s_add_u32 s40, s40, s42
    s_add_u32 s44, s40, 2099200
    s_add_u32 s40, s43, 1
    s_and_b32 s40, s40, 15
    s_lshl_b32 s40, s40, 6
    s_add_u32 s40, s40, s41
    s_lshl_b32 s40, s40, 12
    s_add_u32 s40, s40, s42
    s_add_u32 s45, s40, 2099200
    s_add_u32 s40, s43, 2
    s_and_b32 s40, s40, 15
    s_lshl_b32 s40, s40, 6
    s_add_u32 s40, s40, s41
    s_lshl_b32 s40, s40, 12
    s_add_u32 s40, s40, s42
    s_add_u32 s46, s40, 2099200
    s_barrier
    ds_read_b128 v[36:39], v24 offset:0
    ds_read_b64_tr_b16 v[40:41], v32 offset:0
    ds_read_b64_tr_b16 v[42:43], v32 offset:768
    ds_read_b64_tr_b16 v[44:45], v32 offset:56
    ds_read_b64_tr_b16 v[46:47], v32 offset:824
    ds_read_b64_tr_b16 v[48:49], v32 offset:112
    ds_read_b64_tr_b16 v[50:51], v32 offset:880
    s_waitcnt lgkmcnt(0)
    v_mfma_f32_32x32x16_bf16 v[68:83], v[36:39], v[40:43], 0
    ds_read_b128 v[52:55], v25 offset:0
    ds_read_b64_tr_b16 v[56:57], v32 offset:3072
    ds_read_b64_tr_b16 v[58:59], v32 offset:3840
    ds_read_b64_tr_b16 v[60:61], v32 offset:3128
    v_mfma_f32_32x32x16_bf16 v[84:99], v[36:39], v[44:47], 0
    ds_read_b64_tr_b16 v[62:63], v32 offset:3896
    ds_read_b64_tr_b16 v[64:65], v32 offset:3184
    ds_read_b64_tr_b16 v[66:67], v32 offset:3952
    v_mfma_f32_32x32x16_bf16 v[100:115], v[36:39], v[48:51], 0
    s_waitcnt lgkmcnt(0)
    v_mfma_f32_32x32x16_bf16 v[68:83], v[52:55], v[56:59], v[68:83]
    ds_read_b128 v[36:39], v26 offset:0
    ds_read_b64_tr_b16 v[40:41], v32 offset:6144
    ds_read_b64_tr_b16 v[42:43], v32 offset:6912
    ds_read_b64_tr_b16 v[44:45], v32 offset:6200
    v_mfma_f32_32x32x16_bf16 v[84:99], v[52:55], v[60:63], v[84:99]
    ds_read_b64_tr_b16 v[46:47], v32 offset:6968
    ds_read_b64_tr_b16 v[48:49], v32 offset:6256
    ds_read_b64_tr_b16 v[50:51], v32 offset:7024
    v_mfma_f32_32x32x16_bf16 v[100:115], v[52:55], v[64:67], v[100:115]
    s_waitcnt lgkmcnt(0)
    v_mfma_f32_32x32x16_bf16 v[68:83], v[36:39], v[40:43], v[68:83]
    ds_read_b128 v[52:55], v27 offset:0
    ds_read_b64_tr_b16 v[56:57], v32 offset:9216
    ds_read_b64_tr_b16 v[58:59], v32 offset:9984
    ds_read_b64_tr_b16 v[60:61], v32 offset:9272
    v_mfma_f32_32x32x16_bf16 v[84:99], v[36:39], v[44:47], v[84:99]
    ds_read_b64_tr_b16 v[62:63], v32 offset:10040
    ds_read_b64_tr_b16 v[64:65], v32 offset:9328
    ds_read_b64_tr_b16 v[66:67], v32 offset:10096
    v_mfma_f32_32x32x16_bf16 v[100:115], v[36:39], v[48:51], v[100:115]
    s_waitcnt lgkmcnt(0)
    v_mfma_f32_32x32x16_bf16 v[68:83], v[52:55], v[56:59], v[68:83]
    s_barrier
    ds_read_b128 v[36:39], v24 offset:16384
    ds_read_b64_tr_b16 v[40:41], v32 offset:12288
    ds_read_b64_tr_b16 v[42:43], v32 offset:13056
    ds_read_b64_tr_b16 v[44:45], v32 offset:12344
    v_mfma_f32_32x32x16_bf16 v[84:99], v[52:55], v[60:63], v[84:99]
    ds_read_b64_tr_b16 v[46:47], v32 offset:13112
    ds_read_b64_tr_b16 v[48:49], v32 offset:12400
    ds_read_b64_tr_b16 v[50:51], v32 offset:13168
    v_mfma_f32_32x32x16_bf16 v[100:115], v[52:55], v[64:67], v[100:115]
    s_waitcnt lgkmcnt(0)
    v_mfma_f32_32x32x16_bf16 v[68:83], v[36:39], v[40:43], v[68:83]
    ds_read_b128 v[52:55], v25 offset:16384
    ds_read_b64_tr_b16 v[56:57], v32 offset:15360
    ds_read_b64_tr_b16 v[58:59], v32 offset:16128
    ds_read_b64_tr_b16 v[60:61], v32 offset:15416
    v_mfma_f32_32x32x16_bf16 v[84:99], v[36:39], v[44:47], v[84:99]
    ds_read_b64_tr_b16 v[62:63], v32 offset:16184
    ds_read_b64_tr_b16 v[64:65], v32 offset:15472
    ds_read_b64_tr_b16 v[66:67], v32 offset:16240
    v_mfma_f32_32x32x16_bf16 v[100:115], v[36:39], v[48:51], v[100:115]
    s_waitcnt lgkmcnt(0)
    v_mfma_f32_32x32x16_bf16 v[68:83], v[52:55], v[56:59], v[68:83]
    ds_read_b128 v[36:39], v26 offset:16384
    ds_read_b64_tr_b16 v[40:41], v32 offset:18432
    ds_read_b64_tr_b16 v[42:43], v32 offset:19200
    ds_read_b64_tr_b16 v[44:45], v32 offset:18488
    v_mfma_f32_32x32x16_bf16 v[84:99], v[52:55], v[60:63], v[84:99]
    ds_read_b64_tr_b16 v[46:47], v32 offset:19256
    ds_read_b64_tr_b16 v[48:49], v32 offset:18544
    ds_read_b64_tr_b16 v[50:51], v32 offset:19312
    v_mfma_f32_32x32x16_bf16 v[100:115], v[52:55], v[64:67], v[100:115]
    s_waitcnt lgkmcnt(0)
    v_mfma_f32_32x32x16_bf16 v[68:83], v[36:39], v[40:43], v[68:83]
    ds_read_b128 v[52:55], v27 offset:16384
    ds_read_b64_tr_b16 v[56:57], v32 offset:21504
    ds_read_b64_tr_b16 v[58:59], v32 offset:22272
    ds_read_b64_tr_b16 v[60:61], v32 offset:21560
    v_mfma_f32_32x32x16_bf16 v[84:99], v[36:39], v[44:47], v[84:99]
    ds_read_b64_tr_b16 v[62:63], v32 offset:22328
    ds_read_b64_tr_b16 v[64:65], v32 offset:21616
    ds_read_b64_tr_b16 v[66:67], v32 offset:22384
    v_mfma_f32_32x32x16_bf16 v[100:115], v[36:39], v[48:51], v[100:115]
    s_waitcnt lgkmcnt(0)
    v_mfma_f32_32x32x16_bf16 v[68:83], v[52:55], v[56:59], v[68:83]
    s_barrier
    ds_read_b128 v[36:39], v24 offset:32768
    ds_read_b64_tr_b16 v[40:41], v32 offset:24576
    ds_read_b64_tr_b16 v[42:43], v32 offset:25344
    ds_read_b64_tr_b16 v[44:45], v32 offset:24632
    v_mfma_f32_32x32x16_bf16 v[84:99], v[52:55], v[60:63], v[84:99]
    ds_read_b64_tr_b16 v[46:47], v32 offset:25400
    ds_read_b64_tr_b16 v[48:49], v32 offset:24688
    ds_read_b64_tr_b16 v[50:51], v32 offset:25456
    v_mfma_f32_32x32x16_bf16 v[100:115], v[52:55], v[64:67], v[100:115]
    s_waitcnt lgkmcnt(0)
    v_mfma_f32_32x32x16_bf16 v[68:83], v[36:39], v[40:43], v[68:83]
    ds_read_b128 v[52:55], v25 offset:32768
    ds_read_b64_tr_b16 v[56:57], v32 offset:27648
    ds_read_b64_tr_b16 v[58:59], v32 offset:28416
    ds_read_b64_tr_b16 v[60:61], v32 offset:27704
    v_mfma_f32_32x32x16_bf16 v[84:99], v[36:39], v[44:47], v[84:99]
    ds_read_b64_tr_b16 v[62:63], v32 offset:28472
    ds_read_b64_tr_b16 v[64:65], v32 offset:27760
    ds_read_b64_tr_b16 v[66:67], v32 offset:28528
    v_mfma_f32_32x32x16_bf16 v[100:115], v[36:39], v[48:51], v[100:115]
    s_waitcnt lgkmcnt(0)
    v_mfma_f32_32x32x16_bf16 v[68:83], v[52:55], v[56:59], v[68:83]
    ds_read_b128 v[36:39], v26 offset:32768
    ds_read_b64_tr_b16 v[40:41], v32 offset:30720
    ds_read_b64_tr_b16 v[42:43], v32 offset:31488
    ds_read_b64_tr_b16 v[44:45], v32 offset:30776
    v_mfma_f32_32x32x16_bf16 v[84:99], v[52:55], v[60:63], v[84:99]
    ds_read_b64_tr_b16 v[46:47], v32 offset:31544
    ds_read_b64_tr_b16 v[48:49], v32 offset:30832
    ds_read_b64_tr_b16 v[50:51], v32 offset:31600
    v_mfma_f32_32x32x16_bf16 v[100:115], v[52:55], v[64:67], v[100:115]
    s_waitcnt lgkmcnt(0)
    v_mfma_f32_32x32x16_bf16 v[68:83], v[36:39], v[40:43], v[68:83]
    ds_read_b128 v[52:55], v27 offset:32768
    ds_read_b64_tr_b16 v[56:57], v32 offset:33792
    ds_read_b64_tr_b16 v[58:59], v32 offset:34560
    ds_read_b64_tr_b16 v[60:61], v32 offset:33848
    v_mfma_f32_32x32x16_bf16 v[84:99], v[36:39], v[44:47], v[84:99]
    ds_read_b64_tr_b16 v[62:63], v32 offset:34616
    ds_read_b64_tr_b16 v[64:65], v32 offset:33904
    ds_read_b64_tr_b16 v[66:67], v32 offset:34672
    v_mfma_f32_32x32x16_bf16 v[100:115], v[36:39], v[48:51], v[100:115]
    s_waitcnt lgkmcnt(0)
    v_mfma_f32_32x32x16_bf16 v[68:83], v[52:55], v[56:59], v[68:83]
    s_barrier
    ds_read_b128 v[36:39], v24 offset:49152
    ds_read_b64_tr_b16 v[40:41], v32 offset:0
    ds_read_b64_tr_b16 v[42:43], v32 offset:768
    ds_read_b64_tr_b16 v[44:45], v32 offset:56
    v_mfma_f32_32x32x16_bf16 v[84:99], v[52:55], v[60:63], v[84:99]
    ds_read_b64_tr_b16 v[46:47], v32 offset:824
    ds_read_b64_tr_b16 v[48:49], v32 offset:112
    ds_read_b64_tr_b16 v[50:51], v32 offset:880
    v_mfma_f32_32x32x16_bf16 v[100:115], v[52:55], v[64:67], v[100:115]
    s_waitcnt lgkmcnt(0)
    v_mfma_f32_32x32x16_bf16 v[68:83], v[36:39], v[40:43], v[68:83]
    ds_read_b128 v[52:55], v25 offset:49152
    ds_read_b64_tr_b16 v[56:57], v32 offset:3072
    ds_read_b64_tr_b16 v[58:59], v32 offset:3840
    ds_read_b64_tr_b16 v[60:61], v32 offset:3128
    v_mfma_f32_32x32x16_bf16 v[84:99], v[36:39], v[44:47], v[84:99]
    ds_read_b64_tr_b16 v[62:63], v32 offset:3896
    ds_read_b64_tr_b16 v[64:65], v32 offset:3184
    ds_read_b64_tr_b16 v[66:67], v32 offset:3952
    v_mfma_f32_32x32x16_bf16 v[100:115], v[36:39], v[48:51], v[100:115]
    s_waitcnt lgkmcnt(0)
    v_mfma_f32_32x32x16_bf16 v[68:83], v[52:55], v[56:59], v[68:83]
    ds_read_b128 v[36:39], v26 offset:49152
    ds_read_b64_tr_b16 v[40:41], v32 offset:6144
    ds_read_b64_tr_b16 v[42:43], v32 offset:6912
    ds_read_b64_tr_b16 v[44:45], v32 offset:6200
    v_mfma_f32_32x32x16_bf16 v[84:99], v[52:55], v[60:63], v[84:99]
    ds_read_b64_tr_b16 v[46:47], v32 offset:6968
    ds_read_b64_tr_b16 v[48:49], v32 offset:6256
    ds_read_b64_tr_b16 v[50:51], v32 offset:7024
    v_mfma_f32_32x32x16_bf16 v[100:115], v[52:55], v[64:67], v[100:115]
    s_waitcnt lgkmcnt(0)
    v_mfma_f32_32x32x16_bf16 v[68:83], v[36:39], v[40:43], v[68:83]
    ds_read_b128 v[52:55], v27 offset:49152
    ds_read_b64_tr_b16 v[56:57], v32 offset:9216
    ds_read_b64_tr_b16 v[58:59], v32 offset:9984
    ds_read_b64_tr_b16 v[60:61], v32 offset:9272
    v_mfma_f32_32x32x16_bf16 v[84:99], v[36:39], v[44:47], v[84:99]
    ds_read_b64_tr_b16 v[62:63], v32 offset:10040
    ds_read_b64_tr_b16 v[64:65], v32 offset:9328
    ds_read_b64_tr_b16 v[66:67], v32 offset:10096
    v_mfma_f32_32x32x16_bf16 v[100:115], v[36:39], v[48:51], v[100:115]
    s_waitcnt lgkmcnt(0)
    v_mfma_f32_32x32x16_bf16 v[68:83], v[52:55], v[56:59], v[68:83]
    s_barrier
    ds_read_b128 v[36:39], v28 offset:0
    ds_read_b64_tr_b16 v[40:41], v32 offset:12288
    ds_read_b64_tr_b16 v[42:43], v32 offset:13056
    ds_read_b64_tr_b16 v[44:45], v32 offset:12344
    v_mfma_f32_32x32x16_bf16 v[84:99], v[52:55], v[60:63], v[84:99]
    ds_read_b64_tr_b16 v[46:47], v32 offset:13112
    ds_read_b64_tr_b16 v[48:49], v32 offset:12400
    ds_read_b64_tr_b16 v[50:51], v32 offset:13168
    v_mfma_f32_32x32x16_bf16 v[100:115], v[52:55], v[64:67], v[100:115]
    s_waitcnt lgkmcnt(0)
    v_mfma_f32_32x32x16_bf16 v[68:83], v[36:39], v[40:43], v[68:83]
    ds_read_b128 v[52:55], v29 offset:0
    ds_read_b64_tr_b16 v[56:57], v32 offset:15360
    ds_read_b64_tr_b16 v[58:59], v32 offset:16128
    ds_read_b64_tr_b16 v[60:61], v32 offset:15416
    v_mfma_f32_32x32x16_bf16 v[84:99], v[36:39], v[44:47], v[84:99]
    ds_read_b64_tr_b16 v[62:63], v32 offset:16184
    ds_read_b64_tr_b16 v[64:65], v32 offset:15472
    ds_read_b64_tr_b16 v[66:67], v32 offset:16240
    v_mfma_f32_32x32x16_bf16 v[100:115], v[36:39], v[48:51], v[100:115]
    s_waitcnt lgkmcnt(0)
    v_mfma_f32_32x32x16_bf16 v[68:83], v[52:55], v[56:59], v[68:83]
    ds_read_b128 v[36:39], v30 offset:0
    ds_read_b64_tr_b16 v[40:41], v32 offset:18432
    ds_read_b64_tr_b16 v[42:43], v32 offset:19200
    ds_read_b64_tr_b16 v[44:45], v32 offset:18488
    v_mfma_f32_32x32x16_bf16 v[84:99], v[52:55], v[60:63], v[84:99]
    ds_read_b64_tr_b16 v[46:47], v32 offset:19256
    ds_read_b64_tr_b16 v[48:49], v32 offset:18544
    ds_read_b64_tr_b16 v[50:51], v32 offset:19312
    v_mfma_f32_32x32x16_bf16 v[100:115], v[52:55], v[64:67], v[100:115]
    s_waitcnt lgkmcnt(0)
    v_mfma_f32_32x32x16_bf16 v[68:83], v[36:39], v[40:43], v[68:83]
    ds_read_b128 v[52:55], v31 offset:0
    ds_read_b64_tr_b16 v[56:57], v32 offset:21504
    ds_read_b64_tr_b16 v[58:59], v32 offset:22272
    ds_read_b64_tr_b16 v[60:61], v32 offset:21560
    v_mfma_f32_32x32x16_bf16 v[84:99], v[36:39], v[44:47], v[84:99]
    ds_read_b64_tr_b16 v[62:63], v32 offset:22328
    ds_read_b64_tr_b16 v[64:65], v32 offset:21616
    ds_read_b64_tr_b16 v[66:67], v32 offset:22384
    v_mfma_f32_32x32x16_bf16 v[100:115], v[36:39], v[48:51], v[100:115]
    s_waitcnt lgkmcnt(0)
    v_mfma_f32_32x32x16_bf16 v[68:83], v[52:55], v[56:59], v[68:83]
    s_barrier
    ds_read_b128 v[36:39], v28 offset:16384
    ds_read_b64_tr_b16 v[40:41], v32 offset:24576
    ds_read_b64_tr_b16 v[42:43], v32 offset:25344
    ds_read_b64_tr_b16 v[44:45], v32 offset:24632
    v_mfma_f32_32x32x16_bf16 v[84:99], v[52:55], v[60:63], v[84:99]
    ds_read_b64_tr_b16 v[46:47], v32 offset:25400
    ds_read_b64_tr_b16 v[48:49], v32 offset:24688
    ds_read_b64_tr_b16 v[50:51], v32 offset:25456
    v_mfma_f32_32x32x16_bf16 v[100:115], v[52:55], v[64:67], v[100:115]
    s_waitcnt lgkmcnt(0)
    v_mfma_f32_32x32x16_bf16 v[68:83], v[36:39], v[40:43], v[68:83]
    ds_read_b128 v[52:55], v29 offset:16384
    ds_read_b64_tr_b16 v[56:57], v32 offset:27648
    ds_read_b64_tr_b16 v[58:59], v32 offset:28416
    ds_read_b64_tr_b16 v[60:61], v32 offset:27704
    v_mfma_f32_32x32x16_bf16 v[84:99], v[36:39], v[44:47], v[84:99]
    ds_read_b64_tr_b16 v[62:63], v32 offset:28472
    ds_read_b64_tr_b16 v[64:65], v32 offset:27760
    ds_read_b64_tr_b16 v[66:67], v32 offset:28528
    v_mfma_f32_32x32x16_bf16 v[100:115], v[36:39], v[48:51], v[100:115]
    s_waitcnt lgkmcnt(0)
    v_mfma_f32_32x32x16_bf16 v[68:83], v[52:55], v[56:59], v[68:83]
    ds_read_b128 v[36:39], v30 offset:16384
    ds_read_b64_tr_b16 v[40:41], v32 offset:30720
    ds_read_b64_tr_b16 v[42:43], v32 offset:31488
    ds_read_b64_tr_b16 v[44:45], v32 offset:30776
    v_mfma_f32_32x32x16_bf16 v[84:99], v[52:55], v[60:63], v[84:99]
    ds_read_b64_tr_b16 v[46:47], v32 offset:31544
    ds_read_b64_tr_b16 v[48:49], v32 offset:30832
    ds_read_b64_tr_b16 v[50:51], v32 offset:31600
    v_mfma_f32_32x32x16_bf16 v[100:115], v[52:55], v[64:67], v[100:115]
    s_waitcnt lgkmcnt(0)
    v_mfma_f32_32x32x16_bf16 v[68:83], v[36:39], v[40:43], v[68:83]
    ds_read_b128 v[52:55], v31 offset:16384
    ds_read_b64_tr_b16 v[56:57], v32 offset:33792
    ds_read_b64_tr_b16 v[58:59], v32 offset:34560
    ds_read_b64_tr_b16 v[60:61], v32 offset:33848
    v_mfma_f32_32x32x16_bf16 v[84:99], v[36:39], v[44:47], v[84:99]
    ds_read_b64_tr_b16 v[62:63], v32 offset:34616
    ds_read_b64_tr_b16 v[64:65], v32 offset:33904
    ds_read_b64_tr_b16 v[66:67], v32 offset:34672
    v_mfma_f32_32x32x16_bf16 v[100:115], v[36:39], v[48:51], v[100:115]
    s_waitcnt lgkmcnt(0)
    v_mfma_f32_32x32x16_bf16 v[68:83], v[52:55], v[56:59], v[68:83]
    s_barrier
    ds_read_b128 v[36:39], v28 offset:32768
    ds_read_b64_tr_b16 v[40:41], v32 offset:0
    ds_read_b64_tr_b16 v[42:43], v32 offset:768
    ds_read_b64_tr_b16 v[44:45], v32 offset:56
    v_mfma_f32_32x32x16_bf16 v[84:99], v[52:55], v[60:63], v[84:99]
    ds_read_b64_tr_b16 v[46:47], v32 offset:824
    ds_read_b64_tr_b16 v[48:49], v32 offset:112
    ds_read_b64_tr_b16 v[50:51], v32 offset:880
    v_mfma_f32_32x32x16_bf16 v[100:115], v[52:55], v[64:67], v[100:115]
    s_waitcnt lgkmcnt(0)
    v_mfma_f32_32x32x16_bf16 v[68:83], v[36:39], v[40:43], v[68:83]
    ds_read_b128 v[52:55], v29 offset:32768
    ds_read_b64_tr_b16 v[56:57], v32 offset:3072
    ds_read_b64_tr_b16 v[58:59], v32 offset:3840
    ds_read_b64_tr_b16 v[60:61], v32 offset:3128
    v_mfma_f32_32x32x16_bf16 v[84:99], v[36:39], v[44:47], v[84:99]
    ds_read_b64_tr_b16 v[62:63], v32 offset:3896
    ds_read_b64_tr_b16 v[64:65], v32 offset:3184
    ds_read_b64_tr_b16 v[66:67], v32 offset:3952
    v_mfma_f32_32x32x16_bf16 v[100:115], v[36:39], v[48:51], v[100:115]
    s_waitcnt lgkmcnt(0)
    v_mfma_f32_32x32x16_bf16 v[68:83], v[52:55], v[56:59], v[68:83]
    ds_read_b128 v[36:39], v30 offset:32768
    ds_read_b64_tr_b16 v[40:41], v32 offset:6144
    ds_read_b64_tr_b16 v[42:43], v32 offset:6912
    ds_read_b64_tr_b16 v[44:45], v32 offset:6200
    v_mfma_f32_32x32x16_bf16 v[84:99], v[52:55], v[60:63], v[84:99]
    ds_read_b64_tr_b16 v[46:47], v32 offset:6968
    ds_read_b64_tr_b16 v[48:49], v32 offset:6256
    ds_read_b64_tr_b16 v[50:51], v32 offset:7024
    v_mfma_f32_32x32x16_bf16 v[100:115], v[52:55], v[64:67], v[100:115]
    s_waitcnt lgkmcnt(0)
    v_mfma_f32_32x32x16_bf16 v[68:83], v[36:39], v[40:43], v[68:83]
    ds_read_b128 v[52:55], v31 offset:32768
    ds_read_b64_tr_b16 v[56:57], v32 offset:9216
    ds_read_b64_tr_b16 v[58:59], v32 offset:9984
    ds_read_b64_tr_b16 v[60:61], v32 offset:9272
    v_mfma_f32_32x32x16_bf16 v[84:99], v[36:39], v[44:47], v[84:99]
    ds_read_b64_tr_b16 v[62:63], v32 offset:10040
    ds_read_b64_tr_b16 v[64:65], v32 offset:9328
    ds_read_b64_tr_b16 v[66:67], v32 offset:10096
    v_mfma_f32_32x32x16_bf16 v[100:115], v[36:39], v[48:51], v[100:115]
    s_waitcnt lgkmcnt(0)
    v_mfma_f32_32x32x16_bf16 v[68:83], v[52:55], v[56:59], v[68:83]
    v_mfma_f32_32x32x16_bf16 v[84:99], v[52:55], v[60:63], v[84:99]
    v_mfma_f32_32x32x16_bf16 v[100:115], v[52:55], v[64:67], v[100:115]
    s_barrier
    s_nop 10
    v_cvt_pk_bf16_f32 v100, v100, v101
    v_cvt_pk_bf16_f32 v101, v102, v103
    v_cvt_pk_bf16_f32 v102, v104, v105
    v_cvt_pk_bf16_f32 v103, v106, v107
    v_cvt_pk_bf16_f32 v104, v108, v109
    v_cvt_pk_bf16_f32 v105, v110, v111
    v_cvt_pk_bf16_f32 v106, v112, v113
    v_cvt_pk_bf16_f32 v107, v114, v115
    s_mov_b32 exec_lo, 0xf0000000
    s_mov_b32 exec_hi, 0xf0000000
    v_mov_b32 v100, v33
    v_mov_b32 v101, v33
    v_mov_b32 v102, v33
    v_mov_b32 v103, v33
    v_mov_b32 v104, v33
    v_mov_b32 v105, v33
    v_mov_b32 v106, v33
    v_mov_b32 v107, v33
    s_mov_b64 exec, -1
    buffer_store_dwordx4 v[100:103], v2, s[24:27], s46 offen sc1
    buffer_store_dwordx4 v[104:107], v2, s[24:27], s46 offen offset:1024 sc1
    v_cvt_pk_bf16_f32 v84, v84, v85
    v_cvt_pk_bf16_f32 v85, v86, v87
    v_cvt_pk_bf16_f32 v86, v88, v89
    v_cvt_pk_bf16_f32 v87, v90, v91
    v_cvt_pk_bf16_f32 v88, v92, v93
    v_cvt_pk_bf16_f32 v89, v94, v95
    v_cvt_pk_bf16_f32 v90, v96, v97
    v_cvt_pk_bf16_f32 v91, v98, v99
    s_mov_b32 exec_lo, 0xf0000000
    s_mov_b32 exec_hi, 0xf0000000
    v_mov_b32 v84, v33
    v_mov_b32 v85, v33
    v_mov_b32 v86, v33
    v_mov_b32 v87, v33
    v_mov_b32 v88, v33
    v_mov_b32 v89, v33
    v_mov_b32 v90, v33
    v_mov_b32 v91, v33
    s_mov_b64 exec, -1
    buffer_store_dwordx4 v[84:87], v2, s[24:27], s45 offen sc1
    buffer_store_dwordx4 v[88:91], v2, s[24:27], s45 offen offset:1024 sc1
    v_cvt_pk_bf16_f32 v68, v68, v69
    v_cvt_pk_bf16_f32 v69, v70, v71
    v_cvt_pk_bf16_f32 v70, v72, v73
    v_cvt_pk_bf16_f32 v71, v74, v75
    v_cvt_pk_bf16_f32 v72, v76, v77
    v_cvt_pk_bf16_f32 v73, v78, v79
    v_cvt_pk_bf16_f32 v74, v80, v81
    v_cvt_pk_bf16_f32 v75, v82, v83
    s_mov_b32 exec_lo, 0xf0000000
    s_mov_b32 exec_hi, 0xf0000000
    v_mov_b32 v68, v33
    v_mov_b32 v69, v33
    v_mov_b32 v70, v33
    v_mov_b32 v71, v33
    v_mov_b32 v72, v33
    v_mov_b32 v73, v33
    v_mov_b32 v74, v33
    v_mov_b32 v75, v33
    s_mov_b64 exec, -1
    buffer_store_dwordx4 v[68:71], v2, s[24:27], s44 offen sc1
    buffer_store_dwordx4 v[72:75], v2, s[24:27], s44 offen offset:1024 sc1
    s_branch KF_EPI0
KF_EPI0:
    s_barrier
    s_waitcnt vmcnt(0)
    s_barrier
    s_barrier
    s_barrier
    s_barrier
    s_barrier
    s_branch KF_FIRST
KF_PASSB:
    s_barrier
    s_barrier
    s_barrier
    s_barrier
    s_barrier
    s_barrier
    s_barrier
    s_cmp_le_u32 s33, 4
    s_cbranch_scc1 KF_V1_qqq
    s_cmp_le_u32 s33, 5
    s_cbranch_scc1 KF_V1_qkk
    s_cmp_le_u32 s33, 9
    s_cbranch_scc1 KF_V1_kkk
    s_cmp_le_u32 s33, 10
    s_cbranch_scc1 KF_V1_kkv
    s_branch KF_V1_vvv
KF_V1_qqq:
    s_add_u32 s40, s43, 0
    s_and_b32 s40, s40, 15
    s_lshl_b32 s40, s40, 6
    s_add_u32 s40, s40, s41
    s_lshl_b32 s40, s40, 11
    s_add_u32 s44, s40, s42
    s_add_u32 s40, s43, 1
    s_and_b32 s40, s40, 15
    s_lshl_b32 s40, s40, 6
    s_add_u32 s40, s40, s41
    s_lshl_b32 s40, s40, 11
    s_add_u32 s45, s40, s42
    s_add_u32 s40, s43, 2
    s_and_b32 s40, s40, 15
    s_lshl_b32 s40, s40, 6
    s_add_u32 s40, s40, s41
    s_lshl_b32 s40, s40, 11
    s_add_u32 s46, s40, s42
    s_barrier
    ds_read_b128 v[36:39], v24 offset:0
    ds_read_b64_tr_b16 v[40:41], v32 offset:12288
    ds_read_b64_tr_b16 v[42:43], v32 offset:13056
    ds_read_b64_tr_b16 v[44:45], v32 offset:12344
    ds_read_b64_tr_b16 v[46:47], v32 offset:13112
    ds_read_b64_tr_b16 v[48:49], v32 offset:12400
    ds_read_b64_tr_b16 v[50:51], v32 offset:13168
    s_waitcnt lgkmcnt(0)
    v_mfma_f32_32x32x16_bf16 v[68:83], v[40:43], v[36:39], 0
    ds_read_b128 v[52:55], v25 offset:0
    ds_read_b64_tr_b16 v[56:57], v32 offset:15360
    ds_read_b64_tr_b16 v[58:59], v32 offset:16128
    ds_read_b64_tr_b16 v[60:61], v32 offset:15416
    v_mfma_f32_32x32x16_bf16 v[84:99], v[44:47], v[36:39], 0
    ds_read_b64_tr_b16 v[62:63], v32 offset:16184
    ds_read_b64_tr_b16 v[64:65], v32 offset:15472
    ds_read_b64_tr_b16 v[66:67], v32 offset:16240
    v_mfma_f32_32x32x16_bf16 v[100:115], v[48:51], v[36:39], 0
    s_waitcnt lgkmcnt(0)
    v_mfma_f32_32x32x16_bf16 v[68:83], v[56:59], v[52:55], v[68:83]
    ds_read_b128 v[36:39], v26 offset:0
    ds_read_b64_tr_b16 v[40:41], v32 offset:18432
    ds_read_b64_tr_b16 v[42:43], v32 offset:19200
    ds_read_b64_tr_b16 v[44:45], v32 offset:18488
    v_mfma_f32_32x32x16_bf16 v[84:99], v[60:63], v[52:55], v[84:99]
    ds_read_b64_tr_b16 v[46:47], v32 offset:19256
    ds_read_b64_tr_b16 v[48:49], v32 offset:18544
    ds_read_b64_tr_b16 v[50:51], v32 offset:19312
    v_mfma_f32_32x32x16_bf16 v[100:115], v[64:67], v[52:55], v[100:115]
    s_waitcnt lgkmcnt(0)
    v_mfma_f32_32x32x16_bf16 v[68:83], v[40:43], v[36:39], v[68:83]
    ds_read_b128 v[52:55], v27 offset:0
    ds_read_b64_tr_b16 v[56:57], v32 offset:21504
    ds_read_b64_tr_b16 v[58:59], v32 offset:22272
    ds_read_b64_tr_b16 v[60:61], v32 offset:21560
    v_mfma_f32_32x32x16_bf16 v[84:99], v[44:47], v[36:39], v[84:99]
    ds_read_b64_tr_b16 v[62:63], v32 offset:22328
    ds_read_b64_tr_b16 v[64:65], v32 offset:21616
    ds_read_b64_tr_b16 v[66:67], v32 offset:22384
    v_mfma_f32_32x32x16_bf16 v[100:115], v[48:51], v[36:39], v[100:115]
    s_waitcnt lgkmcnt(0)
    v_mfma_f32_32x32x16_bf16 v[68:83], v[56:59], v[52:55], v[68:83]
    s_barrier
    ds_read_b128 v[36:39], v24 offset:16384
    ds_read_b64_tr_b16 v[40:41], v32 offset:24576
    ds_read_b64_tr_b16 v[42:43], v32 offset:25344
    ds_read_b64_tr_b16 v[44:45], v32 offset:24632
    v_mfma_f32_32x32x16_bf16 v[84:99], v[60:63], v[52:55], v[84:99]
    ds_read_b64_tr_b16 v[46:47], v32 offset:25400
    ds_read_b64_tr_b16 v[48:49], v32 offset:24688
    ds_read_b64_tr_b16 v[50:51], v32 offset:25456
    v_mfma_f32_32x32x16_bf16 v[100:115], v[64:67], v[52:55], v[100:115]
    s_waitcnt lgkmcnt(0)
    v_mfma_f32_32x32x16_bf16 v[68:83], v[40:43], v[36:39], v[68:83]
    ds_read_b128 v[52:55], v25 offset:16384
    ds_read_b64_tr_b16 v[56:57], v32 offset:27648
    ds_read_b64_tr_b16 v[58:59], v32 offset:28416
    ds_read_b64_tr_b16 v[60:61], v32 offset:27704
    v_mfma_f32_32x32x16_bf16 v[84:99], v[44:47], v[36:39], v[84:99]
    ds_read_b64_tr_b16 v[62:63], v32 offset:28472
    ds_read_b64_tr_b16 v[64:65], v32 offset:27760
    ds_read_b64_tr_b16 v[66:67], v32 offset:28528
    v_mfma_f32_32x32x16_bf16 v[100:115], v[48:51], v[36:39], v[100:115]
    s_waitcnt lgkmcnt(0)
    v_mfma_f32_32x32x16_bf16 v[68:83], v[56:59], v[52:55], v[68:83]
    ds_read_b128 v[36:39], v26 offset:16384
    ds_read_b64_tr_b16 v[40:41], v32 offset:30720
    ds_read_b64_tr_b16 v[42:43], v32 offset:31488
    ds_read_b64_tr_b16 v[44:45], v32 offset:30776
    v_mfma_f32_32x32x16_bf16 v[84:99], v[60:63], v[52:55], v[84:99]
    ds_read_b64_tr_b16 v[46:47], v32 offset:31544
    ds_read_b64_tr_b16 v[48:49], v32 offset:30832
    ds_read_b64_tr_b16 v[50:51], v32 offset:31600
    v_mfma_f32_32x32x16_bf16 v[100:115], v[64:67], v[52:55], v[100:115]
    s_waitcnt lgkmcnt(0)
    v_mfma_f32_32x32x16_bf16 v[68:83], v[40:43], v[36:39], v[68:83]
    ds_read_b128 v[52:55], v27 offset:16384
    ds_read_b64_tr_b16 v[56:57], v32 offset:33792
    ds_read_b64_tr_b16 v[58:59], v32 offset:34560
    ds_read_b64_tr_b16 v[60:61], v32 offset:33848
    v_mfma_f32_32x32x16_bf16 v[84:99], v[44:47], v[36:39], v[84:99]
    ds_read_b64_tr_b16 v[62:63], v32 offset:34616
    ds_read_b64_tr_b16 v[64:65], v32 offset:33904
    ds_read_b64_tr_b16 v[66:67], v32 offset:34672
    v_mfma_f32_32x32x16_bf16 v[100:115], v[48:51], v[36:39], v[100:115]
    s_waitcnt lgkmcnt(0)
    v_mfma_f32_32x32x16_bf16 v[68:83], v[56:59], v[52:55], v[68:83]
    s_barrier
    ds_read_b128 v[36:39], v24 offset:32768
    ds_read_b64_tr_b16 v[40:41], v32 offset:0
    ds_read_b64_tr_b16 v[42:43], v32 offset:768
    ds_read_b64_tr_b16 v[44:45], v32 offset:56
    v_mfma_f32_32x32x16_bf16 v[84:99], v[60:63], v[52:55], v[84:99]
    ds_read_b64_tr_b16 v[46:47], v32 offset:824
    ds_read_b64_tr_b16 v[48:49], v32 offset:112
    ds_read_b64_tr_b16 v[50:51], v32 offset:880
    v_mfma_f32_32x32x16_bf16 v[100:115], v[64:67], v[52:55], v[100:115]
    s_waitcnt lgkmcnt(0)
    v_mfma_f32_32x32x16_bf16 v[68:83], v[40:43], v[36:39], v[68:83]
    ds_read_b128 v[52:55], v25 offset:32768
    ds_read_b64_tr_b16 v[56:57], v32 offset:3072
    ds_read_b64_tr_b16 v[58:59], v32 offset:3840
    ds_read_b64_tr_b16 v[60:61], v32 offset:3128
    v_mfma_f32_32x32x16_bf16 v[84:99], v[44:47], v[36:39], v[84:99]
    ds_read_b64_tr_b16 v[62:63], v32 offset:3896
    ds_read_b64_tr_b16 v[64:65], v32 offset:3184
    ds_read_b64_tr_b16 v[66:67], v32 offset:3952
    v_mfma_f32_32x32x16_bf16 v[100:115], v[48:51], v[36:39], v[100:115]
    s_waitcnt lgkmcnt(0)
    v_mfma_f32_32x32x16_bf16 v[68:83], v[56:59], v[52:55], v[68:83]
    ds_read_b128 v[36:39], v26 offset:32768
    ds_read_b64_tr_b16 v[40:41], v32 offset:6144
    ds_read_b64_tr_b16 v[42:43], v32 offset:6912
    ds_read_b64_tr_b16 v[44:45], v32 offset:6200
    v_mfma_f32_32x32x16_bf16 v[84:99], v[60:63], v[52:55], v[84:99]
    ds_read_b64_tr_b16 v[46:47], v32 offset:6968
    ds_read_b64_tr_b16 v[48:49], v32 offset:6256
    ds_read_b64_tr_b16 v[50:51], v32 offset:7024
    v_mfma_f32_32x32x16_bf16 v[100:115], v[64:67], v[52:55], v[100:115]
    s_waitcnt lgkmcnt(0)
    v_mfma_f32_32x32x16_bf16 v[68:83], v[40:43], v[36:39], v[68:83]
    ds_read_b128 v[52:55], v27 offset:32768
    ds_read_b64_tr_b16 v[56:57], v32 offset:9216
    ds_read_b64_tr_b16 v[58:59], v32 offset:9984
    ds_read_b64_tr_b16 v[60:61], v32 offset:9272
    v_mfma_f32_32x32x16_bf16 v[84:99], v[44:47], v[36:39], v[84:99]
    ds_read_b64_tr_b16 v[62:63], v32 offset:10040
    ds_read_b64_tr_b16 v[64:65], v32 offset:9328
    ds_read_b64_tr_b16 v[66:67], v32 offset:10096
    v_mfma_f32_32x32x16_bf16 v[100:115], v[48:51], v[36:39], v[100:115]
    s_waitcnt lgkmcnt(0)
    v_mfma_f32_32x32x16_bf16 v[68:83], v[56:59], v[52:55], v[68:83]
    s_barrier
    ds_read_b128 v[36:39], v24 offset:49152
    ds_read_b64_tr_b16 v[40:41], v32 offset:12288
    ds_read_b64_tr_b16 v[42:43], v32 offset:13056
    ds_read_b64_tr_b16 v[44:45], v32 offset:12344
    v_mfma_f32_32x32x16_bf16 v[84:99], v[60:63], v[52:55], v[84:99]
    ds_read_b64_tr_b16 v[46:47], v32 offset:13112
    ds_read_b64_tr_b16 v[48:49], v32 offset:12400
    ds_read_b64_tr_b16 v[50:51], v32 offset:13168
    v_mfma_f32_32x32x16_bf16 v[100:115], v[64:67], v[52:55], v[100:115]
    s_waitcnt lgkmcnt(0)
    v_mfma_f32_32x32x16_bf16 v[68:83], v[40:43], v[36:39], v[68:83]
    ds_read_b128 v[52:55], v25 offset:49152
    ds_read_b64_tr_b16 v[56:57], v32 offset:15360
    ds_read_b64_tr_b16 v[58:59], v32 offset:16128
    ds_read_b64_tr_b16 v[60:61], v32 offset:15416
    v_mfma_f32_32x32x16_bf16 v[84:99], v[44:47], v[36:39], v[84:99]
    ds_read_b64_tr_b16 v[62:63], v32 offset:16184
    ds_read_b64_tr_b16 v[64:65], v32 offset:15472
    ds_read_b64_tr_b16 v[66:67], v32 offset:16240
    v_mfma_f32_32x32x16_bf16 v[100:115], v[48:51], v[36:39], v[100:115]
    s_waitcnt lgkmcnt(0)
    v_mfma_f32_32x32x16_bf16 v[68:83], v[56:59], v[52:55], v[68:83]
    ds_read_b128 v[36:39], v26 offset:49152
    ds_read_b64_tr_b16 v[40:41], v32 offset:18432
    ds_read_b64_tr_b16 v[42:43], v32 offset:19200
    ds_read_b64_tr_b16 v[44:45], v32 offset:18488
    v_mfma_f32_32x32x16_bf16 v[84:99], v[60:63], v[52:55], v[84:99]
    ds_read_b64_tr_b16 v[46:47], v32 offset:19256
    ds_read_b64_tr_b16 v[48:49], v32 offset:18544
    ds_read_b64_tr_b16 v[50:51], v32 offset:19312
    v_mfma_f32_32x32x16_bf16 v[100:115], v[64:67], v[52:55], v[100:115]
    s_waitcnt lgkmcnt(0)
    v_mfma_f32_32x32x16_bf16 v[68:83], v[40:43], v[36:39], v[68:83]
    ds_read_b128 v[52:55], v27 offset:49152
    ds_read_b64_tr_b16 v[56:57], v32 offset:21504
    ds_read_b64_tr_b16 v[58:59], v32 offset:22272
    ds_read_b64_tr_b16 v[60:61], v32 offset:21560
    v_mfma_f32_32x32x16_bf16 v[84:99], v[44:47], v[36:39], v[84:99]
    ds_read_b64_tr_b16 v[62:63], v32 offset:22328
    ds_read_b64_tr_b16 v[64:65], v32 offset:21616
    ds_read_b64_tr_b16 v[66:67], v32 offset:22384
    v_mfma_f32_32x32x16_bf16 v[100:115], v[48:51], v[36:39], v[100:115]
    s_waitcnt lgkmcnt(0)
    v_mfma_f32_32x32x16_bf16 v[68:83], v[56:59], v[52:55], v[68:83]
    s_barrier
    ds_read_b128 v[36:39], v28 offset:0
    ds_read_b64_tr_b16 v[40:41], v32 offset:24576
    ds_read_b64_tr_b16 v[42:43], v32 offset:25344
    ds_read_b64_tr_b16 v[44:45], v32 offset:24632
    v_mfma_f32_32x32x16_bf16 v[84:99], v[60:63], v[52:55], v[84:99]
    ds_read_b64_tr_b16 v[46:47], v32 offset:25400
    ds_read_b64_tr_b16 v[48:49], v32 offset:24688
    ds_read_b64_tr_b16 v[50:51], v32 offset:25456
    v_mfma_f32_32x32x16_bf16 v[100:115], v[64:67], v[52:55], v[100:115]
    s_waitcnt lgkmcnt(0)
    v_mfma_f32_32x32x16_bf16 v[68:83], v[40:43], v[36:39], v[68:83]
    ds_read_b128 v[52:55], v29 offset:0
    ds_read_b64_tr_b16 v[56:57], v32 offset:27648
    ds_read_b64_tr_b16 v[58:59], v32 offset:28416
    ds_read_b64_tr_b16 v[60:61], v32 offset:27704
    v_mfma_f32_32x32x16_bf16 v[84:99], v[44:47], v[36:39], v[84:99]
    ds_read_b64_tr_b16 v[62:63], v32 offset:28472
    ds_read_b64_tr_b16 v[64:65], v32 offset:27760
    ds_read_b64_tr_b16 v[66:67], v32 offset:28528
    v_mfma_f32_32x32x16_bf16 v[100:115], v[48:51], v[36:39], v[100:115]
    s_waitcnt lgkmcnt(0)
    v_mfma_f32_32x32x16_bf16 v[68:83], v[56:59], v[52:55], v[68:83]
    ds_read_b128 v[36:39], v30 offset:0
    ds_read_b64_tr_b16 v[40:41], v32 offset:30720
    ds_read_b64_tr_b16 v[42:43], v32 offset:31488
    ds_read_b64_tr_b16 v[44:45], v32 offset:30776
    v_mfma_f32_32x32x16_bf16 v[84:99], v[60:63], v[52:55], v[84:99]
    ds_read_b64_tr_b16 v[46:47], v32 offset:31544
    ds_read_b64_tr_b16 v[48:49], v32 offset:30832
    ds_read_b64_tr_b16 v[50:51], v32 offset:31600
    v_mfma_f32_32x32x16_bf16 v[100:115], v[64:67], v[52:55], v[100:115]
    s_waitcnt lgkmcnt(0)
    v_mfma_f32_32x32x16_bf16 v[68:83], v[40:43], v[36:39], v[68:83]
    ds_read_b128 v[52:55], v31 offset:0
    ds_read_b64_tr_b16 v[56:57], v32 offset:33792
    ds_read_b64_tr_b16 v[58:59], v32 offset:34560
    ds_read_b64_tr_b16 v[60:61], v32 offset:33848
    v_mfma_f32_32x32x16_bf16 v[84:99], v[44:47], v[36:39], v[84:99]
    ds_read_b64_tr_b16 v[62:63], v32 offset:34616
    ds_read_b64_tr_b16 v[64:65], v32 offset:33904
    ds_read_b64_tr_b16 v[66:67], v32 offset:34672
    v_mfma_f32_32x32x16_bf16 v[100:115], v[48:51], v[36:39], v[100:115]
    s_waitcnt lgkmcnt(0)
    v_mfma_f32_32x32x16_bf16 v[68:83], v[56:59], v[52:55], v[68:83]
    s_barrier
    ds_read_b128 v[36:39], v28 offset:16384
    ds_read_b64_tr_b16 v[40:41], v32 offset:0
    ds_read_b64_tr_b16 v[42:43], v32 offset:768
    ds_read_b64_tr_b16 v[44:45], v32 offset:56
    v_mfma_f32_32x32x16_bf16 v[84:99], v[60:63], v[52:55], v[84:99]
    ds_read_b64_tr_b16 v[46:47], v32 offset:824
    ds_read_b64_tr_b16 v[48:49], v32 offset:112
    ds_read_b64_tr_b16 v[50:51], v32 offset:880
    v_mfma_f32_32x32x16_bf16 v[100:115], v[64:67], v[52:55], v[100:115]
    s_waitcnt lgkmcnt(0)
    v_mfma_f32_32x32x16_bf16 v[68:83], v[40:43], v[36:39], v[68:83]
    ds_read_b128 v[52:55], v29 offset:16384
    ds_read_b64_tr_b16 v[56:57], v32 offset:3072
    ds_read_b64_tr_b16 v[58:59], v32 offset:3840
    ds_read_b64_tr_b16 v[60:61], v32 offset:3128
    v_mfma_f32_32x32x16_bf16 v[84:99], v[44:47], v[36:39], v[84:99]
    ds_read_b64_tr_b16 v[62:63], v32 offset:3896
    ds_read_b64_tr_b16 v[64:65], v32 offset:3184
    ds_read_b64_tr_b16 v[66:67], v32 offset:3952
    v_mfma_f32_32x32x16_bf16 v[100:115], v[48:51], v[36:39], v[100:115]
    s_waitcnt lgkmcnt(0)
    v_mfma_f32_32x32x16_bf16 v[68:83], v[56:59], v[52:55], v[68:83]
    ds_read_b128 v[36:39], v30 offset:16384
    ds_read_b64_tr_b16 v[40:41], v32 offset:6144
    ds_read_b64_tr_b16 v[42:43], v32 offset:6912
    ds_read_b64_tr_b16 v[44:45], v32 offset:6200
    v_mfma_f32_32x32x16_bf16 v[84:99], v[60:63], v[52:55], v[84:99]
    ds_read_b64_tr_b16 v[46:47], v32 offset:6968
    ds_read_b64_tr_b16 v[48:49], v32 offset:6256
    ds_read_b64_tr_b16 v[50:51], v32 offset:7024
    v_mfma_f32_32x32x16_bf16 v[100:115], v[64:67], v[52:55], v[100:115]
    s_waitcnt lgkmcnt(0)
    v_mfma_f32_32x32x16_bf16 v[68:83], v[40:43], v[36:39], v[68:83]
    ds_read_b128 v[52:55], v31 offset:16384
    ds_read_b64_tr_b16 v[56:57], v32 offset:9216
    ds_read_b64_tr_b16 v[58:59], v32 offset:9984
    ds_read_b64_tr_b16 v[60:61], v32 offset:9272
    v_mfma_f32_32x32x16_bf16 v[84:99], v[44:47], v[36:39], v[84:99]
    ds_read_b64_tr_b16 v[62:63], v32 offset:10040
    ds_read_b64_tr_b16 v[64:65], v32 offset:9328
    ds_read_b64_tr_b16 v[66:67], v32 offset:10096
    v_mfma_f32_32x32x16_bf16 v[100:115], v[48:51], v[36:39], v[100:115]
    s_waitcnt lgkmcnt(0)
    v_mfma_f32_32x32x16_bf16 v[68:83], v[56:59], v[52:55], v[68:83]
    s_barrier
    ds_read_b128 v[36:39], v28 offset:32768
    ds_read_b64_tr_b16 v[40:41], v32 offset:12288
    ds_read_b64_tr_b16 v[42:43], v32 offset:13056
    ds_read_b64_tr_b16 v[44:45], v32 offset:12344
    v_mfma_f32_32x32x16_bf16 v[84:99], v[60:63], v[52:55], v[84:99]
    ds_read_b64_tr_b16 v[46:47], v32 offset:13112
    ds_read_b64_tr_b16 v[48:49], v32 offset:12400
    ds_read_b64_tr_b16 v[50:51], v32 offset:13168
    v_mfma_f32_32x32x16_bf16 v[100:115], v[64:67], v[52:55], v[100:115]
    s_waitcnt lgkmcnt(0)
    v_mfma_f32_32x32x16_bf16 v[68:83], v[40:43], v[36:39], v[68:83]
    ds_read_b128 v[52:55], v29 offset:32768
    ds_read_b64_tr_b16 v[56:57], v32 offset:15360
    ds_read_b64_tr_b16 v[58:59], v32 offset:16128
    ds_read_b64_tr_b16 v[60:61], v32 offset:15416
    v_mfma_f32_32x32x16_bf16 v[84:99], v[44:47], v[36:39], v[84:99]
    ds_read_b64_tr_b16 v[62:63], v32 offset:16184
    ds_read_b64_tr_b16 v[64:65], v32 offset:15472
    ds_read_b64_tr_b16 v[66:67], v32 offset:16240
    v_mfma_f32_32x32x16_bf16 v[100:115], v[48:51], v[36:39], v[100:115]
    s_waitcnt lgkmcnt(0)
    v_mfma_f32_32x32x16_bf16 v[68:83], v[56:59], v[52:55], v[68:83]
    ds_read_b128 v[36:39], v30 offset:32768
    ds_read_b64_tr_b16 v[40:41], v32 offset:18432
    ds_read_b64_tr_b16 v[42:43], v32 offset:19200
    ds_read_b64_tr_b16 v[44:45], v32 offset:18488
    v_mfma_f32_32x32x16_bf16 v[84:99], v[60:63], v[52:55], v[84:99]
    ds_read_b64_tr_b16 v[46:47], v32 offset:19256
    ds_read_b64_tr_b16 v[48:49], v32 offset:18544
    ds_read_b64_tr_b16 v[50:51], v32 offset:19312
    v_mfma_f32_32x32x16_bf16 v[100:115], v[64:67], v[52:55], v[100:115]
    s_waitcnt lgkmcnt(0)
    v_mfma_f32_32x32x16_bf16 v[68:83], v[40:43], v[36:39], v[68:83]
    ds_read_b128 v[52:55], v31 offset:32768
    ds_read_b64_tr_b16 v[56:57], v32 offset:21504
    ds_read_b64_tr_b16 v[58:59], v32 offset:22272
    ds_read_b64_tr_b16 v[60:61], v32 offset:21560
    v_mfma_f32_32x32x16_bf16 v[84:99], v[44:47], v[36:39], v[84:99]
    ds_read_b64_tr_b16 v[62:63], v32 offset:22328
    ds_read_b64_tr_b16 v[64:65], v32 offset:21616
    ds_read_b64_tr_b16 v[66:67], v32 offset:22384
    v_mfma_f32_32x32x16_bf16 v[100:115], v[48:51], v[36:39], v[100:115]
    s_waitcnt lgkmcnt(0)
    v_mfma_f32_32x32x16_bf16 v[68:83], v[56:59], v[52:55], v[68:83]
    v_mfma_f32_32x32x16_bf16 v[84:99], v[60:63], v[52:55], v[84:99]
    v_mfma_f32_32x32x16_bf16 v[100:115], v[64:67], v[52:55], v[100:115]
    s_barrier
    s_barrier
    s_nop 9
    v_mul_f32 v100, s48, v100
    v_mul_f32 v101, s48, v101
    v_mul_f32 v102, s48, v102
    v_mul_f32 v103, s48, v103
    v_mul_f32 v104, s48, v104
    v_mul_f32 v105, s48, v105
    v_mul_f32 v106, s48, v106
    v_mul_f32 v107, s48, v107
    v_mul_f32 v108, s48, v108
    v_mul_f32 v109, s48, v109
    v_mul_f32 v110, s48, v110
    v_mul_f32 v111, s48, v111
    v_mul_f32 v112, s48, v112
    v_mul_f32 v113, s48, v113
    v_mul_f32 v114, s48, v114
    v_mul_f32 v115, s48, v115
    v_cvt_pk_bf16_f32 v100, v100, v101
    v_cvt_pk_bf16_f32 v101, v102, v103
    v_cvt_pk_bf16_f32 v102, v104, v105
    v_cvt_pk_bf16_f32 v103, v106, v107
    v_cvt_pk_bf16_f32 v104, v108, v109
    v_cvt_pk_bf16_f32 v105, v110, v111
    v_cvt_pk_bf16_f32 v106, v112, v113
    v_cvt_pk_bf16_f32 v107, v114, v115
    s_mov_b32 exec_lo, 0
    v_mov_b32 v106, 0
    v_mov_b32 v107, 0
    s_mov_b64 exec, -1
    buffer_store_dwordx4 v[100:103], v2, s[24:27], s46 offen sc1
    buffer_store_dwordx4 v[104:107], v2, s[24:27], s46 offen offset:1024 sc1
    v_mul_f32 v84, s48, v84
    v_mul_f32 v85, s48, v85
    v_mul_f32 v86, s48, v86
    v_mul_f32 v87, s48, v87
    v_mul_f32 v88, s48, v88
    v_mul_f32 v89, s48, v89
    v_mul_f32 v90, s48, v90
    v_mul_f32 v91, s48, v91
    v_mul_f32 v92, s48, v92
    v_mul_f32 v93, s48, v93
    v_mul_f32 v94, s48, v94
    v_mul_f32 v95, s48, v95
    v_mul_f32 v96, s48, v96
    v_mul_f32 v97, s48, v97
    v_mul_f32 v98, s48, v98
    v_mul_f32 v99, s48, v99
    v_cvt_pk_bf16_f32 v84, v84, v85
    v_cvt_pk_bf16_f32 v85, v86, v87
    v_cvt_pk_bf16_f32 v86, v88, v89
    v_cvt_pk_bf16_f32 v87, v90, v91
    v_cvt_pk_bf16_f32 v88, v92, v93
    v_cvt_pk_bf16_f32 v89, v94, v95
    v_cvt_pk_bf16_f32 v90, v96, v97
    v_cvt_pk_bf16_f32 v91, v98, v99
    s_mov_b32 exec_lo, 0
    v_mov_b32 v90, 0
    v_mov_b32 v91, 0
    s_mov_b64 exec, -1
    buffer_store_dwordx4 v[84:87], v2, s[24:27], s45 offen sc1
    buffer_store_dwordx4 v[88:91], v2, s[24:27], s45 offen offset:1024 sc1
    v_mul_f32 v68, s48, v68
    v_mul_f32 v69, s48, v69
    v_mul_f32 v70, s48, v70
    v_mul_f32 v71, s48, v71
    v_mul_f32 v72, s48, v72
    v_mul_f32 v73, s48, v73
    v_mul_f32 v74, s48, v74
    v_mul_f32 v75, s48, v75
    v_mul_f32 v76, s48, v76
    v_mul_f32 v77, s48, v77
    v_mul_f32 v78, s48, v78
    v_mul_f32 v79, s48, v79
    v_mul_f32 v80, s48, v80
    v_mul_f32 v81, s48, v81
    v_mul_f32 v82, s48, v82
    v_mul_f32 v83, s48, v83
    v_cvt_pk_bf16_f32 v68, v68, v69
    v_cvt_pk_bf16_f32 v69, v70, v71
    v_cvt_pk_bf16_f32 v70, v72, v73
    v_cvt_pk_bf16_f32 v71, v74, v75
    v_cvt_pk_bf16_f32 v72, v76, v77
    v_cvt_pk_bf16_f32 v73, v78, v79
    v_cvt_pk_bf16_f32 v74, v80, v81
    v_cvt_pk_bf16_f32 v75, v82, v83
    s_mov_b32 exec_lo, 0
    v_mov_b32 v74, 0
    v_mov_b32 v75, 0
    s_mov_b64 exec, -1
    buffer_store_dwordx4 v[68:71], v2, s[24:27], s44 offen sc1
    buffer_store_dwordx4 v[72:75], v2, s[24:27], s44 offen offset:1024 sc1
    s_branch KF_EPI1
KF_V1_qkk:
    s_add_u32 s40, s43, 0
    s_and_b32 s40, s40, 15
    s_lshl_b32 s40, s40, 6
    s_add_u32 s40, s40, s41
    s_lshl_b32 s40, s40, 11
    s_add_u32 s44, s40, s42
    s_add_u32 s40, s43, 1
    s_and_b32 s40, s40, 15
    s_lshl_b32 s40, s40, 6
    s_add_u32 s40, s40, s41
    s_lshl_b32 s40, s40, 12
    s_add_u32 s40, s40, s42
    s_add_u32 s45, s40, 2097152
    s_add_u32 s40, s43, 2
    s_and_b32 s40, s40, 15
    s_lshl_b32 s40, s40, 6
    s_add_u32 s40, s40, s41
    s_lshl_b32 s40, s40, 12
    s_add_u32 s40, s40, s42
    s_add_u32 s46, s40, 2097152
    s_barrier
    ds_read_b128 v[36:39], v24 offset:0
    ds_read_b64_tr_b16 v[40:41], v32 offset:12288
    ds_read_b64_tr_b16 v[42:43], v32 offset:13056
    ds_read_b64_tr_b16 v[44:45], v32 offset:12344
    ds_read_b64_tr_b16 v[46:47], v32 offset:13112
    ds_read_b64_tr_b16 v[48:49], v32 offset:12400
    ds_read_b64_tr_b16 v[50:51], v32 offset:13168
    s_waitcnt lgkmcnt(0)
    v_mfma_f32_32x32x16_bf16 v[68:83], v[40:43], v[36:39], 0
    ds_read_b128 v[52:55], v25 offset:0
    ds_read_b64_tr_b16 v[56:57], v32 offset:15360
    ds_read_b64_tr_b16 v[58:59], v32 offset:16128
    ds_read_b64_tr_b16 v[60:61], v32 offset:15416
    v_mfma_f32_32x32x16_bf16 v[84:99], v[44:47], v[36:39], 0
    ds_read_b64_tr_b16 v[62:63], v32 offset:16184
    ds_read_b64_tr_b16 v[64:65], v32 offset:15472
    ds_read_b64_tr_b16 v[66:67], v32 offset:16240
    v_mfma_f32_32x32x16_bf16 v[100:115], v[48:51], v[36:39], 0
    s_waitcnt lgkmcnt(0)
    v_mfma_f32_32x32x16_bf16 v[68:83], v[56:59], v[52:55], v[68:83]
    ds_read_b128 v[36:39], v26 offset:0
    ds_read_b64_tr_b16 v[40:41], v32 offset:18432
    ds_read_b64_tr_b16 v[42:43], v32 offset:19200
    ds_read_b64_tr_b16 v[44:45], v32 offset:18488
    v_mfma_f32_32x32x16_bf16 v[84:99], v[60:63], v[52:55], v[84:99]
    ds_read_b64_tr_b16 v[46:47], v32 offset:19256
    ds_read_b64_tr_b16 v[48:49], v32 offset:18544
    ds_read_b64_tr_b16 v[50:51], v32 offset:19312
    v_mfma_f32_32x32x16_bf16 v[100:115], v[64:67], v[52:55], v[100:115]
    s_waitcnt lgkmcnt(0)
    v_mfma_f32_32x32x16_bf16 v[68:83], v[40:43], v[36:39], v[68:83]
    ds_read_b128 v[52:55], v27 offset:0
    ds_read_b64_tr_b16 v[56:57], v32 offset:21504
    ds_read_b64_tr_b16 v[58:59], v32 offset:22272
    ds_read_b64_tr_b16 v[60:61], v32 offset:21560
    v_mfma_f32_32x32x16_bf16 v[84:99], v[44:47], v[36:39], v[84:99]
    ds_read_b64_tr_b16 v[62:63], v32 offset:22328
    ds_read_b64_tr_b16 v[64:65], v32 offset:21616
    ds_read_b64_tr_b16 v[66:67], v32 offset:22384
    v_mfma_f32_32x32x16_bf16 v[100:115], v[48:51], v[36:39], v[100:115]
    s_waitcnt lgkmcnt(0)
    v_mfma_f32_32x32x16_bf16 v[68:83], v[56:59], v[52:55], v[68:83]
    s_barrier
    ds_read_b128 v[36:39], v24 offset:16384
    ds_read_b64_tr_b16 v[40:41], v32 offset:24576
    ds_read_b64_tr_b16 v[42:43], v32 offset:25344
    ds_read_b64_tr_b16 v[44:45], v32 offset:24632
    v_mfma_f32_32x32x16_bf16 v[84:99], v[60:63], v[52:55], v[84:99]
    ds_read_b64_tr_b16 v[46:47], v32 offset:25400
    ds_read_b64_tr_b16 v[48:49], v32 offset:24688
    ds_read_b64_tr_b16 v[50:51], v32 offset:25456
    v_mfma_f32_32x32x16_bf16 v[100:115], v[64:67], v[52:55], v[100:115]
    s_waitcnt lgkmcnt(0)
    v_mfma_f32_32x32x16_bf16 v[68:83], v[40:43], v[36:39], v[68:83]
    ds_read_b128 v[52:55], v25 offset:16384
    ds_read_b64_tr_b16 v[56:57], v32 offset:27648
    ds_read_b64_tr_b16 v[58:59], v32 offset:28416
    ds_read_b64_tr_b16 v[60:61], v32 offset:27704
    v_mfma_f32_32x32x16_bf16 v[84:99], v[44:47], v[36:39], v[84:99]
    ds_read_b64_tr_b16 v[62:63], v32 offset:28472
    ds_read_b64_tr_b16 v[64:65], v32 offset:27760
    ds_read_b64_tr_b16 v[66:67], v32 offset:28528
    v_mfma_f32_32x32x16_bf16 v[100:115], v[48:51], v[36:39], v[100:115]
    s_waitcnt lgkmcnt(0)
    v_mfma_f32_32x32x16_bf16 v[68:83], v[56:59], v[52:55], v[68:83]
    ds_read_b128 v[36:39], v26 offset:16384
    ds_read_b64_tr_b16 v[40:41], v32 offset:30720
    ds_read_b64_tr_b16 v[42:43], v32 offset:31488
    ds_read_b64_tr_b16 v[44:45], v32 offset:30776
    v_mfma_f32_32x32x16_bf16 v[84:99], v[60:63], v[52:55], v[84:99]
    ds_read_b64_tr_b16 v[46:47], v32 offset:31544
    ds_read_b64_tr_b16 v[48:49], v32 offset:30832
    ds_read_b64_tr_b16 v[50:51], v32 offset:31600
    v_mfma_f32_32x32x16_bf16 v[100:115], v[64:67], v[52:55], v[100:115]
    s_waitcnt lgkmcnt(0)
    v_mfma_f32_32x32x16_bf16 v[68:83], v[40:43], v[36:39], v[68:83]
    ds_read_b128 v[52:55], v27 offset:16384
    ds_read_b64_tr_b16 v[56:57], v32 offset:33792
    ds_read_b64_tr_b16 v[58:59], v32 offset:34560
    ds_read_b64_tr_b16 v[60:61], v32 offset:33848
    v_mfma_f32_32x32x16_bf16 v[84:99], v[44:47], v[36:39], v[84:99]
    ds_read_b64_tr_b16 v[62:63], v32 offset:34616
    ds_read_b64_tr_b16 v[64:65], v32 offset:33904
    ds_read_b64_tr_b16 v[66:67], v32 offset:34672
    v_mfma_f32_32x32x16_bf16 v[100:115], v[48:51], v[36:39], v[100:115]
    s_waitcnt lgkmcnt(0)
    v_mfma_f32_32x32x16_bf16 v[68:83], v[56:59], v[52:55], v[68:83]
    s_barrier
    ds_read_b128 v[36:39], v24 offset:32768
    ds_read_b64_tr_b16 v[40:41], v32 offset:0
    ds_read_b64_tr_b16 v[42:43], v32 offset:768
    ds_read_b64_tr_b16 v[44:45], v32 offset:56
    v_mfma_f32_32x32x16_bf16 v[84:99], v[60:63], v[52:55], v[84:99]
    ds_read_b64_tr_b16 v[46:47], v32 offset:824
    ds_read_b64_tr_b16 v[48:49], v32 offset:112
    ds_read_b64_tr_b16 v[50:51], v32 offset:880
    v_mfma_f32_32x32x16_bf16 v[100:115], v[64:67], v[52:55], v[100:115]
    s_waitcnt lgkmcnt(0)
    v_mfma_f32_32x32x16_bf16 v[68:83], v[40:43], v[36:39], v[68:83]
    ds_read_b128 v[52:55], v25 offset:32768
    ds_read_b64_tr_b16 v[56:57], v32 offset:3072
    ds_read_b64_tr_b16 v[58:59], v32 offset:3840
    ds_read_b64_tr_b16 v[60:61], v32 offset:3128
    v_mfma_f32_32x32x16_bf16 v[84:99], v[44:47], v[36:39], v[84:99]
    ds_read_b64_tr_b16 v[62:63], v32 offset:3896
    ds_read_b64_tr_b16 v[64:65], v32 offset:3184
    ds_read_b64_tr_b16 v[66:67], v32 offset:3952
    v_mfma_f32_32x32x16_bf16 v[100:115], v[48:51], v[36:39], v[100:115]
    s_waitcnt lgkmcnt(0)
    v_mfma_f32_32x32x16_bf16 v[68:83], v[56:59], v[52:55], v[68:83]
    ds_read_b128 v[36:39], v26 offset:32768
    ds_read_b64_tr_b16 v[40:41], v32 offset:6144
    ds_read_b64_tr_b16 v[42:43], v32 offset:6912
    ds_read_b64_tr_b16 v[44:45], v32 offset:6200
    v_mfma_f32_32x32x16_bf16 v[84:99], v[60:63], v[52:55], v[84:99]
    ds_read_b64_tr_b16 v[46:47], v32 offset:6968
    ds_read_b64_tr_b16 v[48:49], v32 offset:6256
    ds_read_b64_tr_b16 v[50:51], v32 offset:7024
    v_mfma_f32_32x32x16_bf16 v[100:115], v[64:67], v[52:55], v[100:115]
    s_waitcnt lgkmcnt(0)
    v_mfma_f32_32x32x16_bf16 v[68:83], v[40:43], v[36:39], v[68:83]
    ds_read_b128 v[52:55], v27 offset:32768
    ds_read_b64_tr_b16 v[56:57], v32 offset:9216
    ds_read_b64_tr_b16 v[58:59], v32 offset:9984
    ds_read_b64_tr_b16 v[60:61], v32 offset:9272
    v_mfma_f32_32x32x16_bf16 v[84:99], v[44:47], v[36:39], v[84:99]
    ds_read_b64_tr_b16 v[62:63], v32 offset:10040
    ds_read_b64_tr_b16 v[64:65], v32 offset:9328
    ds_read_b64_tr_b16 v[66:67], v32 offset:10096
    v_mfma_f32_32x32x16_bf16 v[100:115], v[48:51], v[36:39], v[100:115]
    s_waitcnt lgkmcnt(0)
    v_mfma_f32_32x32x16_bf16 v[68:83], v[56:59], v[52:55], v[68:83]
    s_barrier
    ds_read_b128 v[36:39], v24 offset:49152
    ds_read_b64_tr_b16 v[40:41], v32 offset:12288
    ds_read_b64_tr_b16 v[42:43], v32 offset:13056
    ds_read_b64_tr_b16 v[44:45], v32 offset:12344
    v_mfma_f32_32x32x16_bf16 v[84:99], v[60:63], v[52:55], v[84:99]
    ds_read_b64_tr_b16 v[46:47], v32 offset:13112
    ds_read_b64_tr_b16 v[48:49], v32 offset:12400
    ds_read_b64_tr_b16 v[50:51], v32 offset:13168
    v_mfma_f32_32x32x16_bf16 v[100:115], v[64:67], v[52:55], v[100:115]
    s_waitcnt lgkmcnt(0)
    v_mfma_f32_32x32x16_bf16 v[68:83], v[40:43], v[36:39], v[68:83]
    ds_read_b128 v[52:55], v25 offset:49152
    ds_read_b64_tr_b16 v[56:57], v32 offset:15360
    ds_read_b64_tr_b16 v[58:59], v32 offset:16128
    ds_read_b64_tr_b16 v[60:61], v32 offset:15416
    v_mfma_f32_32x32x16_bf16 v[84:99], v[44:47], v[36:39], v[84:99]
    ds_read_b64_tr_b16 v[62:63], v32 offset:16184
    ds_read_b64_tr_b16 v[64:65], v32 offset:15472
    ds_read_b64_tr_b16 v[66:67], v32 offset:16240
    v_mfma_f32_32x32x16_bf16 v[100:115], v[48:51], v[36:39], v[100:115]
    s_waitcnt lgkmcnt(0)
    v_mfma_f32_32x32x16_bf16 v[68:83], v[56:59], v[52:55], v[68:83]
    ds_read_b128 v[36:39], v26 offset:49152
    ds_read_b64_tr_b16 v[40:41], v32 offset:18432
    ds_read_b64_tr_b16 v[42:43], v32 offset:19200
    ds_read_b64_tr_b16 v[44:45], v32 offset:18488
    v_mfma_f32_32x32x16_bf16 v[84:99], v[60:63], v[52:55], v[84:99]
    ds_read_b64_tr_b16 v[46:47], v32 offset:19256
    ds_read_b64_tr_b16 v[48:49], v32 offset:18544
    ds_read_b64_tr_b16 v[50:51], v32 offset:19312
    v_mfma_f32_32x32x16_bf16 v[100:115], v[64:67], v[52:55], v[100:115]
    s_waitcnt lgkmcnt(0)
    v_mfma_f32_32x32x16_bf16 v[68:83], v[40:43], v[36:39], v[68:83]
    ds_read_b128 v[52:55], v27 offset:49152
    ds_read_b64_tr_b16 v[56:57], v32 offset:21504
    ds_read_b64_tr_b16 v[58:59], v32 offset:22272
    ds_read_b64_tr_b16 v[60:61], v32 offset:21560
    v_mfma_f32_32x32x16_bf16 v[84:99], v[44:47], v[36:39], v[84:99]
    ds_read_b64_tr_b16 v[62:63], v32 offset:22328
    ds_read_b64_tr_b16 v[64:65], v32 offset:21616
    ds_read_b64_tr_b16 v[66:67], v32 offset:22384
    v_mfma_f32_32x32x16_bf16 v[100:115], v[48:51], v[36:39], v[100:115]
    s_waitcnt lgkmcnt(0)
    v_mfma_f32_32x32x16_bf16 v[68:83], v[56:59], v[52:55], v[68:83]
    s_barrier
    ds_read_b128 v[36:39], v28 offset:0
    ds_read_b64_tr_b16 v[40:41], v32 offset:24576
    ds_read_b64_tr_b16 v[42:43], v32 offset:25344
    ds_read_b64_tr_b16 v[44:45], v32 offset:24632
    v_mfma_f32_32x32x16_bf16 v[84:99], v[60:63], v[52:55], v[84:99]
    ds_read_b64_tr_b16 v[46:47], v32 offset:25400
    ds_read_b64_tr_b16 v[48:49], v32 offset:24688
    ds_read_b64_tr_b16 v[50:51], v32 offset:25456
    v_mfma_f32_32x32x16_bf16 v[100:115], v[64:67], v[52:55], v[100:115]
    s_waitcnt lgkmcnt(0)
    v_mfma_f32_32x32x16_bf16 v[68:83], v[40:43], v[36:39], v[68:83]
    ds_read_b128 v[52:55], v29 offset:0
    ds_read_b64_tr_b16 v[56:57], v32 offset:27648
    ds_read_b64_tr_b16 v[58:59], v32 offset:28416
    ds_read_b64_tr_b16 v[60:61], v32 offset:27704
    v_mfma_f32_32x32x16_bf16 v[84:99], v[44:47], v[36:39], v[84:99]
    ds_read_b64_tr_b16 v[62:63], v32 offset:28472
    ds_read_b64_tr_b16 v[64:65], v32 offset:27760
    ds_read_b64_tr_b16 v[66:67], v32 offset:28528
    v_mfma_f32_32x32x16_bf16 v[100:115], v[48:51], v[36:39], v[100:115]
    s_waitcnt lgkmcnt(0)
    v_mfma_f32_32x32x16_bf16 v[68:83], v[56:59], v[52:55], v[68:83]
    ds_read_b128 v[36:39], v30 offset:0
    ds_read_b64_tr_b16 v[40:41], v32 offset:30720
    ds_read_b64_tr_b16 v[42:43], v32 offset:31488
    ds_read_b64_tr_b16 v[44:45], v32 offset:30776
    v_mfma_f32_32x32x16_bf16 v[84:99], v[60:63], v[52:55], v[84:99]
    ds_read_b64_tr_b16 v[46:47], v32 offset:31544
    ds_read_b64_tr_b16 v[48:49], v32 offset:30832
    ds_read_b64_tr_b16 v[50:51], v32 offset:31600
    v_mfma_f32_32x32x16_bf16 v[100:115], v[64:67], v[52:55], v[100:115]
    s_waitcnt lgkmcnt(0)
    v_mfma_f32_32x32x16_bf16 v[68:83], v[40:43], v[36:39], v[68:83]
    ds_read_b128 v[52:55], v31 offset:0
    ds_read_b64_tr_b16 v[56:57], v32 offset:33792
    ds_read_b64_tr_b16 v[58:59], v32 offset:34560
    ds_read_b64_tr_b16 v[60:61], v32 offset:33848
    v_mfma_f32_32x32x16_bf16 v[84:99], v[44:47], v[36:39], v[84:99]
    ds_read_b64_tr_b16 v[62:63], v32 offset:34616
    ds_read_b64_tr_b16 v[64:65], v32 offset:33904
    ds_read_b64_tr_b16 v[66:67], v32 offset:34672
    v_mfma_f32_32x32x16_bf16 v[100:115], v[48:51], v[36:39], v[100:115]
    s_waitcnt lgkmcnt(0)
    v_mfma_f32_32x32x16_bf16 v[68:83], v[56:59], v[52:55], v[68:83]
    s_barrier
    ds_read_b128 v[36:39], v28 offset:16384
    ds_read_b64_tr_b16 v[40:41], v32 offset:0
    ds_read_b64_tr_b16 v[42:43], v32 offset:768
    ds_read_b64_tr_b16 v[44:45], v32 offset:56
    v_mfma_f32_32x32x16_bf16 v[84:99], v[60:63], v[52:55], v[84:99]
    ds_read_b64_tr_b16 v[46:47], v32 offset:824
    ds_read_b64_tr_b16 v[48:49], v32 offset:112
    ds_read_b64_tr_b16 v[50:51], v32 offset:880
    v_mfma_f32_32x32x16_bf16 v[100:115], v[64:67], v[52:55], v[100:115]
    s_waitcnt lgkmcnt(0)
    v_mfma_f32_32x32x16_bf16 v[68:83], v[40:43], v[36:39], v[68:83]
    ds_read_b128 v[52:55], v29 offset:16384
    ds_read_b64_tr_b16 v[56:57], v32 offset:3072
    ds_read_b64_tr_b16 v[58:59], v32 offset:3840
    ds_read_b64_tr_b16 v[60:61], v32 offset:3128
    v_mfma_f32_32x32x16_bf16 v[84:99], v[44:47], v[36:39], v[84:99]
    ds_read_b64_tr_b16 v[62:63], v32 offset:3896
    ds_read_b64_tr_b16 v[64:65], v32 offset:3184
    ds_read_b64_tr_b16 v[66:67], v32 offset:3952
    v_mfma_f32_32x32x16_bf16 v[100:115], v[48:51], v[36:39], v[100:115]
    s_waitcnt lgkmcnt(0)
    v_mfma_f32_32x32x16_bf16 v[68:83], v[56:59], v[52:55], v[68:83]
    ds_read_b128 v[36:39], v30 offset:16384
    ds_read_b64_tr_b16 v[40:41], v32 offset:6144
    ds_read_b64_tr_b16 v[42:43], v32 offset:6912
    ds_read_b64_tr_b16 v[44:45], v32 offset:6200
    v_mfma_f32_32x32x16_bf16 v[84:99], v[60:63], v[52:55], v[84:99]
    ds_read_b64_tr_b16 v[46:47], v32 offset:6968
    ds_read_b64_tr_b16 v[48:49], v32 offset:6256
    ds_read_b64_tr_b16 v[50:51], v32 offset:7024
    v_mfma_f32_32x32x16_bf16 v[100:115], v[64:67], v[52:55], v[100:115]
    s_waitcnt lgkmcnt(0)
    v_mfma_f32_32x32x16_bf16 v[68:83], v[40:43], v[36:39], v[68:83]
    ds_read_b128 v[52:55], v31 offset:16384
    ds_read_b64_tr_b16 v[56:57], v32 offset:9216
    ds_read_b64_tr_b16 v[58:59], v32 offset:9984
    ds_read_b64_tr_b16 v[60:61], v32 offset:9272
    v_mfma_f32_32x32x16_bf16 v[84:99], v[44:47], v[36:39], v[84:99]
    ds_read_b64_tr_b16 v[62:63], v32 offset:10040
    ds_read_b64_tr_b16 v[64:65], v32 offset:9328
    ds_read_b64_tr_b16 v[66:67], v32 offset:10096
    v_mfma_f32_32x32x16_bf16 v[100:115], v[48:51], v[36:39], v[100:115]
    s_waitcnt lgkmcnt(0)
    v_mfma_f32_32x32x16_bf16 v[68:83], v[56:59], v[52:55], v[68:83]
    s_barrier
    ds_read_b128 v[36:39], v28 offset:32768
    ds_read_b64_tr_b16 v[40:41], v32 offset:12288
    ds_read_b64_tr_b16 v[42:43], v32 offset:13056
    ds_read_b64_tr_b16 v[44:45], v32 offset:12344
    v_mfma_f32_32x32x16_bf16 v[84:99], v[60:63], v[52:55], v[84:99]
    ds_read_b64_tr_b16 v[46:47], v32 offset:13112
    ds_read_b64_tr_b16 v[48:49], v32 offset:12400
    ds_read_b64_tr_b16 v[50:51], v32 offset:13168
    v_mfma_f32_32x32x16_bf16 v[100:115], v[64:67], v[52:55], v[100:115]
    s_waitcnt lgkmcnt(0)
    v_mfma_f32_32x32x16_bf16 v[68:83], v[40:43], v[36:39], v[68:83]
    ds_read_b128 v[52:55], v29 offset:32768
    ds_read_b64_tr_b16 v[56:57], v32 offset:15360
    ds_read_b64_tr_b16 v[58:59], v32 offset:16128
    ds_read_b64_tr_b16 v[60:61], v32 offset:15416
    v_mfma_f32_32x32x16_bf16 v[84:99], v[44:47], v[36:39], v[84:99]
    ds_read_b64_tr_b16 v[62:63], v32 offset:16184
    ds_read_b64_tr_b16 v[64:65], v32 offset:15472
    ds_read_b64_tr_b16 v[66:67], v32 offset:16240
    v_mfma_f32_32x32x16_bf16 v[100:115], v[48:51], v[36:39], v[100:115]
    s_waitcnt lgkmcnt(0)
    v_mfma_f32_32x32x16_bf16 v[68:83], v[56:59], v[52:55], v[68:83]
    ds_read_b128 v[36:39], v30 offset:32768
    ds_read_b64_tr_b16 v[40:41], v32 offset:18432
    ds_read_b64_tr_b16 v[42:43], v32 offset:19200
    ds_read_b64_tr_b16 v[44:45], v32 offset:18488
    v_mfma_f32_32x32x16_bf16 v[84:99], v[60:63], v[52:55], v[84:99]
    ds_read_b64_tr_b16 v[46:47], v32 offset:19256
    ds_read_b64_tr_b16 v[48:49], v32 offset:18544
    ds_read_b64_tr_b16 v[50:51], v32 offset:19312
    v_mfma_f32_32x32x16_bf16 v[100:115], v[64:67], v[52:55], v[100:115]
    s_waitcnt lgkmcnt(0)
    v_mfma_f32_32x32x16_bf16 v[68:83], v[40:43], v[36:39], v[68:83]
    ds_read_b128 v[52:55], v31 offset:32768
    ds_read_b64_tr_b16 v[56:57], v32 offset:21504
    ds_read_b64_tr_b16 v[58:59], v32 offset:22272
    ds_read_b64_tr_b16 v[60:61], v32 offset:21560
    v_mfma_f32_32x32x16_bf16 v[84:99], v[44:47], v[36:39], v[84:99]
    ds_read_b64_tr_b16 v[62:63], v32 offset:22328
    ds_read_b64_tr_b16 v[64:65], v32 offset:21616
    ds_read_b64_tr_b16 v[66:67], v32 offset:22384
    v_mfma_f32_32x32x16_bf16 v[100:115], v[48:51], v[36:39], v[100:115]
    s_waitcnt lgkmcnt(0)
    v_mfma_f32_32x32x16_bf16 v[68:83], v[56:59], v[52:55], v[68:83]
    v_mfma_f32_32x32x16_bf16 v[84:99], v[60:63], v[52:55], v[84:99]
    v_mfma_f32_32x32x16_bf16 v[100:115], v[64:67], v[52:55], v[100:115]
    s_barrier
    s_barrier
    s_nop 9
    v_cvt_pk_bf16_f32 v100, v100, v101
    v_cvt_pk_bf16_f32 v101, v102, v103
    v_cvt_pk_bf16_f32 v102, v104, v105
    v_cvt_pk_bf16_f32 v103, v106, v107
    v_cvt_pk_bf16_f32 v104, v108, v109
    v_cvt_pk_bf16_f32 v105, v110, v111
    v_cvt_pk_bf16_f32 v106, v112, v113
    v_cvt_pk_bf16_f32 v107, v114, v115
    s_mov_b32 exec_lo, 0
    v_mov_b32 v106, 0x3f803f80
    v_mov_b32 v107, 0x3f80
    s_mov_b64 exec, -1
    buffer_store_dwordx4 v[100:103], v2, s[24:27], s46 offen sc1
    buffer_store_dwordx4 v[104:107], v2, s[24:27], s46 offen offset:1024 sc1
    v_cvt_pk_bf16_f32 v84, v84, v85
    v_cvt_pk_bf16_f32 v85, v86, v87
    v_cvt_pk_bf16_f32 v86, v88, v89
    v_cvt_pk_bf16_f32 v87, v90, v91
    v_cvt_pk_bf16_f32 v88, v92, v93
    v_cvt_pk_bf16_f32 v89, v94, v95
    v_cvt_pk_bf16_f32 v90, v96, v97
    v_cvt_pk_bf16_f32 v91, v98, v99
    s_mov_b32 exec_lo, 0
    v_mov_b32 v90, 0x3f803f80
    v_mov_b32 v91, 0x3f80
    s_mov_b64 exec, -1
    buffer_store_dwordx4 v[84:87], v2, s[24:27], s45 offen sc1
    buffer_store_dwordx4 v[88:91], v2, s[24:27], s45 offen offset:1024 sc1
    v_mul_f32 v68, s48, v68
    v_mul_f32 v69, s48, v69
    v_mul_f32 v70, s48, v70
    v_mul_f32 v71, s48, v71
    v_mul_f32 v72, s48, v72
    v_mul_f32 v73, s48, v73
    v_mul_f32 v74, s48, v74
    v_mul_f32 v75, s48, v75
    v_mul_f32 v76, s48, v76
    v_mul_f32 v77, s48, v77
    v_mul_f32 v78, s48, v78
    v_mul_f32 v79, s48, v79
    v_mul_f32 v80, s48, v80
    v_mul_f32 v81, s48, v81
    v_mul_f32 v82, s48, v82
    v_mul_f32 v83, s48, v83
    v_cvt_pk_bf16_f32 v68, v68, v69
    v_cvt_pk_bf16_f32 v69, v70, v71
    v_cvt_pk_bf16_f32 v70, v72, v73
    v_cvt_pk_bf16_f32 v71, v74, v75
    v_cvt_pk_bf16_f32 v72, v76, v77
    v_cvt_pk_bf16_f32 v73, v78, v79
    v_cvt_pk_bf16_f32 v74, v80, v81
    v_cvt_pk_bf16_f32 v75, v82, v83
    s_mov_b32 exec_lo, 0
    v_mov_b32 v74, 0
    v_mov_b32 v75, 0
    s_mov_b64 exec, -1
    buffer_store_dwordx4 v[68:71], v2, s[24:27], s44 offen sc1
    buffer_store_dwordx4 v[72:75], v2, s[24:27], s44 offen offset:1024 sc1
    s_branch KF_EPI1
KF_V1_kkk:
    s_add_u32 s40, s43, 0
    s_and_b32 s40, s40, 15
    s_lshl_b32 s40, s40, 6
    s_add_u32 s40, s40, s41
    s_lshl_b32 s40, s40, 12
    s_add_u32 s40, s40, s42
    s_add_u32 s44, s40, 2097152
    s_add_u32 s40, s43, 1
    s_and_b32 s40, s40, 15
    s_lshl_b32 s40, s40, 6
    s_add_u32 s40, s40, s41
    s_lshl_b32 s40, s40, 12
    s_add_u32 s40, s40, s42
    s_add_u32 s45, s40, 2097152
    s_add_u32 s40, s43, 2
    s_and_b32 s40, s40, 15
    s_lshl_b32 s40, s40, 6
    s_add_u32 s40, s40, s41
    s_lshl_b32 s40, s40, 12
    s_add_u32 s40, s40, s42
    s_add_u32 s46, s40, 2097152
    s_barrier
    ds_read_b128 v[36:39], v24 offset:0
    ds_read_b64_tr_b16 v[40:41], v32 offset:12288
    ds_read_b64_tr_b16 v[42:43], v32 offset:13056
    ds_read_b64_tr_b16 v[44:45], v32 offset:12344
    ds_read_b64_tr_b16 v[46:47], v32 offset:13112
    ds_read_b64_tr_b16 v[48:49], v32 offset:12400
    ds_read_b64_tr_b16 v[50:51], v32 offset:13168
    s_waitcnt lgkmcnt(0)
    v_mfma_f32_32x32x16_bf16 v[68:83], v[40:43], v[36:39], 0
    ds_read_b128 v[52:55], v25 offset:0
    ds_read_b64_tr_b16 v[56:57], v32 offset:15360
    ds_read_b64_tr_b16 v[58:59], v32 offset:16128
    ds_read_b64_tr_b16 v[60:61], v32 offset:15416
    v_mfma_f32_32x32x16_bf16 v[84:99], v[44:47], v[36:39], 0
    ds_read_b64_tr_b16 v[62:63], v32 offset:16184
    ds_read_b64_tr_b16 v[64:65], v32 offset:15472
    ds_read_b64_tr_b16 v[66:67], v32 offset:16240
    v_mfma_f32_32x32x16_bf16 v[100:115], v[48:51], v[36:39], 0
    s_waitcnt lgkmcnt(0)
    v_mfma_f32_32x32x16_bf16 v[68:83], v[56:59], v[52:55], v[68:83]
    ds_read_b128 v[36:39], v26 offset:0
    ds_read_b64_tr_b16 v[40:41], v32 offset:18432
    ds_read_b64_tr_b16 v[42:43], v32 offset:19200
    ds_read_b64_tr_b16 v[44:45], v32 offset:18488
    v_mfma_f32_32x32x16_bf16 v[84:99], v[60:63], v[52:55], v[84:99]
    ds_read_b64_tr_b16 v[46:47], v32 offset:19256
    ds_read_b64_tr_b16 v[48:49], v32 offset:18544
    ds_read_b64_tr_b16 v[50:51], v32 offset:19312
    v_mfma_f32_32x32x16_bf16 v[100:115], v[64:67], v[52:55], v[100:115]
    s_waitcnt lgkmcnt(0)
    v_mfma_f32_32x32x16_bf16 v[68:83], v[40:43], v[36:39], v[68:83]
    ds_read_b128 v[52:55], v27 offset:0
    ds_read_b64_tr_b16 v[56:57], v32 offset:21504
    ds_read_b64_tr_b16 v[58:59], v32 offset:22272
    ds_read_b64_tr_b16 v[60:61], v32 offset:21560
    v_mfma_f32_32x32x16_bf16 v[84:99], v[44:47], v[36:39], v[84:99]
    ds_read_b64_tr_b16 v[62:63], v32 offset:22328
    ds_read_b64_tr_b16 v[64:65], v32 offset:21616
    ds_read_b64_tr_b16 v[66:67], v32 offset:22384
    v_mfma_f32_32x32x16_bf16 v[100:115], v[48:51], v[36:39], v[100:115]
    s_waitcnt lgkmcnt(0)
    v_mfma_f32_32x32x16_bf16 v[68:83], v[56:59], v[52:55], v[68:83]
    s_barrier
    ds_read_b128 v[36:39], v24 offset:16384
    ds_read_b64_tr_b16 v[40:41], v32 offset:24576
    ds_read_b64_tr_b16 v[42:43], v32 offset:25344
    ds_read_b64_tr_b16 v[44:45], v32 offset:24632
    v_mfma_f32_32x32x16_bf16 v[84:99], v[60:63], v[52:55], v[84:99]
    ds_read_b64_tr_b16 v[46:47], v32 offset:25400
    ds_read_b64_tr_b16 v[48:49], v32 offset:24688
    ds_read_b64_tr_b16 v[50:51], v32 offset:25456
    v_mfma_f32_32x32x16_bf16 v[100:115], v[64:67], v[52:55], v[100:115]
    s_waitcnt lgkmcnt(0)
    v_mfma_f32_32x32x16_bf16 v[68:83], v[40:43], v[36:39], v[68:83]
    ds_read_b128 v[52:55], v25 offset:16384
    ds_read_b64_tr_b16 v[56:57], v32 offset:27648
    ds_read_b64_tr_b16 v[58:59], v32 offset:28416
    ds_read_b64_tr_b16 v[60:61], v32 offset:27704
    v_mfma_f32_32x32x16_bf16 v[84:99], v[44:47], v[36:39], v[84:99]
    ds_read_b64_tr_b16 v[62:63], v32 offset:28472
    ds_read_b64_tr_b16 v[64:65], v32 offset:27760
    ds_read_b64_tr_b16 v[66:67], v32 offset:28528
    v_mfma_f32_32x32x16_bf16 v[100:115], v[48:51], v[36:39], v[100:115]
    s_waitcnt lgkmcnt(0)
    v_mfma_f32_32x32x16_bf16 v[68:83], v[56:59], v[52:55], v[68:83]
    ds_read_b128 v[36:39], v26 offset:16384
    ds_read_b64_tr_b16 v[40:41], v32 offset:30720
    ds_read_b64_tr_b16 v[42:43], v32 offset:31488
    ds_read_b64_tr_b16 v[44:45], v32 offset:30776
    v_mfma_f32_32x32x16_bf16 v[84:99], v[60:63], v[52:55], v[84:99]
    ds_read_b64_tr_b16 v[46:47], v32 offset:31544
    ds_read_b64_tr_b16 v[48:49], v32 offset:30832
    ds_read_b64_tr_b16 v[50:51], v32 offset:31600
    v_mfma_f32_32x32x16_bf16 v[100:115], v[64:67], v[52:55], v[100:115]
    s_waitcnt lgkmcnt(0)
    v_mfma_f32_32x32x16_bf16 v[68:83], v[40:43], v[36:39], v[68:83]
    ds_read_b128 v[52:55], v27 offset:16384
    ds_read_b64_tr_b16 v[56:57], v32 offset:33792
    ds_read_b64_tr_b16 v[58:59], v32 offset:34560
    ds_read_b64_tr_b16 v[60:61], v32 offset:33848
    v_mfma_f32_32x32x16_bf16 v[84:99], v[44:47], v[36:39], v[84:99]
    ds_read_b64_tr_b16 v[62:63], v32 offset:34616
    ds_read_b64_tr_b16 v[64:65], v32 offset:33904
    ds_read_b64_tr_b16 v[66:67], v32 offset:34672
    v_mfma_f32_32x32x16_bf16 v[100:115], v[48:51], v[36:39], v[100:115]
    s_waitcnt lgkmcnt(0)
    v_mfma_f32_32x32x16_bf16 v[68:83], v[56:59], v[52:55], v[68:83]
    s_barrier
    ds_read_b128 v[36:39], v24 offset:32768
    ds_read_b64_tr_b16 v[40:41], v32 offset:0
    ds_read_b64_tr_b16 v[42:43], v32 offset:768
    ds_read_b64_tr_b16 v[44:45], v32 offset:56
    v_mfma_f32_32x32x16_bf16 v[84:99], v[60:63], v[52:55], v[84:99]
    ds_read_b64_tr_b16 v[46:47], v32 offset:824
    ds_read_b64_tr_b16 v[48:49], v32 offset:112
    ds_read_b64_tr_b16 v[50:51], v32 offset:880
    v_mfma_f32_32x32x16_bf16 v[100:115], v[64:67], v[52:55], v[100:115]
    s_waitcnt lgkmcnt(0)
    v_mfma_f32_32x32x16_bf16 v[68:83], v[40:43], v[36:39], v[68:83]
    ds_read_b128 v[52:55], v25 offset:32768
    ds_read_b64_tr_b16 v[56:57], v32 offset:3072
    ds_read_b64_tr_b16 v[58:59], v32 offset:3840
    ds_read_b64_tr_b16 v[60:61], v32 offset:3128
    v_mfma_f32_32x32x16_bf16 v[84:99], v[44:47], v[36:39], v[84:99]
    ds_read_b64_tr_b16 v[62:63], v32 offset:3896
    ds_read_b64_tr_b16 v[64:65], v32 offset:3184
    ds_read_b64_tr_b16 v[66:67], v32 offset:3952
    v_mfma_f32_32x32x16_bf16 v[100:115], v[48:51], v[36:39], v[100:115]
    s_waitcnt lgkmcnt(0)
    v_mfma_f32_32x32x16_bf16 v[68:83], v[56:59], v[52:55], v[68:83]
    ds_read_b128 v[36:39], v26 offset:32768
    ds_read_b64_tr_b16 v[40:41], v32 offset:6144
    ds_read_b64_tr_b16 v[42:43], v32 offset:6912
    ds_read_b64_tr_b16 v[44:45], v32 offset:6200
    v_mfma_f32_32x32x16_bf16 v[84:99], v[60:63], v[52:55], v[84:99]
    ds_read_b64_tr_b16 v[46:47], v32 offset:6968
    ds_read_b64_tr_b16 v[48:49], v32 offset:6256
    ds_read_b64_tr_b16 v[50:51], v32 offset:7024
    v_mfma_f32_32x32x16_bf16 v[100:115], v[64:67], v[52:55], v[100:115]
    s_waitcnt lgkmcnt(0)
    v_mfma_f32_32x32x16_bf16 v[68:83], v[40:43], v[36:39], v[68:83]
    ds_read_b128 v[52:55], v27 offset:32768
    ds_read_b64_tr_b16 v[56:57], v32 offset:9216
    ds_read_b64_tr_b16 v[58:59], v32 offset:9984
    ds_read_b64_tr_b16 v[60:61], v32 offset:9272
    v_mfma_f32_32x32x16_bf16 v[84:99], v[44:47], v[36:39], v[84:99]
    ds_read_b64_tr_b16 v[62:63], v32 offset:10040
    ds_read_b64_tr_b16 v[64:65], v32 offset:9328
    ds_read_b64_tr_b16 v[66:67], v32 offset:10096
    v_mfma_f32_32x32x16_bf16 v[100:115], v[48:51], v[36:39], v[100:115]
    s_waitcnt lgkmcnt(0)
    v_mfma_f32_32x32x16_bf16 v[68:83], v[56:59], v[52:55], v[68:83]
    s_barrier
    ds_read_b128 v[36:39], v24 offset:49152
    ds_read_b64_tr_b16 v[40:41], v32 offset:12288
    ds_read_b64_tr_b16 v[42:43], v32 offset:13056
    ds_read_b64_tr_b16 v[44:45], v32 offset:12344
    v_mfma_f32_32x32x16_bf16 v[84:99], v[60:63], v[52:55], v[84:99]
    ds_read_b64_tr_b16 v[46:47], v32 offset:13112
    ds_read_b64_tr_b16 v[48:49], v32 offset:12400
    ds_read_b64_tr_b16 v[50:51], v32 offset:13168
    v_mfma_f32_32x32x16_bf16 v[100:115], v[64:67], v[52:55], v[100:115]
    s_waitcnt lgkmcnt(0)
    v_mfma_f32_32x32x16_bf16 v[68:83], v[40:43], v[36:39], v[68:83]
    ds_read_b128 v[52:55], v25 offset:49152
    ds_read_b64_tr_b16 v[56:57], v32 offset:15360
    ds_read_b64_tr_b16 v[58:59], v32 offset:16128
    ds_read_b64_tr_b16 v[60:61], v32 offset:15416
    v_mfma_f32_32x32x16_bf16 v[84:99], v[44:47], v[36:39], v[84:99]
    ds_read_b64_tr_b16 v[62:63], v32 offset:16184
    ds_read_b64_tr_b16 v[64:65], v32 offset:15472
    ds_read_b64_tr_b16 v[66:67], v32 offset:16240
    v_mfma_f32_32x32x16_bf16 v[100:115], v[48:51], v[36:39], v[100:115]
    s_waitcnt lgkmcnt(0)
    v_mfma_f32_32x32x16_bf16 v[68:83], v[56:59], v[52:55], v[68:83]
    ds_read_b128 v[36:39], v26 offset:49152
    ds_read_b64_tr_b16 v[40:41], v32 offset:18432
    ds_read_b64_tr_b16 v[42:43], v32 offset:19200
    ds_read_b64_tr_b16 v[44:45], v32 offset:18488
    v_mfma_f32_32x32x16_bf16 v[84:99], v[60:63], v[52:55], v[84:99]
    ds_read_b64_tr_b16 v[46:47], v32 offset:19256
    ds_read_b64_tr_b16 v[48:49], v32 offset:18544
    ds_read_b64_tr_b16 v[50:51], v32 offset:19312
    v_mfma_f32_32x32x16_bf16 v[100:115], v[64:67], v[52:55], v[100:115]
    s_waitcnt lgkmcnt(0)
    v_mfma_f32_32x32x16_bf16 v[68:83], v[40:43], v[36:39], v[68:83]
    ds_read_b128 v[52:55], v27 offset:49152
    ds_read_b64_tr_b16 v[56:57], v32 offset:21504
    ds_read_b64_tr_b16 v[58:59], v32 offset:22272
    ds_read_b64_tr_b16 v[60:61], v32 offset:21560
    v_mfma_f32_32x32x16_bf16 v[84:99], v[44:47], v[36:39], v[84:99]
    ds_read_b64_tr_b16 v[62:63], v32 offset:22328
    ds_read_b64_tr_b16 v[64:65], v32 offset:21616
    ds_read_b64_tr_b16 v[66:67], v32 offset:22384
    v_mfma_f32_32x32x16_bf16 v[100:115], v[48:51], v[36:39], v[100:115]
    s_waitcnt lgkmcnt(0)
    v_mfma_f32_32x32x16_bf16 v[68:83], v[56:59], v[52:55], v[68:83]
    s_barrier
    ds_read_b128 v[36:39], v28 offset:0
    ds_read_b64_tr_b16 v[40:41], v32 offset:24576
    ds_read_b64_tr_b16 v[42:43], v32 offset:25344
    ds_read_b64_tr_b16 v[44:45], v32 offset:24632
    v_mfma_f32_32x32x16_bf16 v[84:99], v[60:63], v[52:55], v[84:99]
    ds_read_b64_tr_b16 v[46:47], v32 offset:25400
    ds_read_b64_tr_b16 v[48:49], v32 offset:24688
    ds_read_b64_tr_b16 v[50:51], v32 offset:25456
    v_mfma_f32_32x32x16_bf16 v[100:115], v[64:67], v[52:55], v[100:115]
    s_waitcnt lgkmcnt(0)
    v_mfma_f32_32x32x16_bf16 v[68:83], v[40:43], v[36:39], v[68:83]
    ds_read_b128 v[52:55], v29 offset:0
    ds_read_b64_tr_b16 v[56:57], v32 offset:27648
    ds_read_b64_tr_b16 v[58:59], v32 offset:28416
    ds_read_b64_tr_b16 v[60:61], v32 offset:27704
    v_mfma_f32_32x32x16_bf16 v[84:99], v[44:47], v[36:39], v[84:99]
    ds_read_b64_tr_b16 v[62:63], v32 offset:28472
    ds_read_b64_tr_b16 v[64:65], v32 offset:27760
    ds_read_b64_tr_b16 v[66:67], v32 offset:28528
    v_mfma_f32_32x32x16_bf16 v[100:115], v[48:51], v[36:39], v[100:115]
    s_waitcnt lgkmcnt(0)
    v_mfma_f32_32x32x16_bf16 v[68:83], v[56:59], v[52:55], v[68:83]
    ds_read_b128 v[36:39], v30 offset:0
    ds_read_b64_tr_b16 v[40:41], v32 offset:30720
    ds_read_b64_tr_b16 v[42:43], v32 offset:31488
    ds_read_b64_tr_b16 v[44:45], v32 offset:30776
    v_mfma_f32_32x32x16_bf16 v[84:99], v[60:63], v[52:55], v[84:99]
    ds_read_b64_tr_b16 v[46:47], v32 offset:31544
    ds_read_b64_tr_b16 v[48:49], v32 offset:30832
    ds_read_b64_tr_b16 v[50:51], v32 offset:31600
    v_mfma_f32_32x32x16_bf16 v[100:115], v[64:67], v[52:55], v[100:115]
    s_waitcnt lgkmcnt(0)
    v_mfma_f32_32x32x16_bf16 v[68:83], v[40:43], v[36:39], v[68:83]
    ds_read_b128 v[52:55], v31 offset:0
    ds_read_b64_tr_b16 v[56:57], v32 offset:33792
    ds_read_b64_tr_b16 v[58:59], v32 offset:34560
    ds_read_b64_tr_b16 v[60:61], v32 offset:33848
    v_mfma_f32_32x32x16_bf16 v[84:99], v[44:47], v[36:39], v[84:99]
    ds_read_b64_tr_b16 v[62:63], v32 offset:34616
    ds_read_b64_tr_b16 v[64:65], v32 offset:33904
    ds_read_b64_tr_b16 v[66:67], v32 offset:34672
    v_mfma_f32_32x32x16_bf16 v[100:115], v[48:51], v[36:39], v[100:115]
    s_waitcnt lgkmcnt(0)
    v_mfma_f32_32x32x16_bf16 v[68:83], v[56:59], v[52:55], v[68:83]
    s_barrier
    ds_read_b128 v[36:39], v28 offset:16384
    ds_read_b64_tr_b16 v[40:41], v32 offset:0
    ds_read_b64_tr_b16 v[42:43], v32 offset:768
    ds_read_b64_tr_b16 v[44:45], v32 offset:56
    v_mfma_f32_32x32x16_bf16 v[84:99], v[60:63], v[52:55], v[84:99]
    ds_read_b64_tr_b16 v[46:47], v32 offset:824
    ds_read_b64_tr_b16 v[48:49], v32 offset:112
    ds_read_b64_tr_b16 v[50:51], v32 offset:880
    v_mfma_f32_32x32x16_bf16 v[100:115], v[64:67], v[52:55], v[100:115]
    s_waitcnt lgkmcnt(0)
    v_mfma_f32_32x32x16_bf16 v[68:83], v[40:43], v[36:39], v[68:83]
    ds_read_b128 v[52:55], v29 offset:16384
    ds_read_b64_tr_b16 v[56:57], v32 offset:3072
    ds_read_b64_tr_b16 v[58:59], v32 offset:3840
    ds_read_b64_tr_b16 v[60:61], v32 offset:3128
    v_mfma_f32_32x32x16_bf16 v[84:99], v[44:47], v[36:39], v[84:99]
    ds_read_b64_tr_b16 v[62:63], v32 offset:3896
    ds_read_b64_tr_b16 v[64:65], v32 offset:3184
    ds_read_b64_tr_b16 v[66:67], v32 offset:3952
    v_mfma_f32_32x32x16_bf16 v[100:115], v[48:51], v[36:39], v[100:115]
    s_waitcnt lgkmcnt(0)
    v_mfma_f32_32x32x16_bf16 v[68:83], v[56:59], v[52:55], v[68:83]
    ds_read_b128 v[36:39], v30 offset:16384
    ds_read_b64_tr_b16 v[40:41], v32 offset:6144
    ds_read_b64_tr_b16 v[42:43], v32 offset:6912
    ds_read_b64_tr_b16 v[44:45], v32 offset:6200
    v_mfma_f32_32x32x16_bf16 v[84:99], v[60:63], v[52:55], v[84:99]
    ds_read_b64_tr_b16 v[46:47], v32 offset:6968
    ds_read_b64_tr_b16 v[48:49], v32 offset:6256
    ds_read_b64_tr_b16 v[50:51], v32 offset:7024
    v_mfma_f32_32x32x16_bf16 v[100:115], v[64:67], v[52:55], v[100:115]
    s_waitcnt lgkmcnt(0)
    v_mfma_f32_32x32x16_bf16 v[68:83], v[40:43], v[36:39], v[68:83]
    ds_read_b128 v[52:55], v31 offset:16384
    ds_read_b64_tr_b16 v[56:57], v32 offset:9216
    ds_read_b64_tr_b16 v[58:59], v32 offset:9984
    ds_read_b64_tr_b16 v[60:61], v32 offset:9272
    v_mfma_f32_32x32x16_bf16 v[84:99], v[44:47], v[36:39], v[84:99]
    ds_read_b64_tr_b16 v[62:63], v32 offset:10040
    ds_read_b64_tr_b16 v[64:65], v32 offset:9328
    ds_read_b64_tr_b16 v[66:67], v32 offset:10096
    v_mfma_f32_32x32x16_bf16 v[100:115], v[48:51], v[36:39], v[100:115]
    s_waitcnt lgkmcnt(0)
    v_mfma_f32_32x32x16_bf16 v[68:83], v[56:59], v[52:55], v[68:83]
    s_barrier
    ds_read_b128 v[36:39], v28 offset:32768
    ds_read_b64_tr_b16 v[40:41], v32 offset:12288
    ds_read_b64_tr_b16 v[42:43], v32 offset:13056
    ds_read_b64_tr_b16 v[44:45], v32 offset:12344
    v_mfma_f32_32x32x16_bf16 v[84:99], v[60:63], v[52:55], v[84:99]
    ds_read_b64_tr_b16 v[46:47], v32 offset:13112
    ds_read_b64_tr_b16 v[48:49], v32 offset:12400
    ds_read_b64_tr_b16 v[50:51], v32 offset:13168
    v_mfma_f32_32x32x16_bf16 v[100:115], v[64:67], v[52:55], v[100:115]
    s_waitcnt lgkmcnt(0)
    v_mfma_f32_32x32x16_bf16 v[68:83], v[40:43], v[36:39], v[68:83]
    ds_read_b128 v[52:55], v29 offset:32768
    ds_read_b64_tr_b16 v[56:57], v32 offset:15360
    ds_read_b64_tr_b16 v[58:59], v32 offset:16128
    ds_read_b64_tr_b16 v[60:61], v32 offset:15416
    v_mfma_f32_32x32x16_bf16 v[84:99], v[44:47], v[36:39], v[84:99]
    ds_read_b64_tr_b16 v[62:63], v32 offset:16184
    ds_read_b64_tr_b16 v[64:65], v32 offset:15472
    ds_read_b64_tr_b16 v[66:67], v32 offset:16240
    v_mfma_f32_32x32x16_bf16 v[100:115], v[48:51], v[36:39], v[100:115]
    s_waitcnt lgkmcnt(0)
    v_mfma_f32_32x32x16_bf16 v[68:83], v[56:59], v[52:55], v[68:83]
    ds_read_b128 v[36:39], v30 offset:32768
    ds_read_b64_tr_b16 v[40:41], v32 offset:18432
    ds_read_b64_tr_b16 v[42:43], v32 offset:19200
    ds_read_b64_tr_b16 v[44:45], v32 offset:18488
    v_mfma_f32_32x32x16_bf16 v[84:99], v[60:63], v[52:55], v[84:99]
    ds_read_b64_tr_b16 v[46:47], v32 offset:19256
    ds_read_b64_tr_b16 v[48:49], v32 offset:18544
    ds_read_b64_tr_b16 v[50:51], v32 offset:19312
    v_mfma_f32_32x32x16_bf16 v[100:115], v[64:67], v[52:55], v[100:115]
    s_waitcnt lgkmcnt(0)
    v_mfma_f32_32x32x16_bf16 v[68:83], v[40:43], v[36:39], v[68:83]
    ds_read_b128 v[52:55], v31 offset:32768
    ds_read_b64_tr_b16 v[56:57], v32 offset:21504
    ds_read_b64_tr_b16 v[58:59], v32 offset:22272
    ds_read_b64_tr_b16 v[60:61], v32 offset:21560
    v_mfma_f32_32x32x16_bf16 v[84:99], v[44:47], v[36:39], v[84:99]
    ds_read_b64_tr_b16 v[62:63], v32 offset:22328
    ds_read_b64_tr_b16 v[64:65], v32 offset:21616
    ds_read_b64_tr_b16 v[66:67], v32 offset:22384
    v_mfma_f32_32x32x16_bf16 v[100:115], v[48:51], v[36:39], v[100:115]
    s_waitcnt lgkmcnt(0)
    v_mfma_f32_32x32x16_bf16 v[68:83], v[56:59], v[52:55], v[68:83]
    v_mfma_f32_32x32x16_bf16 v[84:99], v[60:63], v[52:55], v[84:99]
    v_mfma_f32_32x32x16_bf16 v[100:115], v[64:67], v[52:55], v[100:115]
    s_barrier
    s_barrier
    s_nop 9
    v_cvt_pk_bf16_f32 v100, v100, v101
    v_cvt_pk_bf16_f32 v101, v102, v103
    v_cvt_pk_bf16_f32 v102, v104, v105
    v_cvt_pk_bf16_f32 v103, v106, v107
    v_cvt_pk_bf16_f32 v104, v108, v109
    v_cvt_pk_bf16_f32 v105, v110, v111
    v_cvt_pk_bf16_f32 v106, v112, v113
    v_cvt_pk_bf16_f32 v107, v114, v115
    s_mov_b32 exec_lo, 0
    v_mov_b32 v106, 0x3f803f80
    v_mov_b32 v107, 0x3f80
    s_mov_b64 exec, -1
    buffer_store_dwordx4 v[100:103], v2, s[24:27], s46 offen sc1
    buffer_store_dwordx4 v[104:107], v2, s[24:27], s46 offen offset:1024 sc1
    v_cvt_pk_bf16_f32 v84, v84, v85
    v_cvt_pk_bf16_f32 v85, v86, v87
    v_cvt_pk_bf16_f32 v86, v88, v89
    v_cvt_pk_bf16_f32 v87, v90, v91
    v_cvt_pk_bf16_f32 v88, v92, v93
    v_cvt_pk_bf16_f32 v89, v94, v95
    v_cvt_pk_bf16_f32 v90, v96, v97
    v_cvt_pk_bf16_f32 v91, v98, v99
    s_mov_b32 exec_lo, 0
    v_mov_b32 v90, 0x3f803f80
    v_mov_b32 v91, 0x3f80
    s_mov_b64 exec, -1
    buffer_store_dwordx4 v[84:87], v2, s[24:27], s45 offen sc1
    buffer_store_dwordx4 v[88:91], v2, s[24:27], s45 offen offset:1024 sc1
    v_cvt_pk_bf16_f32 v68, v68, v69
    v_cvt_pk_bf16_f32 v69, v70, v71
    v_cvt_pk_bf16_f32 v70, v72, v73
    v_cvt_pk_bf16_f32 v71, v74, v75
    v_cvt_pk_bf16_f32 v72, v76, v77
    v_cvt_pk_bf16_f32 v73, v78, v79
    v_cvt_pk_bf16_f32 v74, v80, v81
    v_cvt_pk_bf16_f32 v75, v82, v83
    s_mov_b32 exec_lo, 0
    v_mov_b32 v74, 0x3f803f80
    v_mov_b32 v75, 0x3f80
    s_mov_b64 exec, -1
    buffer_store_dwordx4 v[68:71], v2, s[24:27], s44 offen sc1
    buffer_store_dwordx4 v[72:75], v2, s[24:27], s44 offen offset:1024 sc1
    s_branch KF_EPI1
KF_V1_kkv:
    s_add_u32 s40, s43, 0
    s_and_b32 s40, s40, 15
    s_lshl_b32 s40, s40, 6
    s_add_u32 s40, s40, s41
    s_lshl_b32 s40, s40, 12
    s_add_u32 s40, s40, s42
    s_add_u32 s44, s40, 2097152
    s_add_u32 s40, s43, 1
    s_and_b32 s40, s40, 15
    s_lshl_b32 s40, s40, 6
    s_add_u32 s40, s40, s41
    s_lshl_b32 s40, s40, 12
    s_add_u32 s40, s40, s42
    s_add_u32 s45, s40, 2097152
    s_add_u32 s40, s43, 2
    s_and_b32 s40, s40, 15
    s_lshl_b32 s40, s40, 6
    s_add_u32 s40, s40, s41
    s_lshl_b32 s40, s40, 12
    s_add_u32 s40, s40, s42
    s_add_u32 s46, s40, 2099200
    s_barrier
    ds_read_b128 v[36:39], v24 offset:0
    ds_read_b64_tr_b16 v[40:41], v32 offset:12288
    ds_read_b64_tr_b16 v[42:43], v32 offset:13056
    ds_read_b64_tr_b16 v[44:45], v32 offset:12344
    ds_read_b64_tr_b16 v[46:47], v32 offset:13112
    ds_read_b64_tr_b16 v[48:49], v32 offset:12400
    ds_read_b64_tr_b16 v[50:51], v32 offset:13168
    s_waitcnt lgkmcnt(0)
    v_mfma_f32_32x32x16_bf16 v[68:83], v[40:43], v[36:39], 0
    ds_read_b128 v[52:55], v25 offset:0
    ds_read_b64_tr_b16 v[56:57], v32 offset:15360
    ds_read_b64_tr_b16 v[58:59], v32 offset:16128
    ds_read_b64_tr_b16 v[60:61], v32 offset:15416
    v_mfma_f32_32x32x16_bf16 v[84:99], v[44:47], v[36:39], 0
    ds_read_b64_tr_b16 v[62:63], v32 offset:16184
    ds_read_b64_tr_b16 v[64:65], v32 offset:15472
    ds_read_b64_tr_b16 v[66:67], v32 offset:16240
    v_mfma_f32_32x32x16_bf16 v[100:115], v[36:39], v[48:51], 0
    s_waitcnt lgkmcnt(0)
    v_mfma_f32_32x32x16_bf16 v[68:83], v[56:59], v[52:55], v[68:83]
    ds_read_b128 v[36:39], v26 offset:0
    ds_read_b64_tr_b16 v[40:41], v32 offset:18432
    ds_read_b64_tr_b16 v[42:43], v32 offset:19200
    ds_read_b64_tr_b16 v[44:45], v32 offset:18488
    v_mfma_f32_32x32x16_bf16 v[84:99], v[60:63], v[52:55], v[84:99]
    ds_read_b64_tr_b16 v[46:47], v32 offset:19256
    ds_read_b64_tr_b16 v[48:49], v32 offset:18544
    ds_read_b64_tr_b16 v[50:51], v32 offset:19312
    v_mfma_f32_32x32x16_bf16 v[100:115], v[52:55], v[64:67], v[100:115]
    s_waitcnt lgkmcnt(0)
    v_mfma_f32_32x32x16_bf16 v[68:83], v[40:43], v[36:39], v[68:83]
    ds_read_b128 v[52:55], v27 offset:0
    ds_read_b64_tr_b16 v[56:57], v32 offset:21504
    ds_read_b64_tr_b16 v[58:59], v32 offset:22272
    ds_read_b64_tr_b16 v[60:61], v32 offset:21560
    v_mfma_f32_32x32x16_bf16 v[84:99], v[44:47], v[36:39], v[84:99]
    ds_read_b64_tr_b16 v[62:63], v32 offset:22328
    ds_read_b64_tr_b16 v[64:65], v32 offset:21616
    ds_read_b64_tr_b16 v[66:67], v32 offset:22384
    v_mfma_f32_32x32x16_bf16 v[100:115], v[36:39], v[48:51], v[100:115]
    s_waitcnt lgkmcnt(0)
    v_mfma_f32_32x32x16_bf16 v[68:83], v[56:59], v[52:55], v[68:83]
    s_barrier
    ds_read_b128 v[36:39], v24 offset:16384
    ds_read_b64_tr_b16 v[40:41], v32 offset:24576
    ds_read_b64_tr_b16 v[42:43], v32 offset:25344
    ds_read_b64_tr_b16 v[44:45], v32 offset:24632
    v_mfma_f32_32x32x16_bf16 v[84:99], v[60:63], v[52:55], v[84:99]
    ds_read_b64_tr_b16 v[46:47], v32 offset:25400
    ds_read_b64_tr_b16 v[48:49], v32 offset:24688
    ds_read_b64_tr_b16 v[50:51], v32 offset:25456
    v_mfma_f32_32x32x16_bf16 v[100:115], v[52:55], v[64:67], v[100:115]
    s_waitcnt lgkmcnt(0)
    v_mfma_f32_32x32x16_bf16 v[68:83], v[40:43], v[36:39], v[68:83]
    ds_read_b128 v[52:55], v25 offset:16384
    ds_read_b64_tr_b16 v[56:57], v32 offset:27648
    ds_read_b64_tr_b16 v[58:59], v32 offset:28416
    ds_read_b64_tr_b16 v[60:61], v32 offset:27704
    v_mfma_f32_32x32x16_bf16 v[84:99], v[44:47], v[36:39], v[84:99]
    ds_read_b64_tr_b16 v[62:63], v32 offset:28472
    ds_read_b64_tr_b16 v[64:65], v32 offset:27760
    ds_read_b64_tr_b16 v[66:67], v32 offset:28528
    v_mfma_f32_32x32x16_bf16 v[100:115], v[36:39], v[48:51], v[100:115]
    s_waitcnt lgkmcnt(0)
    v_mfma_f32_32x32x16_bf16 v[68:83], v[56:59], v[52:55], v[68:83]
    ds_read_b128 v[36:39], v26 offset:16384
    ds_read_b64_tr_b16 v[40:41], v32 offset:30720
    ds_read_b64_tr_b16 v[42:43], v32 offset:31488
    ds_read_b64_tr_b16 v[44:45], v32 offset:30776
    v_mfma_f32_32x32x16_bf16 v[84:99], v[60:63], v[52:55], v[84:99]
    ds_read_b64_tr_b16 v[46:47], v32 offset:31544
    ds_read_b64_tr_b16 v[48:49], v32 offset:30832
    ds_read_b64_tr_b16 v[50:51], v32 offset:31600
    v_mfma_f32_32x32x16_bf16 v[100:115], v[52:55], v[64:67], v[100:115]
    s_waitcnt lgkmcnt(0)
    v_mfma_f32_32x32x16_bf16 v[68:83], v[40:43], v[36:39], v[68:83]
    ds_read_b128 v[52:55], v27 offset:16384
    ds_read_b64_tr_b16 v[56:57], v32 offset:33792
    ds_read_b64_tr_b16 v[58:59], v32 offset:34560
    ds_read_b64_tr_b16 v[60:61], v32 offset:33848
    v_mfma_f32_32x32x16_bf16 v[84:99], v[44:47], v[36:39], v[84:99]
    ds_read_b64_tr_b16 v[62:63], v32 offset:34616
    ds_read_b64_tr_b16 v[64:65], v32 offset:33904
    ds_read_b64_tr_b16 v[66:67], v32 offset:34672
    v_mfma_f32_32x32x16_bf16 v[100:115], v[36:39], v[48:51], v[100:115]
    s_waitcnt lgkmcnt(0)
    v_mfma_f32_32x32x16_bf16 v[68:83], v[56:59], v[52:55], v[68:83]
    s_barrier
    ds_read_b128 v[36:39], v24 offset:32768
    ds_read_b64_tr_b16 v[40:41], v32 offset:0
    ds_read_b64_tr_b16 v[42:43], v32 offset:768
    ds_read_b64_tr_b16 v[44:45], v32 offset:56
    v_mfma_f32_32x32x16_bf16 v[84:99], v[60:63], v[52:55], v[84:99]
    ds_read_b64_tr_b16 v[46:47], v32 offset:824
    ds_read_b64_tr_b16 v[48:49], v32 offset:112
    ds_read_b64_tr_b16 v[50:51], v32 offset:880
    v_mfma_f32_32x32x16_bf16 v[100:115], v[52:55], v[64:67], v[100:115]
    s_waitcnt lgkmcnt(0)
    v_mfma_f32_32x32x16_bf16 v[68:83], v[40:43], v[36:39], v[68:83]
    ds_read_b128 v[52:55], v25 offset:32768
    ds_read_b64_tr_b16 v[56:57], v32 offset:3072
    ds_read_b64_tr_b16 v[58:59], v32 offset:3840
    ds_read_b64_tr_b16 v[60:61], v32 offset:3128
    v_mfma_f32_32x32x16_bf16 v[84:99], v[44:47], v[36:39], v[84:99]
    ds_read_b64_tr_b16 v[62:63], v32 offset:3896
    ds_read_b64_tr_b16 v[64:65], v32 offset:3184
    ds_read_b64_tr_b16 v[66:67], v32 offset:3952
    v_mfma_f32_32x32x16_bf16 v[100:115], v[36:39], v[48:51], v[100:115]
    s_waitcnt lgkmcnt(0)
    v_mfma_f32_32x32x16_bf16 v[68:83], v[56:59], v[52:55], v[68:83]
    ds_read_b128 v[36:39], v26 offset:32768
    ds_read_b64_tr_b16 v[40:41], v32 offset:6144
    ds_read_b64_tr_b16 v[42:43], v32 offset:6912
    ds_read_b64_tr_b16 v[44:45], v32 offset:6200
    v_mfma_f32_32x32x16_bf16 v[84:99], v[60:63], v[52:55], v[84:99]
    ds_read_b64_tr_b16 v[46:47], v32 offset:6968
    ds_read_b64_tr_b16 v[48:49], v32 offset:6256
    ds_read_b64_tr_b16 v[50:51], v32 offset:7024
    v_mfma_f32_32x32x16_bf16 v[100:115], v[52:55], v[64:67], v[100:115]
    s_waitcnt lgkmcnt(0)
    v_mfma_f32_32x32x16_bf16 v[68:83], v[40:43], v[36:39], v[68:83]
    ds_read_b128 v[52:55], v27 offset:32768
    ds_read_b64_tr_b16 v[56:57], v32 offset:9216
    ds_read_b64_tr_b16 v[58:59], v32 offset:9984
    ds_read_b64_tr_b16 v[60:61], v32 offset:9272
    v_mfma_f32_32x32x16_bf16 v[84:99], v[44:47], v[36:39], v[84:99]
    ds_read_b64_tr_b16 v[62:63], v32 offset:10040
    ds_read_b64_tr_b16 v[64:65], v32 offset:9328
    ds_read_b64_tr_b16 v[66:67], v32 offset:10096
    v_mfma_f32_32x32x16_bf16 v[100:115], v[36:39], v[48:51], v[100:115]
    s_waitcnt lgkmcnt(0)
    v_mfma_f32_32x32x16_bf16 v[68:83], v[56:59], v[52:55], v[68:83]
    s_barrier
    ds_read_b128 v[36:39], v24 offset:49152
    ds_read_b64_tr_b16 v[40:41], v32 offset:12288
    ds_read_b64_tr_b16 v[42:43], v32 offset:13056
    ds_read_b64_tr_b16 v[44:45], v32 offset:12344
    v_mfma_f32_32x32x16_bf16 v[84:99], v[60:63], v[52:55], v[84:99]
    ds_read_b64_tr_b16 v[46:47], v32 offset:13112
    ds_read_b64_tr_b16 v[48:49], v32 offset:12400
    ds_read_b64_tr_b16 v[50:51], v32 offset:13168
    v_mfma_f32_32x32x16_bf16 v[100:115], v[52:55], v[64:67], v[100:115]
    s_waitcnt lgkmcnt(0)
    v_mfma_f32_32x32x16_bf16 v[68:83], v[40:43], v[36:39], v[68:83]
    ds_read_b128 v[52:55], v25 offset:49152
    ds_read_b64_tr_b16 v[56:57], v32 offset:15360
    ds_read_b64_tr_b16 v[58:59], v32 offset:16128
    ds_read_b64_tr_b16 v[60:61], v32 offset:15416
    v_mfma_f32_32x32x16_bf16 v[84:99], v[44:47], v[36:39], v[84:99]
    ds_read_b64_tr_b16 v[62:63], v32 offset:16184
    ds_read_b64_tr_b16 v[64:65], v32 offset:15472
    ds_read_b64_tr_b16 v[66:67], v32 offset:16240
    v_mfma_f32_32x32x16_bf16 v[100:115], v[36:39], v[48:51], v[100:115]
    s_waitcnt lgkmcnt(0)
    v_mfma_f32_32x32x16_bf16 v[68:83], v[56:59], v[52:55], v[68:83]
    ds_read_b128 v[36:39], v26 offset:49152
    ds_read_b64_tr_b16 v[40:41], v32 offset:18432
    ds_read_b64_tr_b16 v[42:43], v32 offset:19200
    ds_read_b64_tr_b16 v[44:45], v32 offset:18488
    v_mfma_f32_32x32x16_bf16 v[84:99], v[60:63], v[52:55], v[84:99]
    ds_read_b64_tr_b16 v[46:47], v32 offset:19256
    ds_read_b64_tr_b16 v[48:49], v32 offset:18544
    ds_read_b64_tr_b16 v[50:51], v32 offset:19312
    v_mfma_f32_32x32x16_bf16 v[100:115], v[52:55], v[64:67], v[100:115]
    s_waitcnt lgkmcnt(0)
    v_mfma_f32_32x32x16_bf16 v[68:83], v[40:43], v[36:39], v[68:83]
    ds_read_b128 v[52:55], v27 offset:49152
    ds_read_b64_tr_b16 v[56:57], v32 offset:21504
    ds_read_b64_tr_b16 v[58:59], v32 offset:22272
    ds_read_b64_tr_b16 v[60:61], v32 offset:21560
    v_mfma_f32_32x32x16_bf16 v[84:99], v[44:47], v[36:39], v[84:99]
    ds_read_b64_tr_b16 v[62:63], v32 offset:22328
    ds_read_b64_tr_b16 v[64:65], v32 offset:21616
    ds_read_b64_tr_b16 v[66:67], v32 offset:22384
    v_mfma_f32_32x32x16_bf16 v[100:115], v[36:39], v[48:51], v[100:115]
    s_waitcnt lgkmcnt(0)
    v_mfma_f32_32x32x16_bf16 v[68:83], v[56:59], v[52:55], v[68:83]
    s_barrier
    ds_read_b128 v[36:39], v28 offset:0
    ds_read_b64_tr_b16 v[40:41], v32 offset:24576
    ds_read_b64_tr_b16 v[42:43], v32 offset:25344
    ds_read_b64_tr_b16 v[44:45], v32 offset:24632
    v_mfma_f32_32x32x16_bf16 v[84:99], v[60:63], v[52:55], v[84:99]
    ds_read_b64_tr_b16 v[46:47], v32 offset:25400
    ds_read_b64_tr_b16 v[48:49], v32 offset:24688
    ds_read_b64_tr_b16 v[50:51], v32 offset:25456
    v_mfma_f32_32x32x16_bf16 v[100:115], v[52:55], v[64:67], v[100:115]
    s_waitcnt lgkmcnt(0)
    v_mfma_f32_32x32x16_bf16 v[68:83], v[40:43], v[36:39], v[68:83]
    ds_read_b128 v[52:55], v29 offset:0
    ds_read_b64_tr_b16 v[56:57], v32 offset:27648
    ds_read_b64_tr_b16 v[58:59], v32 offset:28416
    ds_read_b64_tr_b16 v[60:61], v32 offset:27704
    v_mfma_f32_32x32x16_bf16 v[84:99], v[44:47], v[36:39], v[84:99]
    ds_read_b64_tr_b16 v[62:63], v32 offset:28472
    ds_read_b64_tr_b16 v[64:65], v32 offset:27760
    ds_read_b64_tr_b16 v[66:67], v32 offset:28528
    v_mfma_f32_32x32x16_bf16 v[100:115], v[36:39], v[48:51], v[100:115]
    s_waitcnt lgkmcnt(0)
    v_mfma_f32_32x32x16_bf16 v[68:83], v[56:59], v[52:55], v[68:83]
    ds_read_b128 v[36:39], v30 offset:0
    ds_read_b64_tr_b16 v[40:41], v32 offset:30720
    ds_read_b64_tr_b16 v[42:43], v32 offset:31488
    ds_read_b64_tr_b16 v[44:45], v32 offset:30776
    v_mfma_f32_32x32x16_bf16 v[84:99], v[60:63], v[52:55], v[84:99]
    ds_read_b64_tr_b16 v[46:47], v32 offset:31544
    ds_read_b64_tr_b16 v[48:49], v32 offset:30832
    ds_read_b64_tr_b16 v[50:51], v32 offset:31600
    v_mfma_f32_32x32x16_bf16 v[100:115], v[52:55], v[64:67], v[100:115]
    s_waitcnt lgkmcnt(0)
    v_mfma_f32_32x32x16_bf16 v[68:83], v[40:43], v[36:39], v[68:83]
    ds_read_b128 v[52:55], v31 offset:0
    ds_read_b64_tr_b16 v[56:57], v32 offset:33792
    ds_read_b64_tr_b16 v[58:59], v32 offset:34560
    ds_read_b64_tr_b16 v[60:61], v32 offset:33848
    v_mfma_f32_32x32x16_bf16 v[84:99], v[44:47], v[36:39], v[84:99]
    ds_read_b64_tr_b16 v[62:63], v32 offset:34616
    ds_read_b64_tr_b16 v[64:65], v32 offset:33904
    ds_read_b64_tr_b16 v[66:67], v32 offset:34672
    v_mfma_f32_32x32x16_bf16 v[100:115], v[36:39], v[48:51], v[100:115]
    s_waitcnt lgkmcnt(0)
    v_mfma_f32_32x32x16_bf16 v[68:83], v[56:59], v[52:55], v[68:83]
    s_barrier
    ds_read_b128 v[36:39], v28 offset:16384
    ds_read_b64_tr_b16 v[40:41], v32 offset:0
    ds_read_b64_tr_b16 v[42:43], v32 offset:768
    ds_read_b64_tr_b16 v[44:45], v32 offset:56
    v_mfma_f32_32x32x16_bf16 v[84:99], v[60:63], v[52:55], v[84:99]
    ds_read_b64_tr_b16 v[46:47], v32 offset:824
    ds_read_b64_tr_b16 v[48:49], v32 offset:112
    ds_read_b64_tr_b16 v[50:51], v32 offset:880
    v_mfma_f32_32x32x16_bf16 v[100:115], v[52:55], v[64:67], v[100:115]
    s_waitcnt lgkmcnt(0)
    v_mfma_f32_32x32x16_bf16 v[68:83], v[40:43], v[36:39], v[68:83]
    ds_read_b128 v[52:55], v29 offset:16384
    ds_read_b64_tr_b16 v[56:57], v32 offset:3072
    ds_read_b64_tr_b16 v[58:59], v32 offset:3840
    ds_read_b64_tr_b16 v[60:61], v32 offset:3128
    v_mfma_f32_32x32x16_bf16 v[84:99], v[44:47], v[36:39], v[84:99]
    ds_read_b64_tr_b16 v[62:63], v32 offset:3896
    ds_read_b64_tr_b16 v[64:65], v32 offset:3184
    ds_read_b64_tr_b16 v[66:67], v32 offset:3952
    v_mfma_f32_32x32x16_bf16 v[100:115], v[36:39], v[48:51], v[100:115]
    s_waitcnt lgkmcnt(0)
    v_mfma_f32_32x32x16_bf16 v[68:83], v[56:59], v[52:55], v[68:83]
    ds_read_b128 v[36:39], v30 offset:16384
    ds_read_b64_tr_b16 v[40:41], v32 offset:6144
    ds_read_b64_tr_b16 v[42:43], v32 offset:6912
    ds_read_b64_tr_b16 v[44:45], v32 offset:6200
    v_mfma_f32_32x32x16_bf16 v[84:99], v[60:63], v[52:55], v[84:99]
    ds_read_b64_tr_b16 v[46:47], v32 offset:6968
    ds_read_b64_tr_b16 v[48:49], v32 offset:6256
    ds_read_b64_tr_b16 v[50:51], v32 offset:7024
    v_mfma_f32_32x32x16_bf16 v[100:115], v[52:55], v[64:67], v[100:115]
    s_waitcnt lgkmcnt(0)
    v_mfma_f32_32x32x16_bf16 v[68:83], v[40:43], v[36:39], v[68:83]
    ds_read_b128 v[52:55], v31 offset:16384
    ds_read_b64_tr_b16 v[56:57], v32 offset:9216
    ds_read_b64_tr_b16 v[58:59], v32 offset:9984
    ds_read_b64_tr_b16 v[60:61], v32 offset:9272
    v_mfma_f32_32x32x16_bf16 v[84:99], v[44:47], v[36:39], v[84:99]
    ds_read_b64_tr_b16 v[62:63], v32 offset:10040
    ds_read_b64_tr_b16 v[64:65], v32 offset:9328
    ds_read_b64_tr_b16 v[66:67], v32 offset:10096
    v_mfma_f32_32x32x16_bf16 v[100:115], v[36:39], v[48:51], v[100:115]
    s_waitcnt lgkmcnt(0)
    v_mfma_f32_32x32x16_bf16 v[68:83], v[56:59], v[52:55], v[68:83]
    s_barrier
    ds_read_b128 v[36:39], v28 offset:32768
    ds_read_b64_tr_b16 v[40:41], v32 offset:12288
    ds_read_b64_tr_b16 v[42:43], v32 offset:13056
    ds_read_b64_tr_b16 v[44:45], v32 offset:12344
    v_mfma_f32_32x32x16_bf16 v[84:99], v[60:63], v[52:55], v[84:99]
    ds_read_b64_tr_b16 v[46:47], v32 offset:13112
    ds_read_b64_tr_b16 v[48:49], v32 offset:12400
    ds_read_b64_tr_b16 v[50:51], v32 offset:13168
    v_mfma_f32_32x32x16_bf16 v[100:115], v[52:55], v[64:67], v[100:115]
    s_waitcnt lgkmcnt(0)
    v_mfma_f32_32x32x16_bf16 v[68:83], v[40:43], v[36:39], v[68:83]
    ds_read_b128 v[52:55], v29 offset:32768
    ds_read_b64_tr_b16 v[56:57], v32 offset:15360
    ds_read_b64_tr_b16 v[58:59], v32 offset:16128
    ds_read_b64_tr_b16 v[60:61], v32 offset:15416
    v_mfma_f32_32x32x16_bf16 v[84:99], v[44:47], v[36:39], v[84:99]
    ds_read_b64_tr_b16 v[62:63], v32 offset:16184
    ds_read_b64_tr_b16 v[64:65], v32 offset:15472
    ds_read_b64_tr_b16 v[66:67], v32 offset:16240
    v_mfma_f32_32x32x16_bf16 v[100:115], v[36:39], v[48:51], v[100:115]
    s_waitcnt lgkmcnt(0)
    v_mfma_f32_32x32x16_bf16 v[68:83], v[56:59], v[52:55], v[68:83]
    ds_read_b128 v[36:39], v30 offset:32768
    ds_read_b64_tr_b16 v[40:41], v32 offset:18432
    ds_read_b64_tr_b16 v[42:43], v32 offset:19200
    ds_read_b64_tr_b16 v[44:45], v32 offset:18488
    v_mfma_f32_32x32x16_bf16 v[84:99], v[60:63], v[52:55], v[84:99]
    ds_read_b64_tr_b16 v[46:47], v32 offset:19256
    ds_read_b64_tr_b16 v[48:49], v32 offset:18544
    ds_read_b64_tr_b16 v[50:51], v32 offset:19312
    v_mfma_f32_32x32x16_bf16 v[100:115], v[52:55], v[64:67], v[100:115]
    s_waitcnt lgkmcnt(0)
    v_mfma_f32_32x32x16_bf16 v[68:83], v[40:43], v[36:39], v[68:83]
    ds_read_b128 v[52:55], v31 offset:32768
    ds_read_b64_tr_b16 v[56:57], v32 offset:21504
    ds_read_b64_tr_b16 v[58:59], v32 offset:22272
    ds_read_b64_tr_b16 v[60:61], v32 offset:21560
    v_mfma_f32_32x32x16_bf16 v[84:99], v[44:47], v[36:39], v[84:99]
    ds_read_b64_tr_b16 v[62:63], v32 offset:22328
    ds_read_b64_tr_b16 v[64:65], v32 offset:21616
    ds_read_b64_tr_b16 v[66:67], v32 offset:22384
    v_mfma_f32_32x32x16_bf16 v[100:115], v[36:39], v[48:51], v[100:115]
    s_waitcnt lgkmcnt(0)
    v_mfma_f32_32x32x16_bf16 v[68:83], v[56:59], v[52:55], v[68:83]
    v_mfma_f32_32x32x16_bf16 v[84:99], v[60:63], v[52:55], v[84:99]
    v_mfma_f32_32x32x16_bf16 v[100:115], v[52:55], v[64:67], v[100:115]
    s_barrier
    s_barrier
    s_nop 9
    v_cvt_pk_bf16_f32 v100, v100, v101
    v_cvt_pk_bf16_f32 v101, v102, v103
    v_cvt_pk_bf16_f32 v102, v104, v105
    v_cvt_pk_bf16_f32 v103, v106, v107
    v_cvt_pk_bf16_f32 v104, v108, v109
    v_cvt_pk_bf16_f32 v105, v110, v111
    v_cvt_pk_bf16_f32 v106, v112, v113
    v_cvt_pk_bf16_f32 v107, v114, v115
    s_mov_b32 exec_lo, 0xf0000000
    s_mov_b32 exec_hi, 0xf0000000
    v_mov_b32 v100, v33
    v_mov_b32 v101, v33
    v_mov_b32 v102, v33
    v_mov_b32 v103, v33
    v_mov_b32 v104, v33
    v_mov_b32 v105, v33
    v_mov_b32 v106, v33
    v_mov_b32 v107, v33
    s_mov_b64 exec, -1
    buffer_store_dwordx4 v[100:103], v2, s[24:27], s46 offen sc1
    buffer_store_dwordx4 v[104:107], v2, s[24:27], s46 offen offset:1024 sc1
    v_cvt_pk_bf16_f32 v84, v84, v85
    v_cvt_pk_bf16_f32 v85, v86, v87
    v_cvt_pk_bf16_f32 v86, v88, v89
    v_cvt_pk_bf16_f32 v87, v90, v91
    v_cvt_pk_bf16_f32 v88, v92, v93
    v_cvt_pk_bf16_f32 v89, v94, v95
    v_cvt_pk_bf16_f32 v90, v96, v97
    v_cvt_pk_bf16_f32 v91, v98, v99
    s_mov_b32 exec_lo, 0
    v_mov_b32 v90, 0x3f803f80
    v_mov_b32 v91, 0x3f80
    s_mov_b64 exec, -1
    buffer_store_dwordx4 v[84:87], v2, s[24:27], s45 offen sc1
    buffer_store_dwordx4 v[88:91], v2, s[24:27], s45 offen offset:1024 sc1
    v_cvt_pk_bf16_f32 v68, v68, v69
    v_cvt_pk_bf16_f32 v69, v70, v71
    v_cvt_pk_bf16_f32 v70, v72, v73
    v_cvt_pk_bf16_f32 v71, v74, v75
    v_cvt_pk_bf16_f32 v72, v76, v77
    v_cvt_pk_bf16_f32 v73, v78, v79
    v_cvt_pk_bf16_f32 v74, v80, v81
    v_cvt_pk_bf16_f32 v75, v82, v83
    s_mov_b32 exec_lo, 0
    v_mov_b32 v74, 0x3f803f80
    v_mov_b32 v75, 0x3f80
    s_mov_b64 exec, -1
    buffer_store_dwordx4 v[68:71], v2, s[24:27], s44 offen sc1
    buffer_store_dwordx4 v[72:75], v2, s[24:27], s44 offen offset:1024 sc1
    s_branch KF_EPI1
KF_V1_vvv:
    s_add_u32 s40, s43, 0
    s_and_b32 s40, s40, 15
    s_lshl_b32 s40, s40, 6
    s_add_u32 s40, s40, s41
    s_lshl_b32 s40, s40, 12
    s_add_u32 s40, s40, s42
    s_add_u32 s44, s40, 2099200
    s_add_u32 s40, s43, 1
    s_and_b32 s40, s40, 15
    s_lshl_b32 s40, s40, 6
    s_add_u32 s40, s40, s41
    s_lshl_b32 s40, s40, 12
    s_add_u32 s40, s40, s42
    s_add_u32 s45, s40, 2099200
    s_add_u32 s40, s43, 2
    s_and_b32 s40, s40, 15
    s_lshl_b32 s40, s40, 6
    s_add_u32 s40, s40, s41
    s_lshl_b32 s40, s40, 12
    s_add_u32 s40, s40, s42
    s_add_u32 s46, s40, 2099200
    s_barrier
    ds_read_b128 v[36:39], v24 offset:0
    ds_read_b64_tr_b16 v[40:41], v32 offset:12288
    ds_read_b64_tr_b16 v[42:43], v32 offset:13056
    ds_read_b64_tr_b16 v[44:45], v32 offset:12344
    ds_read_b64_tr_b16 v[46:47], v32 offset:13112
    ds_read_b64_tr_b16 v[48:49], v32 offset:12400
    ds_read_b64_tr_b16 v[50:51], v32 offset:13168
    s_waitcnt lgkmcnt(0)
    v_mfma_f32_32x32x16_bf16 v[68:83], v[36:39], v[40:43], 0
    ds_read_b128 v[52:55], v25 offset:0
    ds_read_b64_tr_b16 v[56:57], v32 offset:15360
    ds_read_b64_tr_b16 v[58:59], v32 offset:16128
    ds_read_b64_tr_b16 v[60:61], v32 offset:15416
    v_mfma_f32_32x32x16_bf16 v[84:99], v[36:39], v[44:47], 0
    ds_read_b64_tr_b16 v[62:63], v32 offset:16184
    ds_read_b64_tr_b16 v[64:65], v32 offset:15472
    ds_read_b64_tr_b16 v[66:67], v32 offset:16240
    v_mfma_f32_32x32x16_bf16 v[100:115], v[36:39], v[48:51], 0
    s_waitcnt lgkmcnt(0)
    v_mfma_f32_32x32x16_bf16 v[68:83], v[52:55], v[56:59], v[68:83]
    ds_read_b128 v[36:39], v26 offset:0
    ds_read_b64_tr_b16 v[40:41], v32 offset:18432
    ds_read_b64_tr_b16 v[42:43], v32 offset:19200
    ds_read_b64_tr_b16 v[44:45], v32 offset:18488
    v_mfma_f32_32x32x16_bf16 v[84:99], v[52:55], v[60:63], v[84:99]
    ds_read_b64_tr_b16 v[46:47], v32 offset:19256
    ds_read_b64_tr_b16 v[48:49], v32 offset:18544
    ds_read_b64_tr_b16 v[50:51], v32 offset:19312
    v_mfma_f32_32x32x16_bf16 v[100:115], v[52:55], v[64:67], v[100:115]
    s_waitcnt lgkmcnt(0)
    v_mfma_f32_32x32x16_bf16 v[68:83], v[36:39], v[40:43], v[68:83]
    ds_read_b128 v[52:55], v27 offset:0
    ds_read_b64_tr_b16 v[56:57], v32 offset:21504
    ds_read_b64_tr_b16 v[58:59], v32 offset:22272
    ds_read_b64_tr_b16 v[60:61], v32 offset:21560
    v_mfma_f32_32x32x16_bf16 v[84:99], v[36:39], v[44:47], v[84:99]
    ds_read_b64_tr_b16 v[62:63], v32 offset:22328
    ds_read_b64_tr_b16 v[64:65], v32 offset:21616
    ds_read_b64_tr_b16 v[66:67], v32 offset:22384
    v_mfma_f32_32x32x16_bf16 v[100:115], v[36:39], v[48:51], v[100:115]
    s_waitcnt lgkmcnt(0)
    v_mfma_f32_32x32x16_bf16 v[68:83], v[52:55], v[56:59], v[68:83]
    s_barrier
    ds_read_b128 v[36:39], v24 offset:16384
    ds_read_b64_tr_b16 v[40:41], v32 offset:24576
    ds_read_b64_tr_b16 v[42:43], v32 offset:25344
    ds_read_b64_tr_b16 v[44:45], v32 offset:24632
    v_mfma_f32_32x32x16_bf16 v[84:99], v[52:55], v[60:63], v[84:99]
    ds_read_b64_tr_b16 v[46:47], v32 offset:25400
    ds_read_b64_tr_b16 v[48:49], v32 offset:24688
    ds_read_b64_tr_b16 v[50:51], v32 offset:25456
    v_mfma_f32_32x32x16_bf16 v[100:115], v[52:55], v[64:67], v[100:115]
    s_waitcnt lgkmcnt(0)
    v_mfma_f32_32x32x16_bf16 v[68:83], v[36:39], v[40:43], v[68:83]
    ds_read_b128 v[52:55], v25 offset:16384
    ds_read_b64_tr_b16 v[56:57], v32 offset:27648
    ds_read_b64_tr_b16 v[58:59], v32 offset:28416
    ds_read_b64_tr_b16 v[60:61], v32 offset:27704
    v_mfma_f32_32x32x16_bf16 v[84:99], v[36:39], v[44:47], v[84:99]
    ds_read_b64_tr_b16 v[62:63], v32 offset:28472
    ds_read_b64_tr_b16 v[64:65], v32 offset:27760
    ds_read_b64_tr_b16 v[66:67], v32 offset:28528
    v_mfma_f32_32x32x16_bf16 v[100:115], v[36:39], v[48:51], v[100:115]
    s_waitcnt lgkmcnt(0)
    v_mfma_f32_32x32x16_bf16 v[68:83], v[52:55], v[56:59], v[68:83]
    ds_read_b128 v[36:39], v26 offset:16384
    ds_read_b64_tr_b16 v[40:41], v32 offset:30720
    ds_read_b64_tr_b16 v[42:43], v32 offset:31488
    ds_read_b64_tr_b16 v[44:45], v32 offset:30776
    v_mfma_f32_32x32x16_bf16 v[84:99], v[52:55], v[60:63], v[84:99]
    ds_read_b64_tr_b16 v[46:47], v32 offset:31544
    ds_read_b64_tr_b16 v[48:49], v32 offset:30832
    ds_read_b64_tr_b16 v[50:51], v32 offset:31600
    v_mfma_f32_32x32x16_bf16 v[100:115], v[52:55], v[64:67], v[100:115]
    s_waitcnt lgkmcnt(0)
    v_mfma_f32_32x32x16_bf16 v[68:83], v[36:39], v[40:43], v[68:83]
    ds_read_b128 v[52:55], v27 offset:16384
    ds_read_b64_tr_b16 v[56:57], v32 offset:33792
    ds_read_b64_tr_b16 v[58:59], v32 offset:34560
    ds_read_b64_tr_b16 v[60:61], v32 offset:33848
    v_mfma_f32_32x32x16_bf16 v[84:99], v[36:39], v[44:47], v[84:99]
    ds_read_b64_tr_b16 v[62:63], v32 offset:34616
    ds_read_b64_tr_b16 v[64:65], v32 offset:33904
    ds_read_b64_tr_b16 v[66:67], v32 offset:34672
    v_mfma_f32_32x32x16_bf16 v[100:115], v[36:39], v[48:51], v[100:115]
    s_waitcnt lgkmcnt(0)
    v_mfma_f32_32x32x16_bf16 v[68:83], v[52:55], v[56:59], v[68:83]
    s_barrier
    ds_read_b128 v[36:39], v24 offset:32768
    ds_read_b64_tr_b16 v[40:41], v32 offset:0
    ds_read_b64_tr_b16 v[42:43], v32 offset:768
    ds_read_b64_tr_b16 v[44:45], v32 offset:56
    v_mfma_f32_32x32x16_bf16 v[84:99], v[52:55], v[60:63], v[84:99]
    ds_read_b64_tr_b16 v[46:47], v32 offset:824
    ds_read_b64_tr_b16 v[48:49], v32 offset:112
    ds_read_b64_tr_b16 v[50:51], v32 offset:880
    v_mfma_f32_32x32x16_bf16 v[100:115], v[52:55], v[64:67], v[100:115]
    s_waitcnt lgkmcnt(0)
    v_mfma_f32_32x32x16_bf16 v[68:83], v[36:39], v[40:43], v[68:83]
    ds_read_b128 v[52:55], v25 offset:32768
    ds_read_b64_tr_b16 v[56:57], v32 offset:3072
    ds_read_b64_tr_b16 v[58:59], v32 offset:3840
    ds_read_b64_tr_b16 v[60:61], v32 offset:3128
    v_mfma_f32_32x32x16_bf16 v[84:99], v[36:39], v[44:47], v[84:99]
    ds_read_b64_tr_b16 v[62:63], v32 offset:3896
    ds_read_b64_tr_b16 v[64:65], v32 offset:3184
    ds_read_b64_tr_b16 v[66:67], v32 offset:3952
    v_mfma_f32_32x32x16_bf16 v[100:115], v[36:39], v[48:51], v[100:115]
    s_waitcnt lgkmcnt(0)
    v_mfma_f32_32x32x16_bf16 v[68:83], v[52:55], v[56:59], v[68:83]
    ds_read_b128 v[36:39], v26 offset:32768
    ds_read_b64_tr_b16 v[40:41], v32 offset:6144
    ds_read_b64_tr_b16 v[42:43], v32 offset:6912
    ds_read_b64_tr_b16 v[44:45], v32 offset:6200
    v_mfma_f32_32x32x16_bf16 v[84:99], v[52:55], v[60:63], v[84:99]
    ds_read_b64_tr_b16 v[46:47], v32 offset:6968
    ds_read_b64_tr_b16 v[48:49], v32 offset:6256
    ds_read_b64_tr_b16 v[50:51], v32 offset:7024
    v_mfma_f32_32x32x16_bf16 v[100:115], v[52:55], v[64:67], v[100:115]
    s_waitcnt lgkmcnt(0)
    v_mfma_f32_32x32x16_bf16 v[68:83], v[36:39], v[40:43], v[68:83]
    ds_read_b128 v[52:55], v27 offset:32768
    ds_read_b64_tr_b16 v[56:57], v32 offset:9216
    ds_read_b64_tr_b16 v[58:59], v32 offset:9984
    ds_read_b64_tr_b16 v[60:61], v32 offset:9272
    v_mfma_f32_32x32x16_bf16 v[84:99], v[36:39], v[44:47], v[84:99]
    ds_read_b64_tr_b16 v[62:63], v32 offset:10040
    ds_read_b64_tr_b16 v[64:65], v32 offset:9328
    ds_read_b64_tr_b16 v[66:67], v32 offset:10096
    v_mfma_f32_32x32x16_bf16 v[100:115], v[36:39], v[48:51], v[100:115]
    s_waitcnt lgkmcnt(0)
    v_mfma_f32_32x32x16_bf16 v[68:83], v[52:55], v[56:59], v[68:83]
    s_barrier
    ds_read_b128 v[36:39], v24 offset:49152
    ds_read_b64_tr_b16 v[40:41], v32 offset:12288
    ds_read_b64_tr_b16 v[42:43], v32 offset:13056
    ds_read_b64_tr_b16 v[44:45], v32 offset:12344
    v_mfma_f32_32x32x16_bf16 v[84:99], v[52:55], v[60:63], v[84:99]
    ds_read_b64_tr_b16 v[46:47], v32 offset:13112
    ds_read_b64_tr_b16 v[48:49], v32 offset:12400
    ds_read_b64_tr_b16 v[50:51], v32 offset:13168
    v_mfma_f32_32x32x16_bf16 v[100:115], v[52:55], v[64:67], v[100:115]
    s_waitcnt lgkmcnt(0)
    v_mfma_f32_32x32x16_bf16 v[68:83], v[36:39], v[40:43], v[68:83]
    ds_read_b128 v[52:55], v25 offset:49152
    ds_read_b64_tr_b16 v[56:57], v32 offset:15360
    ds_read_b64_tr_b16 v[58:59], v32 offset:16128
    ds_read_b64_tr_b16 v[60:61], v32 offset:15416
    v_mfma_f32_32x32x16_bf16 v[84:99], v[36:39], v[44:47], v[84:99]
    ds_read_b64_tr_b16 v[62:63], v32 offset:16184
    ds_read_b64_tr_b16 v[64:65], v32 offset:15472
    ds_read_b64_tr_b16 v[66:67], v32 offset:16240
    v_mfma_f32_32x32x16_bf16 v[100:115], v[36:39], v[48:51], v[100:115]
    s_waitcnt lgkmcnt(0)
    v_mfma_f32_32x32x16_bf16 v[68:83], v[52:55], v[56:59], v[68:83]
    ds_read_b128 v[36:39], v26 offset:49152
    ds_read_b64_tr_b16 v[40:41], v32 offset:18432
    ds_read_b64_tr_b16 v[42:43], v32 offset:19200
    ds_read_b64_tr_b16 v[44:45], v32 offset:18488
    v_mfma_f32_32x32x16_bf16 v[84:99], v[52:55], v[60:63], v[84:99]
    ds_read_b64_tr_b16 v[46:47], v32 offset:19256
    ds_read_b64_tr_b16 v[48:49], v32 offset:18544
    ds_read_b64_tr_b16 v[50:51], v32 offset:19312
    v_mfma_f32_32x32x16_bf16 v[100:115], v[52:55], v[64:67], v[100:115]
    s_waitcnt lgkmcnt(0)
    v_mfma_f32_32x32x16_bf16 v[68:83], v[36:39], v[40:43], v[68:83]
    ds_read_b128 v[52:55], v27 offset:49152
    ds_read_b64_tr_b16 v[56:57], v32 offset:21504
    ds_read_b64_tr_b16 v[58:59], v32 offset:22272
    ds_read_b64_tr_b16 v[60:61], v32 offset:21560
    v_mfma_f32_32x32x16_bf16 v[84:99], v[36:39], v[44:47], v[84:99]
    ds_read_b64_tr_b16 v[62:63], v32 offset:22328
    ds_read_b64_tr_b16 v[64:65], v32 offset:21616
    ds_read_b64_tr_b16 v[66:67], v32 offset:22384
    v_mfma_f32_32x32x16_bf16 v[100:115], v[36:39], v[48:51], v[100:115]
    s_waitcnt lgkmcnt(0)
    v_mfma_f32_32x32x16_bf16 v[68:83], v[52:55], v[56:59], v[68:83]
    s_barrier
    ds_read_b128 v[36:39], v28 offset:0
    ds_read_b64_tr_b16 v[40:41], v32 offset:24576
    ds_read_b64_tr_b16 v[42:43], v32 offset:25344
    ds_read_b64_tr_b16 v[44:45], v32 offset:24632
    v_mfma_f32_32x32x16_bf16 v[84:99], v[52:55], v[60:63], v[84:99]
    ds_read_b64_tr_b16 v[46:47], v32 offset:25400
    ds_read_b64_tr_b16 v[48:49], v32 offset:24688
    ds_read_b64_tr_b16 v[50:51], v32 offset:25456
    v_mfma_f32_32x32x16_bf16 v[100:115], v[52:55], v[64:67], v[100:115]
    s_waitcnt lgkmcnt(0)
    v_mfma_f32_32x32x16_bf16 v[68:83], v[36:39], v[40:43], v[68:83]
    ds_read_b128 v[52:55], v29 offset:0
    ds_read_b64_tr_b16 v[56:57], v32 offset:27648
    ds_read_b64_tr_b16 v[58:59], v32 offset:28416
    ds_read_b64_tr_b16 v[60:61], v32 offset:27704
    v_mfma_f32_32x32x16_bf16 v[84:99], v[36:39], v[44:47], v[84:99]
    ds_read_b64_tr_b16 v[62:63], v32 offset:28472
    ds_read_b64_tr_b16 v[64:65], v32 offset:27760
    ds_read_b64_tr_b16 v[66:67], v32 offset:28528
    v_mfma_f32_32x32x16_bf16 v[100:115], v[36:39], v[48:51], v[100:115]
    s_waitcnt lgkmcnt(0)
    v_mfma_f32_32x32x16_bf16 v[68:83], v[52:55], v[56:59], v[68:83]
    ds_read_b128 v[36:39], v30 offset:0
    ds_read_b64_tr_b16 v[40:41], v32 offset:30720
    ds_read_b64_tr_b16 v[42:43], v32 offset:31488
    ds_read_b64_tr_b16 v[44:45], v32 offset:30776
    v_mfma_f32_32x32x16_bf16 v[84:99], v[52:55], v[60:63], v[84:99]
    ds_read_b64_tr_b16 v[46:47], v32 offset:31544
    ds_read_b64_tr_b16 v[48:49], v32 offset:30832
    ds_read_b64_tr_b16 v[50:51], v32 offset:31600
    v_mfma_f32_32x32x16_bf16 v[100:115], v[52:55], v[64:67], v[100:115]
    s_waitcnt lgkmcnt(0)
    v_mfma_f32_32x32x16_bf16 v[68:83], v[36:39], v[40:43], v[68:83]
    ds_read_b128 v[52:55], v31 offset:0
    ds_read_b64_tr_b16 v[56:57], v32 offset:33792
    ds_read_b64_tr_b16 v[58:59], v32 offset:34560
    ds_read_b64_tr_b16 v[60:61], v32 offset:33848
    v_mfma_f32_32x32x16_bf16 v[84:99], v[36:39], v[44:47], v[84:99]
    ds_read_b64_tr_b16 v[62:63], v32 offset:34616
    ds_read_b64_tr_b16 v[64:65], v32 offset:33904
    ds_read_b64_tr_b16 v[66:67], v32 offset:34672
    v_mfma_f32_32x32x16_bf16 v[100:115], v[36:39], v[48:51], v[100:115]
    s_waitcnt lgkmcnt(0)
    v_mfma_f32_32x32x16_bf16 v[68:83], v[52:55], v[56:59], v[68:83]
    s_barrier
    ds_read_b128 v[36:39], v28 offset:16384
    ds_read_b64_tr_b16 v[40:41], v32 offset:0
    ds_read_b64_tr_b16 v[42:43], v32 offset:768
    ds_read_b64_tr_b16 v[44:45], v32 offset:56
    v_mfma_f32_32x32x16_bf16 v[84:99], v[52:55], v[60:63], v[84:99]
    ds_read_b64_tr_b16 v[46:47], v32 offset:824
    ds_read_b64_tr_b16 v[48:49], v32 offset:112
    ds_read_b64_tr_b16 v[50:51], v32 offset:880
    v_mfma_f32_32x32x16_bf16 v[100:115], v[52:55], v[64:67], v[100:115]
    s_waitcnt lgkmcnt(0)
    v_mfma_f32_32x32x16_bf16 v[68:83], v[36:39], v[40:43], v[68:83]
    ds_read_b128 v[52:55], v29 offset:16384
    ds_read_b64_tr_b16 v[56:57], v32 offset:3072
    ds_read_b64_tr_b16 v[58:59], v32 offset:3840
    ds_read_b64_tr_b16 v[60:61], v32 offset:3128
    v_mfma_f32_32x32x16_bf16 v[84:99], v[36:39], v[44:47], v[84:99]
    ds_read_b64_tr_b16 v[62:63], v32 offset:3896
    ds_read_b64_tr_b16 v[64:65], v32 offset:3184
    ds_read_b64_tr_b16 v[66:67], v32 offset:3952
    v_mfma_f32_32x32x16_bf16 v[100:115], v[36:39], v[48:51], v[100:115]
    s_waitcnt lgkmcnt(0)
    v_mfma_f32_32x32x16_bf16 v[68:83], v[52:55], v[56:59], v[68:83]
    ds_read_b128 v[36:39], v30 offset:16384
    ds_read_b64_tr_b16 v[40:41], v32 offset:6144
    ds_read_b64_tr_b16 v[42:43], v32 offset:6912
    ds_read_b64_tr_b16 v[44:45], v32 offset:6200
    v_mfma_f32_32x32x16_bf16 v[84:99], v[52:55], v[60:63], v[84:99]
    ds_read_b64_tr_b16 v[46:47], v32 offset:6968
    ds_read_b64_tr_b16 v[48:49], v32 offset:6256
    ds_read_b64_tr_b16 v[50:51], v32 offset:7024
    v_mfma_f32_32x32x16_bf16 v[100:115], v[52:55], v[64:67], v[100:115]
    s_waitcnt lgkmcnt(0)
    v_mfma_f32_32x32x16_bf16 v[68:83], v[36:39], v[40:43], v[68:83]
    ds_read_b128 v[52:55], v31 offset:16384
    ds_read_b64_tr_b16 v[56:57], v32 offset:9216
    ds_read_b64_tr_b16 v[58:59], v32 offset:9984
    ds_read_b64_tr_b16 v[60:61], v32 offset:9272
    v_mfma_f32_32x32x16_bf16 v[84:99], v[36:39], v[44:47], v[84:99]
    ds_read_b64_tr_b16 v[62:63], v32 offset:10040
    ds_read_b64_tr_b16 v[64:65], v32 offset:9328
    ds_read_b64_tr_b16 v[66:67], v32 offset:10096
    v_mfma_f32_32x32x16_bf16 v[100:115], v[36:39], v[48:51], v[100:115]
    s_waitcnt lgkmcnt(0)
    v_mfma_f32_32x32x16_bf16 v[68:83], v[52:55], v[56:59], v[68:83]
    s_barrier
    ds_read_b128 v[36:39], v28 offset:32768
    ds_read_b64_tr_b16 v[40:41], v32 offset:12288
    ds_read_b64_tr_b16 v[42:43], v32 offset:13056
    ds_read_b64_tr_b16 v[44:45], v32 offset:12344
    v_mfma_f32_32x32x16_bf16 v[84:99], v[52:55], v[60:63], v[84:99]
    ds_read_b64_tr_b16 v[46:47], v32 offset:13112
    ds_read_b64_tr_b16 v[48:49], v32 offset:12400
    ds_read_b64_tr_b16 v[50:51], v32 offset:13168
    v_mfma_f32_32x32x16_bf16 v[100:115], v[52:55], v[64:67], v[100:115]
    s_waitcnt lgkmcnt(0)
    v_mfma_f32_32x32x16_bf16 v[68:83], v[36:39], v[40:43], v[68:83]
    ds_read_b128 v[52:55], v29 offset:32768
    ds_read_b64_tr_b16 v[56:57], v32 offset:15360
    ds_read_b64_tr_b16 v[58:59], v32 offset:16128
    ds_read_b64_tr_b16 v[60:61], v32 offset:15416
    v_mfma_f32_32x32x16_bf16 v[84:99], v[36:39], v[44:47], v[84:99]
    ds_read_b64_tr_b16 v[62:63], v32 offset:16184
    ds_read_b64_tr_b16 v[64:65], v32 offset:15472
    ds_read_b64_tr_b16 v[66:67], v32 offset:16240
    v_mfma_f32_32x32x16_bf16 v[100:115], v[36:39], v[48:51], v[100:115]
    s_waitcnt lgkmcnt(0)
    v_mfma_f32_32x32x16_bf16 v[68:83], v[52:55], v[56:59], v[68:83]
    ds_read_b128 v[36:39], v30 offset:32768
    ds_read_b64_tr_b16 v[40:41], v32 offset:18432
    ds_read_b64_tr_b16 v[42:43], v32 offset:19200
    ds_read_b64_tr_b16 v[44:45], v32 offset:18488
    v_mfma_f32_32x32x16_bf16 v[84:99], v[52:55], v[60:63], v[84:99]
    ds_read_b64_tr_b16 v[46:47], v32 offset:19256
    ds_read_b64_tr_b16 v[48:49], v32 offset:18544
    ds_read_b64_tr_b16 v[50:51], v32 offset:19312
    v_mfma_f32_32x32x16_bf16 v[100:115], v[52:55], v[64:67], v[100:115]
    s_waitcnt lgkmcnt(0)
    v_mfma_f32_32x32x16_bf16 v[68:83], v[36:39], v[40:43], v[68:83]
    ds_read_b128 v[52:55], v31 offset:32768
    ds_read_b64_tr_b16 v[56:57], v32 offset:21504
    ds_read_b64_tr_b16 v[58:59], v32 offset:22272
    ds_read_b64_tr_b16 v[60:61], v32 offset:21560
    v_mfma_f32_32x32x16_bf16 v[84:99], v[36:39], v[44:47], v[84:99]
    ds_read_b64_tr_b16 v[62:63], v32 offset:22328
    ds_read_b64_tr_b16 v[64:65], v32 offset:21616
    ds_read_b64_tr_b16 v[66:67], v32 offset:22384
    v_mfma_f32_32x32x16_bf16 v[100:115], v[36:39], v[48:51], v[100:115]
    s_waitcnt lgkmcnt(0)
    v_mfma_f32_32x32x16_bf16 v[68:83], v[52:55], v[56:59], v[68:83]
    v_mfma_f32_32x32x16_bf16 v[84:99], v[52:55], v[60:63], v[84:99]
    v_mfma_f32_32x32x16_bf16 v[100:115], v[52:55], v[64:67], v[100:115]
    s_barrier
    s_barrier
    s_nop 9
    v_cvt_pk_bf16_f32 v100, v100, v101
    v_cvt_pk_bf16_f32 v101, v102, v103
    v_cvt_pk_bf16_f32 v102, v104, v105
    v_cvt_pk_bf16_f32 v103, v106, v107
    v_cvt_pk_bf16_f32 v104, v108, v109
    v_cvt_pk_bf16_f32 v105, v110, v111
    v_cvt_pk_bf16_f32 v106, v112, v113
    v_cvt_pk_bf16_f32 v107, v114, v115
    s_mov_b32 exec_lo, 0xf0000000
    s_mov_b32 exec_hi, 0xf0000000
    v_mov_b32 v100, v33
    v_mov_b32 v101, v33
    v_mov_b32 v102, v33
    v_mov_b32 v103, v33
    v_mov_b32 v104, v33
    v_mov_b32 v105, v33
    v_mov_b32 v106, v33
    v_mov_b32 v107, v33
    s_mov_b64 exec, -1
    buffer_store_dwordx4 v[100:103], v2, s[24:27], s46 offen sc1
    buffer_store_dwordx4 v[104:107], v2, s[24:27], s46 offen offset:1024 sc1
    v_cvt_pk_bf16_f32 v84, v84, v85
    v_cvt_pk_bf16_f32 v85, v86, v87
    v_cvt_pk_bf16_f32 v86, v88, v89
    v_cvt_pk_bf16_f32 v87, v90, v91
    v_cvt_pk_bf16_f32 v88, v92, v93
    v_cvt_pk_bf16_f32 v89, v94, v95
    v_cvt_pk_bf16_f32 v90, v96, v97
    v_cvt_pk_bf16_f32 v91, v98, v99
    s_mov_b32 exec_lo, 0xf0000000
    s_mov_b32 exec_hi, 0xf0000000
    v_mov_b32 v84, v33
    v_mov_b32 v85, v33
    v_mov_b32 v86, v33
    v_mov_b32 v87, v33
    v_mov_b32 v88, v33
    v_mov_b32 v89, v33
    v_mov_b32 v90, v33
    v_mov_b32 v91, v33
    s_mov_b64 exec, -1
    buffer_store_dwordx4 v[84:87], v2, s[24:27], s45 offen sc1
    buffer_store_dwordx4 v[88:91], v2, s[24:27], s45 offen offset:1024 sc1
    v_cvt_pk_bf16_f32 v68, v68, v69
    v_cvt_pk_bf16_f32 v69, v70, v71
    v_cvt_pk_bf16_f32 v70, v72, v73
    v_cvt_pk_bf16_f32 v71, v74, v75
    v_cvt_pk_bf16_f32 v72, v76, v77
    v_cvt_pk_bf16_f32 v73, v78, v79
    v_cvt_pk_bf16_f32 v74, v80, v81
    v_cvt_pk_bf16_f32 v75, v82, v83
    s_mov_b32 exec_lo, 0xf0000000
    s_mov_b32 exec_hi, 0xf0000000
    v_mov_b32 v68, v33
    v_mov_b32 v69, v33
    v_mov_b32 v70, v33
    v_mov_b32 v71, v33
    v_mov_b32 v72, v33
    v_mov_b32 v73, v33
    v_mov_b32 v74, v33
    v_mov_b32 v75, v33
    s_mov_b64 exec, -1
    buffer_store_dwordx4 v[68:71], v2, s[24:27], s44 offen sc1
    buffer_store_dwordx4 v[72:75], v2, s[24:27], s44 offen offset:1024 sc1
    s_branch KF_EPI1
KF_EPI1:
    s_mov_b32 s55, 1
    s_branch KF_MAIN
KF_RESTART:
KF_FIRST:
    s_mov_b32 s55, 0
    s_barrier
KF_MAIN:
    s_cmp_lg_u32 s53, 0
    s_cbranch_scc1 KF_NOQ
    ds_read_b128 v[12:15], v9
    ds_read_b128 v[16:19], v9 offset:1024
KF_NOQ:
    ds_read_b128 v[20:23], v2
    ds_read_b128 v[24:27], v2 offset:1024
    v_mov_b32 v76, 0
    v_mov_b32 v77, 0
    v_mov_b32 v78, 0
    v_mov_b32 v79, 0
    v_mov_b32 v80, 0
    v_mov_b32 v81, 0
    v_mov_b32 v82, 0
    v_mov_b32 v83, 0
    v_mov_b32 v84, 0
    v_mov_b32 v85, 0
    v_mov_b32 v86, 0
    v_mov_b32 v87, 0
    v_mov_b32 v88, 0
    v_mov_b32 v89, 0
    v_mov_b32 v90, 0
    v_mov_b32 v91, 0
    v_mov_b32 v40, 0
    v_mov_b32 v41, 0
    v_mov_b32 v42, 0
    v_mov_b32 v43, 0
    v_mov_b32 v32, 0
    v_mov_b32 v33, 0
    v_mov_b32 v34, 0
    v_mov_b32 v35, 0
    s_waitcnt lgkmcnt(0)
    s_cmp_lg_u32 s53, 0
    s_cbranch_scc1 KF_HAVEM
    v_mfma_f32_32x32x16_bf16 v[44:59], v[20:23], v[12:15], 0
    v_mfma_f32_32x32x16_bf16 v[44:59], v[24:27], v[16:19], v[44:59]
    s_nop 11
    v_max3_f32 v5, v44, v45, v46
    v_max3_f32 v5, v5, v47, v48
    v_max3_f32 v5, v5, v49, v50
    v_max3_f32 v5, v5, v51, v52
    v_max3_f32 v5, v5, v53, v54
    v_max3_f32 v5, v5, v55, v56
    v_max3_f32 v5, v5, v57, v58
    v_max_f32 v5, v5, v59
    v_mov_b32 v6, v5
    s_nop 1
    v_permlane32_swap_b32 v5, v6
    v_max_f32 v5, v5, v6
KF_HAVEM:
    ds_read_b128 v[20:23], v3
    ds_read_b128 v[24:27], v3 offset:1024
    v_sub_f32 v6, 0, v5
    v_and_b32 v7, 0xffff0000, v6
    v_sub_f32 v6, v6, v7
    v_and_b32 v1, 0xffff0000, v6
    v_sub_f32 v6, v6, v1
    v_lshrrev_b32 v7, 16, v7
    s_mov_b32 exec_lo, 0
    v_or_b32 v18, v7, v1
    v_lshrrev_b32 v19, 16, v6
    s_mov_b64 exec, -1
    s_waitcnt lgkmcnt(0)
    v_mfma_f32_32x32x16_bf16 v[44:59], v[20:23], v[12:15], 0
    v_mfma_f32_32x32x16_bf16 v[44:59], v[24:27], v[16:19], v[44:59]
    ds_read_b128 v[20:23], v3 offset:4096
    ds_read_b128 v[24:27], v3 offset:5120
    ds_read_b128 v[28:31], v3 offset:2048
    s_waitcnt lgkmcnt(0)
    s_nop 7
    v_mfma_f32_32x32x16_bf16 v[60:75], v[20:23], v[12:15], 0
    s_cmp_lg_u32 s55, 0
    s_cbranch_scc1 KF_SKIPB1
    s_barrier
KF_SKIPB1:
    ds_read_b128 v[20:23], v3 offset:16384
    v_exp_f32 v44, v44
    v_exp_f32 v45, v45
    v_exp_f32 v46, v46
    v_exp_f32 v47, v47
    v_mfma_f32_32x32x16_bf16 v[76:91], v[32:35], v[40:43], v[76:91]
    ds_read_b128 v[32:35], v3 offset:3072
    v_exp_f32 v48, v48
    v_exp_f32 v49, v49
    v_cvt_pk_bf16_f32 v36, v44, v45
    v_exp_f32 v50, v50
    v_cvt_pk_bf16_f32 v37, v46, v47
    v_exp_f32 v51, v51
    v_mfma_f32_32x32x16_bf16 v[60:75], v[24:27], v[16:19], v[60:75]
    ds_read_b128 v[24:27], v3 offset:17408
    v_exp_f32 v52, v52
    v_cvt_pk_bf16_f32 v38, v48, v49
    v_exp_f32 v53, v53
    v_cvt_pk_bf16_f32 v39, v50, v51
    v_exp_f32 v54, v54
    v_exp_f32 v55, v55
    v_mfma_f32_32x32x16_bf16 v[76:91], v[28:31], v[36:39], v[76:91]
    ds_read_b128 v[28:31], v3 offset:6144
    v_exp_f32 v56, v56
    v_exp_f32 v57, v57
    v_exp_f32 v58, v58
    v_exp_f32 v59, v59
    v_cvt_pk_bf16_f32 v40, v52, v53
    v_cvt_pk_bf16_f32 v41, v54, v55
    v_cvt_pk_bf16_f32 v42, v56, v57
    v_cvt_pk_bf16_f32 v43, v58, v59
    s_waitcnt lgkmcnt(3)
    v_mfma_f32_32x32x16_bf16 v[44:59], v[20:23], v[12:15], 0
    ds_read_b128 v[20:23], v3 offset:20480
    v_exp_f32 v60, v60
    v_exp_f32 v61, v61
    v_exp_f32 v62, v62
    v_exp_f32 v63, v63
    s_waitcnt lgkmcnt(3)
    v_mfma_f32_32x32x16_bf16 v[76:91], v[32:35], v[40:43], v[76:91]
    ds_read_b128 v[32:35], v3 offset:7168
    v_exp_f32 v64, v64
    v_exp_f32 v65, v65
    v_cvt_pk_bf16_f32 v36, v60, v61
    v_exp_f32 v66, v66
    v_cvt_pk_bf16_f32 v37, v62, v63
    v_exp_f32 v67, v67
    s_waitcnt lgkmcnt(3)
    v_mfma_f32_32x32x16_bf16 v[44:59], v[24:27], v[16:19], v[44:59]
    ds_read_b128 v[24:27], v3 offset:21504
    v_exp_f32 v68, v68
    v_cvt_pk_bf16_f32 v38, v64, v65
    v_exp_f32 v69, v69
    v_cvt_pk_bf16_f32 v39, v66, v67
    v_exp_f32 v70, v70
    v_exp_f32 v71, v71
    s_waitcnt lgkmcnt(3)
    v_mfma_f32_32x32x16_bf16 v[76:91], v[28:31], v[36:39], v[76:91]
    ds_read_b128 v[28:31], v3 offset:18432
    v_exp_f32 v72, v72
    v_exp_f32 v73, v73
    v_exp_f32 v74, v74
    v_exp_f32 v75, v75
    v_cvt_pk_bf16_f32 v40, v68, v69
    v_cvt_pk_bf16_f32 v41, v70, v71
    v_cvt_pk_bf16_f32 v42, v72, v73
    v_cvt_pk_bf16_f32 v43, v74, v75
    s_waitcnt lgkmcnt(3)
    v_mfma_f32_32x32x16_bf16 v[60:75], v[20:23], v[12:15], 0
    s_waitcnt lgkmcnt(2)
    s_barrier
    ds_read_b128 v[20:23], v3 offset:32768
    v_exp_f32 v44, v44
    v_exp_f32 v45, v45
    v_exp_f32 v46, v46
    v_exp_f32 v47, v47
    v_mfma_f32_32x32x16_bf16 v[76:91], v[32:35], v[40:43], v[76:91]
    ds_read_b128 v[32:35], v3 offset:19456
    v_exp_f32 v48, v48
    v_exp_f32 v49, v49
    v_cvt_pk_bf16_f32 v36, v44, v45
    v_exp_f32 v50, v50
    v_cvt_pk_bf16_f32 v37, v46, v47
    v_exp_f32 v51, v51
    s_waitcnt lgkmcnt(3)
    v_mfma_f32_32x32x16_bf16 v[60:75], v[24:27], v[16:19], v[60:75]
    ds_read_b128 v[24:27], v3 offset:33792
    v_exp_f32 v52, v52
    v_cvt_pk_bf16_f32 v38, v48, v49
    v_exp_f32 v53, v53
    v_cvt_pk_bf16_f32 v39, v50, v51
    v_exp_f32 v54, v54
    v_exp_f32 v55, v55
    s_waitcnt lgkmcnt(3)
    v_mfma_f32_32x32x16_bf16 v[76:91], v[28:31], v[36:39], v[76:91]
    ds_read_b128 v[28:31], v3 offset:22528
    v_exp_f32 v56, v56
    v_exp_f32 v57, v57
    v_exp_f32 v58, v58
    v_exp_f32 v59, v59
    v_cvt_pk_bf16_f32 v40, v52, v53
    v_cvt_pk_bf16_f32 v41, v54, v55
    v_cvt_pk_bf16_f32 v42, v56, v57
    v_cvt_pk_bf16_f32 v43, v58, v59
    s_waitcnt lgkmcnt(3)
    v_mfma_f32_32x32x16_bf16 v[44:59], v[20:23], v[12:15], 0
    ds_read_b128 v[20:23], v3 offset:36864
    v_exp_f32 v60, v60
    v_exp_f32 v61, v61
    v_exp_f32 v62, v62
    v_exp_f32 v63, v63
    s_waitcnt lgkmcnt(3)
    v_mfma_f32_32x32x16_bf16 v[76:91], v[32:35], v[40:43], v[76:91]
    ds_read_b128 v[32:35], v3 offset:23552
    v_exp_f32 v64, v64
    v_exp_f32 v65, v65
    v_cvt_pk_bf16_f32 v36, v60, v61
    v_exp_f32 v66, v66
    v_cvt_pk_bf16_f32 v37, v62, v63
    v_exp_f32 v67, v67
    s_waitcnt lgkmcnt(3)
    v_mfma_f32_32x32x16_bf16 v[44:59], v[24:27], v[16:19], v[44:59]
    ds_read_b128 v[24:27], v3 offset:37888
    v_exp_f32 v68, v68
    v_cvt_pk_bf16_f32 v38, v64, v65
    v_exp_f32 v69, v69
    v_cvt_pk_bf16_f32 v39, v66, v67
    v_exp_f32 v70, v70
    v_exp_f32 v71, v71
    s_waitcnt lgkmcnt(3)
    v_mfma_f32_32x32x16_bf16 v[76:91], v[28:31], v[36:39], v[76:91]
    ds_read_b128 v[28:31], v3 offset:34816
    v_exp_f32 v72, v72
    v_exp_f32 v73, v73
    v_exp_f32 v74, v74
    v_exp_f32 v75, v75
    v_cvt_pk_bf16_f32 v40, v68, v69
    v_cvt_pk_bf16_f32 v41, v70, v71
    v_cvt_pk_bf16_f32 v42, v72, v73
    v_cvt_pk_bf16_f32 v43, v74, v75
    s_waitcnt lgkmcnt(3)
    v_mfma_f32_32x32x16_bf16 v[60:75], v[20:23], v[12:15], 0
    s_waitcnt lgkmcnt(2)
    s_waitcnt vmcnt(0)
    s_barrier
    ds_read_b128 v[20:23], v4 offset:0
    v_exp_f32 v44, v44
    v_exp_f32 v45, v45
    v_exp_f32 v46, v46
    v_exp_f32 v47, v47
    v_mfma_f32_32x32x16_bf16 v[76:91], v[32:35], v[40:43], v[76:91]
    ds_read_b128 v[32:35], v3 offset:35840
    v_exp_f32 v48, v48
    v_exp_f32 v49, v49
    v_cvt_pk_bf16_f32 v36, v44, v45
    v_exp_f32 v50, v50
    v_cvt_pk_bf16_f32 v37, v46, v47
    v_exp_f32 v51, v51
    s_waitcnt lgkmcnt(3)
    v_mfma_f32_32x32x16_bf16 v[60:75], v[24:27], v[16:19], v[60:75]
    ds_read_b128 v[24:27], v4 offset:1024
    v_exp_f32 v52, v52
    v_cvt_pk_bf16_f32 v38, v48, v49
    v_exp_f32 v53, v53
    v_cvt_pk_bf16_f32 v39, v50, v51
    v_exp_f32 v54, v54
    v_exp_f32 v55, v55
    s_waitcnt lgkmcnt(3)
    v_mfma_f32_32x32x16_bf16 v[76:91], v[28:31], v[36:39], v[76:91]
    ds_read_b128 v[28:31], v3 offset:38912
    v_exp_f32 v56, v56
    v_exp_f32 v57, v57
    v_exp_f32 v58, v58
    v_exp_f32 v59, v59
    v_cvt_pk_bf16_f32 v40, v52, v53
    v_cvt_pk_bf16_f32 v41, v54, v55
    v_cvt_pk_bf16_f32 v42, v56, v57
    v_cvt_pk_bf16_f32 v43, v58, v59
    s_waitcnt lgkmcnt(3)
    v_mfma_f32_32x32x16_bf16 v[44:59], v[20:23], v[12:15], 0
    ds_read_b128 v[20:23], v4 offset:4096
    v_exp_f32 v60, v60
    v_exp_f32 v61, v61
    v_exp_f32 v62, v62
    v_exp_f32 v63, v63
    s_waitcnt lgkmcnt(3)
    v_mfma_f32_32x32x16_bf16 v[76:91], v[32:35], v[40:43], v[76:91]
    ds_read_b128 v[32:35], v3 offset:39936
    v_exp_f32 v64, v64
    v_exp_f32 v65, v65
    v_cvt_pk_bf16_f32 v36, v60, v61
    v_exp_f32 v66, v66
    v_cvt_pk_bf16_f32 v37, v62, v63
    v_exp_f32 v67, v67
    s_waitcnt lgkmcnt(3)
    v_mfma_f32_32x32x16_bf16 v[44:59], v[24:27], v[16:19], v[44:59]
    ds_read_b128 v[24:27], v4 offset:5120
    v_exp_f32 v68, v68
    v_cvt_pk_bf16_f32 v38, v64, v65
    v_exp_f32 v69, v69
    v_cvt_pk_bf16_f32 v39, v66, v67
    v_exp_f32 v70, v70
    v_exp_f32 v71, v71
    s_waitcnt lgkmcnt(3)
    v_mfma_f32_32x32x16_bf16 v[76:91], v[28:31], v[36:39], v[76:91]
    ds_read_b128 v[28:31], v4 offset:2048
    v_exp_f32 v72, v72
    v_exp_f32 v73, v73
    v_exp_f32 v74, v74
    v_exp_f32 v75, v75
    v_cvt_pk_bf16_f32 v40, v68, v69
    v_cvt_pk_bf16_f32 v41, v70, v71
    v_cvt_pk_bf16_f32 v42, v72, v73
    v_cvt_pk_bf16_f32 v43, v74, v75
    s_waitcnt lgkmcnt(3)
    v_mfma_f32_32x32x16_bf16 v[60:75], v[20:23], v[12:15], 0
    s_waitcnt lgkmcnt(2)
    s_barrier
    ds_read_b128 v[20:23], v4 offset:16384
    v_exp_f32 v44, v44
    v_exp_f32 v45, v45
    v_exp_f32 v46, v46
    v_exp_f32 v47, v47
    v_mfma_f32_32x32x16_bf16 v[76:91], v[32:35], v[40:43], v[76:91]
    ds_read_b128 v[32:35], v4 offset:3072
    v_exp_f32 v48, v48
    v_exp_f32 v49, v49
    v_cvt_pk_bf16_f32 v36, v44, v45
    v_exp_f32 v50, v50
    v_cvt_pk_bf16_f32 v37, v46, v47
    v_exp_f32 v51, v51
    s_waitcnt lgkmcnt(3)
    v_mfma_f32_32x32x16_bf16 v[60:75], v[24:27], v[16:19], v[60:75]
    ds_read_b128 v[24:27], v4 offset:17408
    v_exp_f32 v52, v52
    v_cvt_pk_bf16_f32 v38, v48, v49
    v_exp_f32 v53, v53
    v_cvt_pk_bf16_f32 v39, v50, v51
    v_exp_f32 v54, v54
    v_exp_f32 v55, v55
    s_waitcnt lgkmcnt(3)
    v_mfma_f32_32x32x16_bf16 v[76:91], v[28:31], v[36:39], v[76:91]
    ds_read_b128 v[28:31], v4 offset:6144
    v_exp_f32 v56, v56
    v_exp_f32 v57, v57
    v_exp_f32 v58, v58
    v_exp_f32 v59, v59
    v_cvt_pk_bf16_f32 v40, v52, v53
    v_cvt_pk_bf16_f32 v41, v54, v55
    v_cvt_pk_bf16_f32 v42, v56, v57
    v_cvt_pk_bf16_f32 v43, v58, v59
    s_waitcnt lgkmcnt(3)
    v_mfma_f32_32x32x16_bf16 v[44:59], v[20:23], v[12:15], 0
    ds_read_b128 v[20:23], v4 offset:20480
    v_exp_f32 v60, v60
    v_exp_f32 v61, v61
    v_exp_f32 v62, v62
    v_exp_f32 v63, v63
    s_waitcnt lgkmcnt(3)
    v_mfma_f32_32x32x16_bf16 v[76:91], v[32:35], v[40:43], v[76:91]
    ds_read_b128 v[32:35], v4 offset:7168
    v_exp_f32 v64, v64
    v_exp_f32 v65, v65
    v_cvt_pk_bf16_f32 v36, v60, v61
    v_exp_f32 v66, v66
    v_cvt_pk_bf16_f32 v37, v62, v63
    v_exp_f32 v67, v67
    s_waitcnt lgkmcnt(3)
    v_mfma_f32_32x32x16_bf16 v[44:59], v[24:27], v[16:19], v[44:59]
    ds_read_b128 v[24:27], v4 offset:21504
    v_exp_f32 v68, v68
    v_cvt_pk_bf16_f32 v38, v64, v65
    v_exp_f32 v69, v69
    v_cvt_pk_bf16_f32 v39, v66, v67
    v_exp_f32 v70, v70
    v_exp_f32 v71, v71
    s_waitcnt lgkmcnt(3)
    v_mfma_f32_32x32x16_bf16 v[76:91], v[28:31], v[36:39], v[76:91]
    ds_read_b128 v[28:31], v4 offset:18432
    v_exp_f32 v72, v72
    v_exp_f32 v73, v73
    v_exp_f32 v74, v74
    v_exp_f32 v75, v75
    v_cvt_pk_bf16_f32 v40, v68, v69
    v_cvt_pk_bf16_f32 v41, v70, v71
    v_cvt_pk_bf16_f32 v42, v72, v73
    v_cvt_pk_bf16_f32 v43, v74, v75
    s_waitcnt lgkmcnt(3)
    v_mfma_f32_32x32x16_bf16 v[60:75], v[20:23], v[12:15], 0
    s_waitcnt lgkmcnt(2)
    s_barrier
    ds_read_b128 v[20:23], v3 offset:0
    v_exp_f32 v44, v44
    v_exp_f32 v45, v45
    v_exp_f32 v46, v46
    v_exp_f32 v47, v47
    v_mfma_f32_32x32x16_bf16 v[76:91], v[32:35], v[40:43], v[76:91]
    ds_read_b128 v[32:35], v4 offset:19456
    v_exp_f32 v48, v48
    v_exp_f32 v49, v49
    v_cvt_pk_bf16_f32 v36, v44, v45
    v_exp_f32 v50, v50
    v_cvt_pk_bf16_f32 v37, v46, v47
    v_exp_f32 v51, v51
    s_waitcnt lgkmcnt(3)
    v_mfma_f32_32x32x16_bf16 v[60:75], v[24:27], v[16:19], v[60:75]
    ds_read_b128 v[24:27], v3 offset:1024
    v_exp_f32 v52, v52
    v_cvt_pk_bf16_f32 v38, v48, v49
    v_exp_f32 v53, v53
    v_cvt_pk_bf16_f32 v39, v50, v51
    v_exp_f32 v54, v54
    v_exp_f32 v55, v55
    s_waitcnt lgkmcnt(3)
    v_mfma_f32_32x32x16_bf16 v[76:91], v[28:31], v[36:39], v[76:91]
    ds_read_b128 v[28:31], v4 offset:22528
    v_exp_f32 v56, v56
    v_exp_f32 v57, v57
    v_exp_f32 v58, v58
    v_exp_f32 v59, v59
    v_cvt_pk_bf16_f32 v40, v52, v53
    v_cvt_pk_bf16_f32 v41, v54, v55
    v_cvt_pk_bf16_f32 v42, v56, v57
    v_cvt_pk_bf16_f32 v43, v58, v59
    s_waitcnt lgkmcnt(3)
    v_mfma_f32_32x32x16_bf16 v[44:59], v[20:23], v[12:15], 0
    ds_read_b128 v[20:23], v3 offset:4096
    v_exp_f32 v60, v60
    v_exp_f32 v61, v61
    v_exp_f32 v62, v62
    v_exp_f32 v63, v63
    s_waitcnt lgkmcnt(3)
    v_mfma_f32_32x32x16_bf16 v[76:91], v[32:35], v[40:43], v[76:91]
    ds_read_b128 v[32:35], v4 offset:23552
    v_exp_f32 v64, v64
    v_exp_f32 v65, v65
    v_cvt_pk_bf16_f32 v36, v60, v61
    v_exp_f32 v66, v66
    v_cvt_pk_bf16_f32 v37, v62, v63
    v_exp_f32 v67, v67
    s_waitcnt lgkmcnt(3)
    v_mfma_f32_32x32x16_bf16 v[44:59], v[24:27], v[16:19], v[44:59]
    ds_read_b128 v[24:27], v3 offset:5120
    v_exp_f32 v68, v68
    v_cvt_pk_bf16_f32 v38, v64, v65
    v_exp_f32 v69, v69
    v_cvt_pk_bf16_f32 v39, v66, v67
    v_exp_f32 v70, v70
    v_exp_f32 v71, v71
    s_waitcnt lgkmcnt(3)
    v_mfma_f32_32x32x16_bf16 v[76:91], v[28:31], v[36:39], v[76:91]
    ds_read_b128 v[28:31], v3 offset:2048
    v_exp_f32 v72, v72
    v_exp_f32 v73, v73
    v_exp_f32 v74, v74
    v_exp_f32 v75, v75
    v_cvt_pk_bf16_f32 v40, v68, v69
    v_cvt_pk_bf16_f32 v41, v70, v71
    v_cvt_pk_bf16_f32 v42, v72, v73
    v_cvt_pk_bf16_f32 v43, v74, v75
    s_waitcnt lgkmcnt(3)
    v_mfma_f32_32x32x16_bf16 v[60:75], v[20:23], v[12:15], 0
    s_waitcnt lgkmcnt(2)
    s_barrier
    ds_read_b128 v[20:23], v3 offset:16384
    v_exp_f32 v44, v44
    v_exp_f32 v45, v45
    v_exp_f32 v46, v46
    v_exp_f32 v47, v47
    v_mfma_f32_32x32x16_bf16 v[76:91], v[32:35], v[40:43], v[76:91]
    ds_read_b128 v[32:35], v3 offset:3072
    v_exp_f32 v48, v48
    v_exp_f32 v49, v49
    v_cvt_pk_bf16_f32 v36, v44, v45
    v_exp_f32 v50, v50
    v_cvt_pk_bf16_f32 v37, v46, v47
    v_exp_f32 v51, v51
    s_waitcnt lgkmcnt(3)
    v_mfma_f32_32x32x16_bf16 v[60:75], v[24:27], v[16:19], v[60:75]
    ds_read_b128 v[24:27], v3 offset:17408
    v_exp_f32 v52, v52
    v_cvt_pk_bf16_f32 v38, v48, v49
    v_exp_f32 v53, v53
    v_cvt_pk_bf16_f32 v39, v50, v51
    v_exp_f32 v54, v54
    v_exp_f32 v55, v55
    s_waitcnt lgkmcnt(3)
    v_mfma_f32_32x32x16_bf16 v[76:91], v[28:31], v[36:39], v[76:91]
    ds_read_b128 v[28:31], v3 offset:6144
    v_exp_f32 v56, v56
    v_exp_f32 v57, v57
    v_exp_f32 v58, v58
    v_exp_f32 v59, v59
    v_cvt_pk_bf16_f32 v40, v52, v53
    v_cvt_pk_bf16_f32 v41, v54, v55
    v_cvt_pk_bf16_f32 v42, v56, v57
    v_cvt_pk_bf16_f32 v43, v58, v59
    s_waitcnt lgkmcnt(3)
    v_mfma_f32_32x32x16_bf16 v[44:59], v[20:23], v[12:15], 0
    ds_read_b128 v[20:23], v3 offset:20480
    v_exp_f32 v60, v60
    v_exp_f32 v61, v61
    v_exp_f32 v62, v62
    v_exp_f32 v63, v63
    s_waitcnt lgkmcnt(3)
    v_mfma_f32_32x32x16_bf16 v[76:91], v[32:35], v[40:43], v[76:91]
    ds_read_b128 v[32:35], v3 offset:7168
    v_exp_f32 v64, v64
    v_exp_f32 v65, v65
    v_cvt_pk_bf16_f32 v36, v60, v61
    v_exp_f32 v66, v66
    v_cvt_pk_bf16_f32 v37, v62, v63
    v_exp_f32 v67, v67
    s_waitcnt lgkmcnt(3)
    v_mfma_f32_32x32x16_bf16 v[44:59], v[24:27], v[16:19], v[44:59]
    ds_read_b128 v[24:27], v3 offset:21504
    v_exp_f32 v68, v68
    v_cvt_pk_bf16_f32 v38, v64, v65
    v_exp_f32 v69, v69
    v_cvt_pk_bf16_f32 v39, v66, v67
    v_exp_f32 v70, v70
    v_exp_f32 v71, v71
    s_waitcnt lgkmcnt(3)
    v_mfma_f32_32x32x16_bf16 v[76:91], v[28:31], v[36:39], v[76:91]
    ds_read_b128 v[28:31], v3 offset:18432
    v_exp_f32 v72, v72
    v_exp_f32 v73, v73
    v_exp_f32 v74, v74
    v_exp_f32 v75, v75
    v_cvt_pk_bf16_f32 v40, v68, v69
    v_cvt_pk_bf16_f32 v41, v70, v71
    v_cvt_pk_bf16_f32 v42, v72, v73
    v_cvt_pk_bf16_f32 v43, v74, v75
    s_waitcnt lgkmcnt(3)
    v_mfma_f32_32x32x16_bf16 v[60:75], v[20:23], v[12:15], 0
    s_waitcnt lgkmcnt(2)
    s_barrier
    ds_read_b128 v[20:23], v3 offset:32768
    v_exp_f32 v44, v44
    v_exp_f32 v45, v45
    v_exp_f32 v46, v46
    v_exp_f32 v47, v47
    v_mfma_f32_32x32x16_bf16 v[76:91], v[32:35], v[40:43], v[76:91]
    ds_read_b128 v[32:35], v3 offset:19456
    v_exp_f32 v48, v48
    v_exp_f32 v49, v49
    v_cvt_pk_bf16_f32 v36, v44, v45
    v_exp_f32 v50, v50
    v_cvt_pk_bf16_f32 v37, v46, v47
    v_exp_f32 v51, v51
    s_waitcnt lgkmcnt(3)
    v_mfma_f32_32x32x16_bf16 v[60:75], v[24:27], v[16:19], v[60:75]
    ds_read_b128 v[24:27], v3 offset:33792
    v_exp_f32 v52, v52
    v_cvt_pk_bf16_f32 v38, v48, v49
    v_exp_f32 v53, v53
    v_cvt_pk_bf16_f32 v39, v50, v51
    v_exp_f32 v54, v54
    v_exp_f32 v55, v55
    s_waitcnt lgkmcnt(3)
    v_mfma_f32_32x32x16_bf16 v[76:91], v[28:31], v[36:39], v[76:91]
    ds_read_b128 v[28:31], v3 offset:22528
    v_exp_f32 v56, v56
    v_exp_f32 v57, v57
    v_exp_f32 v58, v58
    v_exp_f32 v59, v59
    v_cvt_pk_bf16_f32 v40, v52, v53
    v_cvt_pk_bf16_f32 v41, v54, v55
    v_cvt_pk_bf16_f32 v42, v56, v57
    v_cvt_pk_bf16_f32 v43, v58, v59
    s_waitcnt lgkmcnt(3)
    v_mfma_f32_32x32x16_bf16 v[44:59], v[20:23], v[12:15], 0
    ds_read_b128 v[20:23], v3 offset:36864
    v_exp_f32 v60, v60
    v_exp_f32 v61, v61
    v_exp_f32 v62, v62
    v_exp_f32 v63, v63
    s_waitcnt lgkmcnt(3)
    v_mfma_f32_32x32x16_bf16 v[76:91], v[32:35], v[40:43], v[76:91]
    ds_read_b128 v[32:35], v3 offset:23552
    v_exp_f32 v64, v64
    v_exp_f32 v65, v65
    v_cvt_pk_bf16_f32 v36, v60, v61
    v_exp_f32 v66, v66
    v_cvt_pk_bf16_f32 v37, v62, v63
    v_exp_f32 v67, v67
    s_waitcnt lgkmcnt(3)
    v_mfma_f32_32x32x16_bf16 v[44:59], v[24:27], v[16:19], v[44:59]
    ds_read_b128 v[24:27], v3 offset:37888
    v_exp_f32 v68, v68
    v_cvt_pk_bf16_f32 v38, v64, v65
    v_exp_f32 v69, v69
    v_cvt_pk_bf16_f32 v39, v66, v67
    v_exp_f32 v70, v70
    v_exp_f32 v71, v71
    s_waitcnt lgkmcnt(3)
    v_mfma_f32_32x32x16_bf16 v[76:91], v[28:31], v[36:39], v[76:91]
    ds_read_b128 v[28:31], v3 offset:34816
    v_exp_f32 v72, v72
    v_exp_f32 v73, v73
    v_exp_f32 v74, v74
    v_exp_f32 v75, v75
    v_cvt_pk_bf16_f32 v40, v68, v69
    v_cvt_pk_bf16_f32 v41, v70, v71
    v_cvt_pk_bf16_f32 v42, v72, v73
    v_cvt_pk_bf16_f32 v43, v74, v75
    s_waitcnt lgkmcnt(3)
    v_mfma_f32_32x32x16_bf16 v[60:75], v[20:23], v[12:15], 0
    s_waitcnt lgkmcnt(2)
    s_barrier
    ds_read_b128 v[20:23], v4 offset:0
    v_exp_f32 v44, v44
    v_exp_f32 v45, v45
    v_exp_f32 v46, v46
    v_exp_f32 v47, v47
    v_mfma_f32_32x32x16_bf16 v[76:91], v[32:35], v[40:43], v[76:91]
    ds_read_b128 v[32:35], v3 offset:35840
    v_exp_f32 v48, v48
    v_exp_f32 v49, v49
    v_cvt_pk_bf16_f32 v36, v44, v45
    v_exp_f32 v50, v50
    v_cvt_pk_bf16_f32 v37, v46, v47
    v_exp_f32 v51, v51
    s_waitcnt lgkmcnt(3)
    v_mfma_f32_32x32x16_bf16 v[60:75], v[24:27], v[16:19], v[60:75]
    ds_read_b128 v[24:27], v4 offset:1024
    v_exp_f32 v52, v52
    v_cvt_pk_bf16_f32 v38, v48, v49
    v_exp_f32 v53, v53
    v_cvt_pk_bf16_f32 v39, v50, v51
    v_exp_f32 v54, v54
    v_exp_f32 v55, v55
    s_waitcnt lgkmcnt(3)
    v_mfma_f32_32x32x16_bf16 v[76:91], v[28:31], v[36:39], v[76:91]
    ds_read_b128 v[28:31], v3 offset:38912
    v_exp_f32 v56, v56
    v_exp_f32 v57, v57
    v_exp_f32 v58, v58
    v_exp_f32 v59, v59
    v_cvt_pk_bf16_f32 v40, v52, v53
    v_cvt_pk_bf16_f32 v41, v54, v55
    v_cvt_pk_bf16_f32 v42, v56, v57
    v_cvt_pk_bf16_f32 v43, v58, v59
    s_waitcnt lgkmcnt(3)
    v_mfma_f32_32x32x16_bf16 v[44:59], v[20:23], v[12:15], 0
    ds_read_b128 v[20:23], v4 offset:4096
    v_exp_f32 v60, v60
    v_exp_f32 v61, v61
    v_exp_f32 v62, v62
    v_exp_f32 v63, v63
    s_waitcnt lgkmcnt(3)
    v_mfma_f32_32x32x16_bf16 v[76:91], v[32:35], v[40:43], v[76:91]
    ds_read_b128 v[32:35], v3 offset:39936
    v_exp_f32 v64, v64
    v_exp_f32 v65, v65
    v_cvt_pk_bf16_f32 v36, v60, v61
    v_exp_f32 v66, v66
    v_cvt_pk_bf16_f32 v37, v62, v63
    v_exp_f32 v67, v67
    s_waitcnt lgkmcnt(3)
    v_mfma_f32_32x32x16_bf16 v[44:59], v[24:27], v[16:19], v[44:59]
    ds_read_b128 v[24:27], v4 offset:5120
    v_exp_f32 v68, v68
    v_cvt_pk_bf16_f32 v38, v64, v65
    v_exp_f32 v69, v69
    v_cvt_pk_bf16_f32 v39, v66, v67
    v_exp_f32 v70, v70
    v_exp_f32 v71, v71
    s_waitcnt lgkmcnt(3)
    v_mfma_f32_32x32x16_bf16 v[76:91], v[28:31], v[36:39], v[76:91]
    ds_read_b128 v[28:31], v4 offset:2048
    v_exp_f32 v72, v72
    v_exp_f32 v73, v73
    v_exp_f32 v74, v74
    v_exp_f32 v75, v75
    v_cvt_pk_bf16_f32 v40, v68, v69
    v_cvt_pk_bf16_f32 v41, v70, v71
    v_cvt_pk_bf16_f32 v42, v72, v73
    v_cvt_pk_bf16_f32 v43, v74, v75
    s_waitcnt lgkmcnt(3)
    v_mfma_f32_32x32x16_bf16 v[60:75], v[20:23], v[12:15], 0
    s_waitcnt lgkmcnt(2)
    s_barrier
    ds_read_b128 v[20:23], v4 offset:16384
    v_exp_f32 v44, v44
    v_exp_f32 v45, v45
    v_exp_f32 v46, v46
    v_exp_f32 v47, v47
    v_mfma_f32_32x32x16_bf16 v[76:91], v[32:35], v[40:43], v[76:91]
    ds_read_b128 v[32:35], v4 offset:3072
    v_exp_f32 v48, v48
    v_exp_f32 v49, v49
    v_cvt_pk_bf16_f32 v36, v44, v45
    v_exp_f32 v50, v50
    v_cvt_pk_bf16_f32 v37, v46, v47
    v_exp_f32 v51, v51
    s_waitcnt lgkmcnt(3)
    v_mfma_f32_32x32x16_bf16 v[60:75], v[24:27], v[16:19], v[60:75]
    ds_read_b128 v[24:27], v4 offset:17408
    v_exp_f32 v52, v52
    v_cvt_pk_bf16_f32 v38, v48, v49
    v_exp_f32 v53, v53
    v_cvt_pk_bf16_f32 v39, v50, v51
    v_exp_f32 v54, v54
    v_exp_f32 v55, v55
    s_waitcnt lgkmcnt(3)
    v_mfma_f32_32x32x16_bf16 v[76:91], v[28:31], v[36:39], v[76:91]
    ds_read_b128 v[28:31], v4 offset:6144
    v_exp_f32 v56, v56
    v_exp_f32 v57, v57
    v_exp_f32 v58, v58
    v_exp_f32 v59, v59
    v_cvt_pk_bf16_f32 v40, v52, v53
    v_cvt_pk_bf16_f32 v41, v54, v55
    v_cvt_pk_bf16_f32 v42, v56, v57
    v_cvt_pk_bf16_f32 v43, v58, v59
    s_waitcnt lgkmcnt(3)
    v_mfma_f32_32x32x16_bf16 v[44:59], v[20:23], v[12:15], 0
    ds_read_b128 v[20:23], v4 offset:20480
    v_exp_f32 v60, v60
    v_exp_f32 v61, v61
    v_exp_f32 v62, v62
    v_exp_f32 v63, v63
    s_waitcnt lgkmcnt(3)
    v_mfma_f32_32x32x16_bf16 v[76:91], v[32:35], v[40:43], v[76:91]
    ds_read_b128 v[32:35], v4 offset:7168
    v_exp_f32 v64, v64
    v_exp_f32 v65, v65
    v_cvt_pk_bf16_f32 v36, v60, v61
    v_exp_f32 v66, v66
    v_cvt_pk_bf16_f32 v37, v62, v63
    v_exp_f32 v67, v67
    s_waitcnt lgkmcnt(3)
    v_mfma_f32_32x32x16_bf16 v[44:59], v[24:27], v[16:19], v[44:59]
    ds_read_b128 v[24:27], v4 offset:21504
    v_exp_f32 v68, v68
    v_cvt_pk_bf16_f32 v38, v64, v65
    v_exp_f32 v69, v69
    v_cvt_pk_bf16_f32 v39, v66, v67
    v_exp_f32 v70, v70
    v_exp_f32 v71, v71
    s_waitcnt lgkmcnt(3)
    v_mfma_f32_32x32x16_bf16 v[76:91], v[28:31], v[36:39], v[76:91]
    ds_read_b128 v[28:31], v4 offset:18432
    v_exp_f32 v72, v72
    v_exp_f32 v73, v73
    v_exp_f32 v74, v74
    v_exp_f32 v75, v75
    v_cvt_pk_bf16_f32 v40, v68, v69
    v_cvt_pk_bf16_f32 v41, v70, v71
    v_cvt_pk_bf16_f32 v42, v72, v73
    v_cvt_pk_bf16_f32 v43, v74, v75
    s_waitcnt lgkmcnt(3)
    v_mfma_f32_32x32x16_bf16 v[60:75], v[20:23], v[12:15], 0
    s_waitcnt lgkmcnt(2)
    s_barrier
    ds_read_b128 v[20:23], v3 offset:0
    v_exp_f32 v44, v44
    v_exp_f32 v45, v45
    v_exp_f32 v46, v46
    v_exp_f32 v47, v47
    v_mfma_f32_32x32x16_bf16 v[76:91], v[32:35], v[40:43], v[76:91]
    ds_read_b128 v[32:35], v4 offset:19456
    v_exp_f32 v48, v48
    v_exp_f32 v49, v49
    v_cvt_pk_bf16_f32 v36, v44, v45
    v_exp_f32 v50, v50
    v_cvt_pk_bf16_f32 v37, v46, v47
    v_exp_f32 v51, v51
    s_waitcnt lgkmcnt(3)
    v_mfma_f32_32x32x16_bf16 v[60:75], v[24:27], v[16:19], v[60:75]
    ds_read_b128 v[24:27], v3 offset:1024
    v_exp_f32 v52, v52
    v_cvt_pk_bf16_f32 v38, v48, v49
    v_exp_f32 v53, v53
    v_cvt_pk_bf16_f32 v39, v50, v51
    v_exp_f32 v54, v54
    v_exp_f32 v55, v55
    s_waitcnt lgkmcnt(3)
    v_mfma_f32_32x32x16_bf16 v[76:91], v[28:31], v[36:39], v[76:91]
    ds_read_b128 v[28:31], v4 offset:22528
    v_exp_f32 v56, v56
    v_exp_f32 v57, v57
    v_exp_f32 v58, v58
    v_exp_f32 v59, v59
    v_cvt_pk_bf16_f32 v40, v52, v53
    v_cvt_pk_bf16_f32 v41, v54, v55
    v_cvt_pk_bf16_f32 v42, v56, v57
    v_cvt_pk_bf16_f32 v43, v58, v59
    s_waitcnt lgkmcnt(3)
    v_mfma_f32_32x32x16_bf16 v[44:59], v[20:23], v[12:15], 0
    ds_read_b128 v[20:23], v3 offset:4096
    v_exp_f32 v60, v60
    v_exp_f32 v61, v61
    v_exp_f32 v62, v62
    v_exp_f32 v63, v63
    s_waitcnt lgkmcnt(3)
    v_mfma_f32_32x32x16_bf16 v[76:91], v[32:35], v[40:43], v[76:91]
    ds_read_b128 v[32:35], v4 offset:23552
    v_exp_f32 v64, v64
    v_exp_f32 v65, v65
    v_cvt_pk_bf16_f32 v36, v60, v61
    v_exp_f32 v66, v66
    v_cvt_pk_bf16_f32 v37, v62, v63
    v_exp_f32 v67, v67
    s_waitcnt lgkmcnt(3)
    v_mfma_f32_32x32x16_bf16 v[44:59], v[24:27], v[16:19], v[44:59]
    ds_read_b128 v[24:27], v3 offset:5120
    v_exp_f32 v68, v68
    v_cvt_pk_bf16_f32 v38, v64, v65
    v_exp_f32 v69, v69
    v_cvt_pk_bf16_f32 v39, v66, v67
    v_exp_f32 v70, v70
    v_exp_f32 v71, v71
    s_waitcnt lgkmcnt(3)
    v_mfma_f32_32x32x16_bf16 v[76:91], v[28:31], v[36:39], v[76:91]
    ds_read_b128 v[28:31], v3 offset:2048
    v_exp_f32 v72, v72
    v_exp_f32 v73, v73
    v_exp_f32 v74, v74
    v_exp_f32 v75, v75
    v_cvt_pk_bf16_f32 v40, v68, v69
    v_cvt_pk_bf16_f32 v41, v70, v71
    v_cvt_pk_bf16_f32 v42, v72, v73
    v_cvt_pk_bf16_f32 v43, v74, v75
    s_waitcnt lgkmcnt(3)
    v_mfma_f32_32x32x16_bf16 v[60:75], v[20:23], v[12:15], 0
    s_waitcnt lgkmcnt(2)
    s_barrier
    ds_read_b128 v[20:23], v3 offset:16384
    v_exp_f32 v44, v44
    v_exp_f32 v45, v45
    v_exp_f32 v46, v46
    v_exp_f32 v47, v47
    v_mfma_f32_32x32x16_bf16 v[76:91], v[32:35], v[40:43], v[76:91]
    ds_read_b128 v[32:35], v3 offset:3072
    v_exp_f32 v48, v48
    v_exp_f32 v49, v49
    v_cvt_pk_bf16_f32 v36, v44, v45
    v_exp_f32 v50, v50
    v_cvt_pk_bf16_f32 v37, v46, v47
    v_exp_f32 v51, v51
    s_waitcnt lgkmcnt(3)
    v_mfma_f32_32x32x16_bf16 v[60:75], v[24:27], v[16:19], v[60:75]
    ds_read_b128 v[24:27], v3 offset:17408
    v_exp_f32 v52, v52
    v_cvt_pk_bf16_f32 v38, v48, v49
    v_exp_f32 v53, v53
    v_cvt_pk_bf16_f32 v39, v50, v51
    v_exp_f32 v54, v54
    v_exp_f32 v55, v55
    s_waitcnt lgkmcnt(3)
    v_mfma_f32_32x32x16_bf16 v[76:91], v[28:31], v[36:39], v[76:91]
    ds_read_b128 v[28:31], v3 offset:6144
    v_exp_f32 v56, v56
    v_exp_f32 v57, v57
    v_exp_f32 v58, v58
    v_exp_f32 v59, v59
    v_cvt_pk_bf16_f32 v40, v52, v53
    v_cvt_pk_bf16_f32 v41, v54, v55
    v_cvt_pk_bf16_f32 v42, v56, v57
    v_cvt_pk_bf16_f32 v43, v58, v59
    s_waitcnt lgkmcnt(3)
    v_mfma_f32_32x32x16_bf16 v[44:59], v[20:23], v[12:15], 0
    ds_read_b128 v[20:23], v3 offset:20480
    v_exp_f32 v60, v60
    v_exp_f32 v61, v61
    v_exp_f32 v62, v62
    v_exp_f32 v63, v63
    s_waitcnt lgkmcnt(3)
    v_mfma_f32_32x32x16_bf16 v[76:91], v[32:35], v[40:43], v[76:91]
    ds_read_b128 v[32:35], v3 offset:7168
    v_exp_f32 v64, v64
    v_exp_f32 v65, v65
    v_cvt_pk_bf16_f32 v36, v60, v61
    v_exp_f32 v66, v66
    v_cvt_pk_bf16_f32 v37, v62, v63
    v_exp_f32 v67, v67
    s_waitcnt lgkmcnt(3)
    v_mfma_f32_32x32x16_bf16 v[44:59], v[24:27], v[16:19], v[44:59]
    ds_read_b128 v[24:27], v3 offset:21504
    v_exp_f32 v68, v68
    v_cvt_pk_bf16_f32 v38, v64, v65
    v_exp_f32 v69, v69
    v_cvt_pk_bf16_f32 v39, v66, v67
    v_exp_f32 v70, v70
    v_exp_f32 v71, v71
    s_waitcnt lgkmcnt(3)
    v_mfma_f32_32x32x16_bf16 v[76:91], v[28:31], v[36:39], v[76:91]
    ds_read_b128 v[28:31], v3 offset:18432
    v_exp_f32 v72, v72
    v_exp_f32 v73, v73
    v_exp_f32 v74, v74
    v_exp_f32 v75, v75
    v_cvt_pk_bf16_f32 v40, v68, v69
    v_cvt_pk_bf16_f32 v41, v70, v71
    v_cvt_pk_bf16_f32 v42, v72, v73
    v_cvt_pk_bf16_f32 v43, v74, v75
    s_waitcnt lgkmcnt(3)
    v_mfma_f32_32x32x16_bf16 v[60:75], v[20:23], v[12:15], 0
    s_waitcnt lgkmcnt(2)
    s_barrier
    ds_read_b128 v[20:23], v3 offset:32768
    v_exp_f32 v44, v44
    v_exp_f32 v45, v45
    v_exp_f32 v46, v46
    v_exp_f32 v47, v47
    v_mfma_f32_32x32x16_bf16 v[76:91], v[32:35], v[40:43], v[76:91]
    ds_read_b128 v[32:35], v3 offset:19456
    v_exp_f32 v48, v48
    v_exp_f32 v49, v49
    v_cvt_pk_bf16_f32 v36, v44, v45
    v_exp_f32 v50, v50
    v_cvt_pk_bf16_f32 v37, v46, v47
    v_exp_f32 v51, v51
    s_waitcnt lgkmcnt(3)
    v_mfma_f32_32x32x16_bf16 v[60:75], v[24:27], v[16:19], v[60:75]
    ds_read_b128 v[24:27], v3 offset:33792
    v_exp_f32 v52, v52
    v_cvt_pk_bf16_f32 v38, v48, v49
    v_exp_f32 v53, v53
    v_cvt_pk_bf16_f32 v39, v50, v51
    v_exp_f32 v54, v54
    v_exp_f32 v55, v55
    s_waitcnt lgkmcnt(3)
    v_mfma_f32_32x32x16_bf16 v[76:91], v[28:31], v[36:39], v[76:91]
    ds_read_b128 v[28:31], v3 offset:22528
    v_exp_f32 v56, v56
    v_exp_f32 v57, v57
    v_exp_f32 v58, v58
    v_exp_f32 v59, v59
    v_cvt_pk_bf16_f32 v40, v52, v53
    v_cvt_pk_bf16_f32 v41, v54, v55
    v_cvt_pk_bf16_f32 v42, v56, v57
    v_cvt_pk_bf16_f32 v43, v58, v59
    s_waitcnt lgkmcnt(3)
    v_mfma_f32_32x32x16_bf16 v[44:59], v[20:23], v[12:15], 0
    ds_read_b128 v[20:23], v3 offset:36864
    v_exp_f32 v60, v60
    v_exp_f32 v61, v61
    v_exp_f32 v62, v62
    v_exp_f32 v63, v63
    s_waitcnt lgkmcnt(3)
    v_mfma_f32_32x32x16_bf16 v[76:91], v[32:35], v[40:43], v[76:91]
    ds_read_b128 v[32:35], v3 offset:23552
    v_exp_f32 v64, v64
    v_exp_f32 v65, v65
    v_cvt_pk_bf16_f32 v36, v60, v61
    v_exp_f32 v66, v66
    v_cvt_pk_bf16_f32 v37, v62, v63
    v_exp_f32 v67, v67
    s_waitcnt lgkmcnt(3)
    v_mfma_f32_32x32x16_bf16 v[44:59], v[24:27], v[16:19], v[44:59]
    ds_read_b128 v[24:27], v3 offset:37888
    v_exp_f32 v68, v68
    v_cvt_pk_bf16_f32 v38, v64, v65
    v_exp_f32 v69, v69
    v_cvt_pk_bf16_f32 v39, v66, v67
    v_exp_f32 v70, v70
    v_exp_f32 v71, v71
    s_waitcnt lgkmcnt(3)
    v_mfma_f32_32x32x16_bf16 v[76:91], v[28:31], v[36:39], v[76:91]
    ds_read_b128 v[28:31], v3 offset:34816
    v_exp_f32 v72, v72
    v_exp_f32 v73, v73
    v_exp_f32 v74, v74
    v_exp_f32 v75, v75
    v_cvt_pk_bf16_f32 v40, v68, v69
    v_cvt_pk_bf16_f32 v41, v70, v71
    v_cvt_pk_bf16_f32 v42, v72, v73
    v_cvt_pk_bf16_f32 v43, v74, v75
    s_waitcnt lgkmcnt(3)
    v_mfma_f32_32x32x16_bf16 v[60:75], v[20:23], v[12:15], 0
    s_waitcnt lgkmcnt(2)
    s_barrier
    ds_read_b128 v[20:23], v4 offset:0
    v_exp_f32 v44, v44
    v_exp_f32 v45, v45
    v_exp_f32 v46, v46
    v_exp_f32 v47, v47
    v_mfma_f32_32x32x16_bf16 v[76:91], v[32:35], v[40:43], v[76:91]
    ds_read_b128 v[32:35], v3 offset:35840
    v_exp_f32 v48, v48
    v_exp_f32 v49, v49
    v_cvt_pk_bf16_f32 v36, v44, v45
    v_exp_f32 v50, v50
    v_cvt_pk_bf16_f32 v37, v46, v47
    v_exp_f32 v51, v51
    s_waitcnt lgkmcnt(3)
    v_mfma_f32_32x32x16_bf16 v[60:75], v[24:27], v[16:19], v[60:75]
    ds_read_b128 v[24:27], v4 offset:1024
    v_exp_f32 v52, v52
    v_cvt_pk_bf16_f32 v38, v48, v49
    v_exp_f32 v53, v53
    v_cvt_pk_bf16_f32 v39, v50, v51
    v_exp_f32 v54, v54
    v_exp_f32 v55, v55
    s_waitcnt lgkmcnt(3)
    v_mfma_f32_32x32x16_bf16 v[76:91], v[28:31], v[36:39], v[76:91]
    ds_read_b128 v[28:31], v3 offset:38912
    v_exp_f32 v56, v56
    v_exp_f32 v57, v57
    v_exp_f32 v58, v58
    v_exp_f32 v59, v59
    v_cvt_pk_bf16_f32 v40, v52, v53
    v_cvt_pk_bf16_f32 v41, v54, v55
    v_cvt_pk_bf16_f32 v42, v56, v57
    v_cvt_pk_bf16_f32 v43, v58, v59
    s_waitcnt lgkmcnt(3)
    v_mfma_f32_32x32x16_bf16 v[44:59], v[20:23], v[12:15], 0
    ds_read_b128 v[20:23], v4 offset:4096
    v_exp_f32 v60, v60
    v_exp_f32 v61, v61
    v_exp_f32 v62, v62
    v_exp_f32 v63, v63
    s_waitcnt lgkmcnt(3)
    v_mfma_f32_32x32x16_bf16 v[76:91], v[32:35], v[40:43], v[76:91]
    ds_read_b128 v[32:35], v3 offset:39936
    v_exp_f32 v64, v64
    v_exp_f32 v65, v65
    v_cvt_pk_bf16_f32 v36, v60, v61
    v_exp_f32 v66, v66
    v_cvt_pk_bf16_f32 v37, v62, v63
    v_exp_f32 v67, v67
    s_waitcnt lgkmcnt(3)
    v_mfma_f32_32x32x16_bf16 v[44:59], v[24:27], v[16:19], v[44:59]
    ds_read_b128 v[24:27], v4 offset:5120
    v_exp_f32 v68, v68
    v_cvt_pk_bf16_f32 v38, v64, v65
    v_exp_f32 v69, v69
    v_cvt_pk_bf16_f32 v39, v66, v67
    v_exp_f32 v70, v70
    v_exp_f32 v71, v71
    s_waitcnt lgkmcnt(3)
    v_mfma_f32_32x32x16_bf16 v[76:91], v[28:31], v[36:39], v[76:91]
    ds_read_b128 v[28:31], v4 offset:2048
    v_exp_f32 v72, v72
    v_exp_f32 v73, v73
    v_exp_f32 v74, v74
    v_exp_f32 v75, v75
    v_cvt_pk_bf16_f32 v40, v68, v69
    v_cvt_pk_bf16_f32 v41, v70, v71
    v_cvt_pk_bf16_f32 v42, v72, v73
    v_cvt_pk_bf16_f32 v43, v74, v75
    s_waitcnt lgkmcnt(3)
    v_mfma_f32_32x32x16_bf16 v[60:75], v[20:23], v[12:15], 0
    s_waitcnt lgkmcnt(2)
    s_barrier
    ds_read_b128 v[20:23], v4 offset:16384
    v_exp_f32 v44, v44
    v_exp_f32 v45, v45
    v_exp_f32 v46, v46
    v_exp_f32 v47, v47
    v_mfma_f32_32x32x16_bf16 v[76:91], v[32:35], v[40:43], v[76:91]
    ds_read_b128 v[32:35], v4 offset:3072
    v_exp_f32 v48, v48
    v_exp_f32 v49, v49
    v_cvt_pk_bf16_f32 v36, v44, v45
    v_exp_f32 v50, v50
    v_cvt_pk_bf16_f32 v37, v46, v47
    v_exp_f32 v51, v51
    s_waitcnt lgkmcnt(3)
    v_mfma_f32_32x32x16_bf16 v[60:75], v[24:27], v[16:19], v[60:75]
    ds_read_b128 v[24:27], v4 offset:17408
    v_exp_f32 v52, v52
    v_cvt_pk_bf16_f32 v38, v48, v49
    v_exp_f32 v53, v53
    v_cvt_pk_bf16_f32 v39, v50, v51
    v_exp_f32 v54, v54
    v_exp_f32 v55, v55
    s_waitcnt lgkmcnt(3)
    v_mfma_f32_32x32x16_bf16 v[76:91], v[28:31], v[36:39], v[76:91]
    ds_read_b128 v[28:31], v4 offset:6144
    v_exp_f32 v56, v56
    v_exp_f32 v57, v57
    v_exp_f32 v58, v58
    v_exp_f32 v59, v59
    v_cvt_pk_bf16_f32 v40, v52, v53
    v_cvt_pk_bf16_f32 v41, v54, v55
    v_cvt_pk_bf16_f32 v42, v56, v57
    v_cvt_pk_bf16_f32 v43, v58, v59
    s_waitcnt lgkmcnt(3)
    v_mfma_f32_32x32x16_bf16 v[44:59], v[20:23], v[12:15], 0
    ds_read_b128 v[20:23], v4 offset:20480
    v_exp_f32 v60, v60
    v_exp_f32 v61, v61
    v_exp_f32 v62, v62
    v_exp_f32 v63, v63
    s_waitcnt lgkmcnt(3)
    v_mfma_f32_32x32x16_bf16 v[76:91], v[32:35], v[40:43], v[76:91]
    ds_read_b128 v[32:35], v4 offset:7168
    v_exp_f32 v64, v64
    v_exp_f32 v65, v65
    v_cvt_pk_bf16_f32 v36, v60, v61
    v_exp_f32 v66, v66
    v_cvt_pk_bf16_f32 v37, v62, v63
    v_exp_f32 v67, v67
    s_waitcnt lgkmcnt(3)
    v_mfma_f32_32x32x16_bf16 v[44:59], v[24:27], v[16:19], v[44:59]
    ds_read_b128 v[24:27], v4 offset:21504
    v_exp_f32 v68, v68
    v_cvt_pk_bf16_f32 v38, v64, v65
    v_exp_f32 v69, v69
    v_cvt_pk_bf16_f32 v39, v66, v67
    v_exp_f32 v70, v70
    v_exp_f32 v71, v71
    s_waitcnt lgkmcnt(3)
    v_mfma_f32_32x32x16_bf16 v[76:91], v[28:31], v[36:39], v[76:91]
    ds_read_b128 v[28:31], v4 offset:18432
    v_exp_f32 v72, v72
    v_exp_f32 v73, v73
    v_exp_f32 v74, v74
    v_exp_f32 v75, v75
    v_cvt_pk_bf16_f32 v40, v68, v69
    v_cvt_pk_bf16_f32 v41, v70, v71
    v_cvt_pk_bf16_f32 v42, v72, v73
    v_cvt_pk_bf16_f32 v43, v74, v75
    s_waitcnt lgkmcnt(3)
    v_mfma_f32_32x32x16_bf16 v[60:75], v[20:23], v[12:15], 0
    s_waitcnt lgkmcnt(2)
    s_barrier
    ds_read_b128 v[20:23], v3 offset:0
    v_exp_f32 v44, v44
    v_exp_f32 v45, v45
    v_exp_f32 v46, v46
    v_exp_f32 v47, v47
    v_mfma_f32_32x32x16_bf16 v[76:91], v[32:35], v[40:43], v[76:91]
    ds_read_b128 v[32:35], v4 offset:19456
    v_exp_f32 v48, v48
    v_exp_f32 v49, v49
    v_cvt_pk_bf16_f32 v36, v44, v45
    v_exp_f32 v50, v50
    v_cvt_pk_bf16_f32 v37, v46, v47
    v_exp_f32 v51, v51
    s_waitcnt lgkmcnt(3)
    v_mfma_f32_32x32x16_bf16 v[60:75], v[24:27], v[16:19], v[60:75]
    ds_read_b128 v[24:27], v3 offset:1024
    v_exp_f32 v52, v52
    v_cvt_pk_bf16_f32 v38, v48, v49
    v_exp_f32 v53, v53
    v_cvt_pk_bf16_f32 v39, v50, v51
    v_exp_f32 v54, v54
    v_exp_f32 v55, v55
    s_waitcnt lgkmcnt(3)
    v_mfma_f32_32x32x16_bf16 v[76:91], v[28:31], v[36:39], v[76:91]
    ds_read_b128 v[28:31], v4 offset:22528
    v_exp_f32 v56, v56
    v_exp_f32 v57, v57
    v_exp_f32 v58, v58
    v_exp_f32 v59, v59
    v_cvt_pk_bf16_f32 v40, v52, v53
    v_cvt_pk_bf16_f32 v41, v54, v55
    v_cvt_pk_bf16_f32 v42, v56, v57
    v_cvt_pk_bf16_f32 v43, v58, v59
    s_waitcnt lgkmcnt(3)
    v_mfma_f32_32x32x16_bf16 v[44:59], v[20:23], v[12:15], 0
    ds_read_b128 v[20:23], v3 offset:4096
    v_exp_f32 v60, v60
    v_exp_f32 v61, v61
    v_exp_f32 v62, v62
    v_exp_f32 v63, v63
    s_waitcnt lgkmcnt(3)
    v_mfma_f32_32x32x16_bf16 v[76:91], v[32:35], v[40:43], v[76:91]
    ds_read_b128 v[32:35], v4 offset:23552
    v_exp_f32 v64, v64
    v_exp_f32 v65, v65
    v_cvt_pk_bf16_f32 v36, v60, v61
    v_exp_f32 v66, v66
    v_cvt_pk_bf16_f32 v37, v62, v63
    v_exp_f32 v67, v67
    s_waitcnt lgkmcnt(3)
    v_mfma_f32_32x32x16_bf16 v[44:59], v[24:27], v[16:19], v[44:59]
    ds_read_b128 v[24:27], v3 offset:5120
    v_exp_f32 v68, v68
    v_cvt_pk_bf16_f32 v38, v64, v65
    v_exp_f32 v69, v69
    v_cvt_pk_bf16_f32 v39, v66, v67
    v_exp_f32 v70, v70
    v_exp_f32 v71, v71
    s_waitcnt lgkmcnt(3)
    v_mfma_f32_32x32x16_bf16 v[76:91], v[28:31], v[36:39], v[76:91]
    ds_read_b128 v[28:31], v3 offset:2048
    v_exp_f32 v72, v72
    v_exp_f32 v73, v73
    v_exp_f32 v74, v74
    v_exp_f32 v75, v75
    v_cvt_pk_bf16_f32 v40, v68, v69
    v_cvt_pk_bf16_f32 v41, v70, v71
    v_cvt_pk_bf16_f32 v42, v72, v73
    v_cvt_pk_bf16_f32 v43, v74, v75
    s_waitcnt lgkmcnt(3)
    v_mfma_f32_32x32x16_bf16 v[60:75], v[20:23], v[12:15], 0
    v_exp_f32 v44, v44
    v_exp_f32 v45, v45
    v_exp_f32 v46, v46
    v_exp_f32 v47, v47
    s_waitcnt lgkmcnt(2)
    v_mfma_f32_32x32x16_bf16 v[76:91], v[32:35], v[40:43], v[76:91]
    ds_read_b128 v[32:35], v3 offset:3072
    v_exp_f32 v48, v48
    v_exp_f32 v49, v49
    v_cvt_pk_bf16_f32 v36, v44, v45
    v_exp_f32 v50, v50
    v_cvt_pk_bf16_f32 v37, v46, v47
    v_exp_f32 v51, v51
    s_waitcnt lgkmcnt(2)
    v_mfma_f32_32x32x16_bf16 v[60:75], v[24:27], v[16:19], v[60:75]
    v_exp_f32 v52, v52
    v_cvt_pk_bf16_f32 v38, v48, v49
    v_exp_f32 v53, v53
    v_cvt_pk_bf16_f32 v39, v50, v51
    v_exp_f32 v54, v54
    v_exp_f32 v55, v55
    s_waitcnt lgkmcnt(1)
    v_mfma_f32_32x32x16_bf16 v[76:91], v[28:31], v[36:39], v[76:91]
    ds_read_b128 v[28:31], v3 offset:6144
    v_exp_f32 v56, v56
    v_exp_f32 v57, v57
    v_exp_f32 v58, v58
    v_exp_f32 v59, v59
    v_cvt_pk_bf16_f32 v40, v52, v53
    v_cvt_pk_bf16_f32 v41, v54, v55
    v_cvt_pk_bf16_f32 v42, v56, v57
    v_cvt_pk_bf16_f32 v43, v58, v59
    v_exp_f32 v60, v60
    v_exp_f32 v61, v61
    v_exp_f32 v62, v62
    v_exp_f32 v63, v63
    s_waitcnt lgkmcnt(1)
    v_mfma_f32_32x32x16_bf16 v[76:91], v[32:35], v[40:43], v[76:91]
    ds_read_b128 v[32:35], v3 offset:7168
    v_exp_f32 v64, v64
    v_exp_f32 v65, v65
    v_cvt_pk_bf16_f32 v36, v60, v61
    v_exp_f32 v66, v66
    v_cvt_pk_bf16_f32 v37, v62, v63
    v_exp_f32 v67, v67
    v_exp_f32 v68, v68
    v_cvt_pk_bf16_f32 v38, v64, v65
    v_exp_f32 v69, v69
    v_cvt_pk_bf16_f32 v39, v66, v67
    v_exp_f32 v70, v70
    v_exp_f32 v71, v71
    s_waitcnt lgkmcnt(1)
    v_mfma_f32_32x32x16_bf16 v[76:91], v[28:31], v[36:39], v[76:91]
    v_exp_f32 v72, v72
    v_exp_f32 v73, v73
    v_exp_f32 v74, v74
    v_exp_f32 v75, v75
    v_cvt_pk_bf16_f32 v40, v68, v69
    v_cvt_pk_bf16_f32 v41, v70, v71
    v_cvt_pk_bf16_f32 v42, v72, v73
    v_cvt_pk_bf16_f32 v43, v74, v75
    s_waitcnt lgkmcnt(0)
    s_nop 0
    v_mfma_f32_32x32x16_bf16 v[76:91], v[32:35], v[40:43], v[76:91]
    s_mov_b32 s40, 1400897536
    s_lshl_b32 s41, s37, 12
    s_add_u32 s41, s41, 81920
    v_add_u32 v8, s41, v2
    s_lshl_b32 s41, s36, 2
    s_add_u32 s41, s41, 163776
    v_mov_b32 v7, s41
    s_nop 4
    v_cmp_nge_f32 vcc, s40, v88
    s_mov_b32 s41, vcc_hi
    s_cmp_lg_u32 s41, 0
    s_cselect_b32 s41, 1, 0
    v_mov_b32 v6, s41
    ds_write_b32 v7, v6
    s_cmp_eq_u32 s38, 0
    s_cbranch_scc1 KF_RED0
    ds_write_b128 v8, v[76:79] offset:0
    ds_write_b128 v8, v[80:83] offset:1024
    ds_write_b128 v8, v[84:87] offset:2048
    ds_write_b128 v8, v[88:91] offset:3072
KF_RED0:
    s_waitcnt lgkmcnt(0)
    s_barrier
    v_and_b32 v7, 7, v0
    v_lshlrev_b32 v7, 2, v7
    v_add_u32 v7, 163776, v7
    ds_read_b32 v6, v7
    s_cmp_eq_u32 s38, 0
    s_cbranch_scc0 KF_RED1
    ds_read_b128 v[44:47], v8 offset:0
    ds_read_b128 v[48:51], v8 offset:1024
    ds_read_b128 v[52:55], v8 offset:2048
    ds_read_b128 v[56:59], v8 offset:3072
KF_RED1:
    s_waitcnt lgkmcnt(0)
    v_cmp_ne_u32 vcc, 0, v6
    s_cmp_lg_u32 s53, 0
    s_cbranch_scc1 KF_NOFALL
    s_cbranch_vccnz KF_SLOW
KF_NOFALL:
    v_mov_b32 v10, 163584
    s_lshl_b32 s40, s37, 2
    s_add_u32 s40, s40, 163584
    v_mov_b32 v11, s40
    v_mov_b32 v125, 1
    s_cmp_eq_u32 s38, 0
    s_cbranch_scc0 KF_P3
    v_add_f32 v76, v76, v44
    v_add_f32 v77, v77, v45
    v_add_f32 v78, v78, v46
    v_add_f32 v79, v79, v47
    v_add_f32 v80, v80, v48
    v_add_f32 v81, v81, v49
    v_add_f32 v82, v82, v50
    v_add_f32 v83, v83, v51
    v_add_f32 v84, v84, v52
    v_add_f32 v85, v85, v53
    v_add_f32 v86, v86, v54
    v_add_f32 v87, v87, v55
    v_add_f32 v88, v88, v56
    v_add_f32 v89, v89, v57
    v_add_f32 v90, v90, v58
    v_add_f32 v91, v91, v59
    s_add_u32 s41, s49, 12582912
    v_mov_b32 v6, v88
    v_mov_b32 v7, v88
    s_nop 1
    v_permlane32_swap_b32 v6, v7
    v_rcp_f32 v7, v7
    s_nop 0
    v_mul_f32 v76, v76, v7
    v_mul_f32 v77, v77, v7
    v_mul_f32 v78, v78, v7
    v_mul_f32 v79, v79, v7
    v_mul_f32 v80, v80, v7
    v_mul_f32 v81, v81, v7
    v_mul_f32 v82, v82, v7
    v_mul_f32 v83, v83, v7
    v_mul_f32 v84, v84, v7
    v_mul_f32 v85, v85, v7
    v_mul_f32 v86, v86, v7
    v_mul_f32 v87, v87, v7
    v_mul_f32 v88, v88, v7
    v_mul_f32 v89, v89, v7
    v_mul_f32 v90, v90, v7
    v_mul_f32 v91, v91, v7
    v_cvt_pk_bf16_f32 v76, v76, v77
    v_cvt_pk_bf16_f32 v77, v78, v79
    v_cvt_pk_bf16_f32 v78, v80, v81
    v_cvt_pk_bf16_f32 v79, v82, v83
    v_cvt_pk_bf16_f32 v80, v84, v85
    v_cvt_pk_bf16_f32 v81, v86, v87
    v_cvt_pk_bf16_f32 v82, v88, v89
    v_cvt_pk_bf16_f32 v83, v90, v91
    s_mov_b32 exec_lo, 0
    v_mov_b32 v82, 0
    v_mov_b32 v83, 0
    s_mov_b64 exec, -1
    buffer_store_dwordx4 v[76:79], v2, s[24:27], s41 offen sc1
    buffer_store_dwordx4 v[80:83], v2, s[24:27], s41 offen offset:1024 sc1
    ds_write_b32 v11, v125 offset:0
KF_P3:
    v_and_b32 v124, 3, v0
    v_lshlrev_b32 v124, 2, v124
    v_add_u32 v124, 163584, v124
    s_and_b32 s37, s36, 1
    s_bfe_u32 s39, s36, 0x10001
    s_lshl_b32 s40, s34, 2
    s_and_b32 s41, s35, 3
    s_add_u32 s40, s40, s41
    s_lshl_b32 s40, s40, 1
    s_add_u32 s40, s40, s37
    s_lshr_b32 s42, s35, 2
    s_lshl_b32 s44, s40, 15
    s_mul_i32 s41, s38, 2097152
    s_add_u32 s44, s44, s41
    s_lshl_b32 s41, s39, 14
    s_add_u32 s44, s44, s41
    s_add_u32 s44, s44, 12582912
    s_lshl_b32 s46, s40, 7
    s_add_u32 s46, s46, 16777216
    v_lshrrev_b32 v7, 5, v0
    v_bfe_u32 v8, v0, 2, 2
    v_lshl_add_u32 v7, v7, 2, v8
    v_lshlrev_b32 v7, 7, v7
    v_bfe_u32 v8, v0, 3, 1
    v_lshlrev_b32 v8, 2, v8
    v_bfe_u32 v9, v0, 4, 1
    v_lshl_add_u32 v8, v9, 1, v8
    v_bfe_u32 v9, v0, 1, 1
    v_add_u32 v8, v8, v9
    v_and_b32 v9, 1, v0
    v_lshl_add_u32 v7, v9, 3, v7
    s_cmp_eq_u32 s38, 0
    s_mov_b32 s41, 16384
    s_cselect_b32 s41, 98304, s41
    s_mul_i32 s45, s39, 28672
    s_add_u32 s41, s41, s45
    v_add_u32 v7, s41, v7
    v_lshl_add_u32 v3, v8, 4, v7
    v_xor_b32 v8, 4, v8
    v_lshl_add_u32 v4, v8, 4, v7
    v_and_b32 v1, 31, v0
    v_lshlrev_b32 v9, 2, v1
    s_lshl_b32 s41, s40, 5
    v_add_u32 v1, s41, v1
    v_mul_u32_u24 v6, 896, v1
    v_lshrrev_b32 v7, 5, v0
    v_lshl_add_u32 v6, v7, 4, v6
    s_lshl_b32 s45, s42, 7
    s_lshl_b32 s41, s39, 6
    s_add_u32 s45, s45, s41
    s_mov_b32 s28, s78
    s_and_b32 s29, s79, 0xffff
    s_mov_b32 s30, 1835008
    s_mov_b32 s31, 0x00020000
    s_lshl_b32 s41, s37, 13
    s_add_u32 s41, s41, 0
    v_add_u32 v8, s41, v2
    s_cmp_eq_u32 s38, 0
    s_cbranch_scc1 KF_P3A
    s_cmp_ge_u32 s35, 28
    s_cbranch_scc1 KF_CEND
    s_mov_b32 s63, 0
    s_branch KW1E
KW1:
    s_sleep 1
    s_add_u32 s63, s63, 1
    s_cmp_gt_u32 s63, 524288
    s_cbranch_scc1 KW1X
KW1E:
    ds_read_b32 v7, v10 offset:84
    s_waitcnt lgkmcnt(0)
    v_cmp_gt_u32 vcc, 1, v7
    s_nop 1
    s_cbranch_vccnz KW1
KW1X:
    buffer_load_dwordx4 v[60:63], v2, s[24:27], s44 offen offset:0
    buffer_load_dwordx4 v[64:67], v2, s[24:27], s44 offen offset:1024
    buffer_load_dwordx4 v[68:71], v2, s[24:27], s44 offen offset:2048
    buffer_load_dwordx4 v[72:75], v2, s[24:27], s44 offen offset:3072
    s_add_u32 s44, s44, 4096
    buffer_load_dwordx4 v[76:79], v2, s[24:27], s44 offen offset:0
    buffer_load_dwordx4 v[80:83], v2, s[24:27], s44 offen offset:1024
    buffer_load_dwordx4 v[84:87], v2, s[24:27], s44 offen offset:2048
    buffer_load_dwordx4 v[88:91], v2, s[24:27], s44 offen offset:3072
    s_add_u32 s44, s44, 4096
    buffer_load_dwordx4 v[92:95], v2, s[24:27], s44 offen offset:0
    buffer_load_dwordx4 v[96:99], v2, s[24:27], s44 offen offset:1024
    buffer_load_dwordx4 v[100:103], v2, s[24:27], s44 offen offset:2048
    buffer_load_dwordx4 v[104:107], v2, s[24:27], s44 offen offset:3072
    s_add_u32 s44, s44, 4096
    buffer_load_dwordx4 v[108:111], v2, s[24:27], s44 offen offset:0
    buffer_load_dwordx4 v[112:115], v2, s[24:27], s44 offen offset:1024
    buffer_load_dwordx4 v[116:119], v2, s[24:27], s44 offen offset:2048
    buffer_load_dwordx4 v[120:123], v2, s[24:27], s44 offen offset:3072
    buffer_load_dword v5, v9, s[24:27], s46 offen
    s_mov_b32 s63, 0
    s_branch KW2E
KW2:
    s_sleep 1
    s_add_u32 s63, s63, 1
    s_cmp_gt_u32 s63, 524288
    s_cbranch_scc1 KW2X
KW2E:
    ds_read_b32 v7, v124 offset:32
    s_waitcnt lgkmcnt(0)
    v_cmp_gt_u32 vcc, 1, v7
    s_nop 1
    s_cbranch_vccnz KW2
KW2X:
    ds_read_b64_tr_b16 v[12:13], v3 offset:0
    ds_read_b64_tr_b16 v[14:15], v3 offset:1024
    ds_read_b64_tr_b16 v[16:17], v4 offset:0
    ds_read_b64_tr_b16 v[18:19], v4 offset:1024
    s_waitcnt vmcnt(16) lgkmcnt(0)
    v_mfma_f32_32x32x16_bf16 v[28:43], v[12:15], v[60:63], 0
    ds_read_b64_tr_b16 v[20:21], v3 offset:2048
    ds_read_b64_tr_b16 v[22:23], v3 offset:3072
    ds_read_b64_tr_b16 v[24:25], v4 offset:2048
    ds_read_b64_tr_b16 v[26:27], v4 offset:3072
    v_mfma_f32_32x32x16_bf16 v[44:59], v[16:19], v[60:63], 0
    s_waitcnt vmcnt(15) lgkmcnt(0)
    v_mfma_f32_32x32x16_bf16 v[28:43], v[20:23], v[64:67], v[28:43]
    ds_read_b64_tr_b16 v[12:13], v3 offset:3584
    ds_read_b64_tr_b16 v[14:15], v3 offset:4608
    ds_read_b64_tr_b16 v[16:17], v4 offset:3584
    ds_read_b64_tr_b16 v[18:19], v4 offset:4608
    v_mfma_f32_32x32x16_bf16 v[44:59], v[24:27], v[64:67], v[44:59]
    s_waitcnt vmcnt(14) lgkmcnt(0)
    v_mfma_f32_32x32x16_bf16 v[28:43], v[12:15], v[68:71], v[28:43]
    ds_read_b64_tr_b16 v[20:21], v3 offset:5632
    ds_read_b64_tr_b16 v[22:23], v3 offset:6656
    ds_read_b64_tr_b16 v[24:25], v4 offset:5632
    ds_read_b64_tr_b16 v[26:27], v4 offset:6656
    v_mfma_f32_32x32x16_bf16 v[44:59], v[16:19], v[68:71], v[44:59]
    s_waitcnt vmcnt(13) lgkmcnt(0)
    v_mfma_f32_32x32x16_bf16 v[28:43], v[20:23], v[72:75], v[28:43]
    ds_read_b64_tr_b16 v[12:13], v3 offset:7168
    ds_read_b64_tr_b16 v[14:15], v3 offset:8192
    ds_read_b64_tr_b16 v[16:17], v4 offset:7168
    ds_read_b64_tr_b16 v[18:19], v4 offset:8192
    v_mfma_f32_32x32x16_bf16 v[44:59], v[24:27], v[72:75], v[44:59]
    s_waitcnt vmcnt(12) lgkmcnt(0)
    v_mfma_f32_32x32x16_bf16 v[28:43], v[12:15], v[76:79], v[28:43]
    ds_read_b64_tr_b16 v[20:21], v3 offset:9216
    ds_read_b64_tr_b16 v[22:23], v3 offset:10240
    ds_read_b64_tr_b16 v[24:25], v4 offset:9216
    ds_read_b64_tr_b16 v[26:27], v4 offset:10240
    v_mfma_f32_32x32x16_bf16 v[44:59], v[16:19], v[76:79], v[44:59]
    s_waitcnt vmcnt(11) lgkmcnt(0)
    v_mfma_f32_32x32x16_bf16 v[28:43], v[20:23], v[80:83], v[28:43]
    ds_read_b64_tr_b16 v[12:13], v3 offset:10752
    ds_read_b64_tr_b16 v[14:15], v3 offset:11776
    ds_read_b64_tr_b16 v[16:17], v4 offset:10752
    ds_read_b64_tr_b16 v[18:19], v4 offset:11776
    v_mfma_f32_32x32x16_bf16 v[44:59], v[24:27], v[80:83], v[44:59]
    s_waitcnt vmcnt(10) lgkmcnt(0)
    v_mfma_f32_32x32x16_bf16 v[28:43], v[12:15], v[84:87], v[28:43]
    ds_read_b64_tr_b16 v[20:21], v3 offset:12800
    ds_read_b64_tr_b16 v[22:23], v3 offset:13824
    ds_read_b64_tr_b16 v[24:25], v4 offset:12800
    ds_read_b64_tr_b16 v[26:27], v4 offset:13824
    v_mfma_f32_32x32x16_bf16 v[44:59], v[16:19], v[84:87], v[44:59]
    s_waitcnt vmcnt(9) lgkmcnt(0)
    v_mfma_f32_32x32x16_bf16 v[28:43], v[20:23], v[88:91], v[28:43]
    ds_read_b64_tr_b16 v[12:13], v3 offset:14336
    ds_read_b64_tr_b16 v[14:15], v3 offset:15360
    ds_read_b64_tr_b16 v[16:17], v4 offset:14336
    ds_read_b64_tr_b16 v[18:19], v4 offset:15360
    v_mfma_f32_32x32x16_bf16 v[44:59], v[24:27], v[88:91], v[44:59]
    s_waitcnt vmcnt(8) lgkmcnt(0)
    v_mfma_f32_32x32x16_bf16 v[28:43], v[12:15], v[92:95], v[28:43]
    ds_read_b64_tr_b16 v[20:21], v3 offset:16384
    ds_read_b64_tr_b16 v[22:23], v3 offset:17408
    ds_read_b64_tr_b16 v[24:25], v4 offset:16384
    ds_read_b64_tr_b16 v[26:27], v4 offset:17408
    v_mfma_f32_32x32x16_bf16 v[44:59], v[16:19], v[92:95], v[44:59]
    s_waitcnt vmcnt(7) lgkmcnt(0)
    v_mfma_f32_32x32x16_bf16 v[28:43], v[20:23], v[96:99], v[28:43]
    ds_read_b64_tr_b16 v[12:13], v3 offset:17920
    ds_read_b64_tr_b16 v[14:15], v3 offset:18944
    ds_read_b64_tr_b16 v[16:17], v4 offset:17920
    ds_read_b64_tr_b16 v[18:19], v4 offset:18944
    v_mfma_f32_32x32x16_bf16 v[44:59], v[24:27], v[96:99], v[44:59]
    s_waitcnt vmcnt(6) lgkmcnt(0)
    v_mfma_f32_32x32x16_bf16 v[28:43], v[12:15], v[100:103], v[28:43]
    ds_read_b64_tr_b16 v[20:21], v3 offset:19968
    ds_read_b64_tr_b16 v[22:23], v3 offset:20992
    ds_read_b64_tr_b16 v[24:25], v4 offset:19968
    ds_read_b64_tr_b16 v[26:27], v4 offset:20992
    v_mfma_f32_32x32x16_bf16 v[44:59], v[16:19], v[100:103], v[44:59]
    s_waitcnt vmcnt(5) lgkmcnt(0)
    v_mfma_f32_32x32x16_bf16 v[28:43], v[20:23], v[104:107], v[28:43]
    ds_read_b64_tr_b16 v[12:13], v3 offset:21504
    ds_read_b64_tr_b16 v[14:15], v3 offset:22528
    ds_read_b64_tr_b16 v[16:17], v4 offset:21504
    ds_read_b64_tr_b16 v[18:19], v4 offset:22528
    v_mfma_f32_32x32x16_bf16 v[44:59], v[24:27], v[104:107], v[44:59]
    s_waitcnt vmcnt(4) lgkmcnt(0)
    v_mfma_f32_32x32x16_bf16 v[28:43], v[12:15], v[108:111], v[28:43]
    ds_read_b64_tr_b16 v[20:21], v3 offset:23552
    ds_read_b64_tr_b16 v[22:23], v3 offset:24576
    ds_read_b64_tr_b16 v[24:25], v4 offset:23552
    ds_read_b64_tr_b16 v[26:27], v4 offset:24576
    v_mfma_f32_32x32x16_bf16 v[44:59], v[16:19], v[108:111], v[44:59]
    s_waitcnt vmcnt(3) lgkmcnt(0)
    v_mfma_f32_32x32x16_bf16 v[28:43], v[20:23], v[112:115], v[28:43]
    ds_read_b64_tr_b16 v[12:13], v3 offset:25088
    ds_read_b64_tr_b16 v[14:15], v3 offset:26112
    ds_read_b64_tr_b16 v[16:17], v4 offset:25088
    ds_read_b64_tr_b16 v[18:19], v4 offset:26112
    v_mfma_f32_32x32x16_bf16 v[44:59], v[24:27], v[112:115], v[44:59]
    s_waitcnt vmcnt(2) lgkmcnt(0)
    v_mfma_f32_32x32x16_bf16 v[28:43], v[12:15], v[116:119], v[28:43]
    ds_read_b64_tr_b16 v[20:21], v3 offset:27136
    ds_read_b64_tr_b16 v[22:23], v3 offset:28160
    ds_read_b64_tr_b16 v[24:25], v4 offset:27136
    ds_read_b64_tr_b16 v[26:27], v4 offset:28160
    v_mfma_f32_32x32x16_bf16 v[44:59], v[16:19], v[116:119], v[44:59]
    s_waitcnt vmcnt(1) lgkmcnt(0)
    v_mfma_f32_32x32x16_bf16 v[28:43], v[20:23], v[120:123], v[28:43]
    v_mfma_f32_32x32x16_bf16 v[44:59], v[24:27], v[120:123], v[44:59]
    s_waitcnt vmcnt(0)
    v_sub_f32 v5, 1.0, v5
    s_cmp_eq_u32 s39, 0
    s_cbranch_scc1 KF_P3B0
    s_nop 6
    ds_write_b128 v8, v[28:31] offset:0
    ds_write_b128 v8, v[32:35] offset:1024
    ds_write_b128 v8, v[36:39] offset:2048
    ds_write_b128 v8, v[40:43] offset:3072
    ds_write_b128 v8, v[44:47] offset:4096
    ds_write_b128 v8, v[48:51] offset:5120
    ds_write_b128 v8, v[52:55] offset:6144
    ds_write_b128 v8, v[56:59] offset:7168
    s_waitcnt lgkmcnt(0)
    ds_write_b32 v11, v125 offset:64
    s_branch KF_CEND
KF_P3B0:
    s_mov_b32 s63, 0
    s_branch KW3E
KW3:
    s_sleep 1
    s_add_u32 s63, s63, 1
    s_cmp_gt_u32 s63, 524288
    s_cbranch_scc1 KW3X
KW3E:
    ds_read_b32 v7, v11 offset:72
    s_waitcnt lgkmcnt(0)
    v_cmp_gt_u32 vcc, 1, v7
    s_nop 1
    s_cbranch_vccnz KW3
KW3X:
    ds_read_b128 v[60:63], v8 offset:0
    ds_read_b128 v[64:67], v8 offset:1024
    ds_read_b128 v[68:71], v8 offset:2048
    ds_read_b128 v[72:75], v8 offset:3072
    ds_read_b128 v[76:79], v8 offset:4096
    ds_read_b128 v[80:83], v8 offset:5120
    ds_read_b128 v[84:87], v8 offset:6144
    ds_read_b128 v[88:91], v8 offset:7168
    s_waitcnt lgkmcnt(0)
    v_add_f32 v28, v28, v60
    v_add_f32 v29, v29, v61
    v_add_f32 v30, v30, v62
    v_add_f32 v31, v31, v63
    v_add_f32 v32, v32, v64
    v_add_f32 v33, v33, v65
    v_add_f32 v34, v34, v66
    v_add_f32 v35, v35, v67
    v_add_f32 v36, v36, v68
    v_add_f32 v37, v37, v69
    v_add_f32 v38, v38, v70
    v_add_f32 v39, v39, v71
    v_add_f32 v40, v40, v72
    v_add_f32 v41, v41, v73
    v_add_f32 v42, v42, v74
    v_add_f32 v43, v43, v75
    v_add_f32 v44, v44, v76
    v_add_f32 v45, v45, v77
    v_add_f32 v46, v46, v78
    v_add_f32 v47, v47, v79
    v_add_f32 v48, v48, v80
    v_add_f32 v49, v49, v81
    v_add_f32 v50, v50, v82
    v_add_f32 v51, v51, v83
    v_add_f32 v52, v52, v84
    v_add_f32 v53, v53, v85
    v_add_f32 v54, v54, v86
    v_add_f32 v55, v55, v87
    v_add_f32 v56, v56, v88
    v_add_f32 v57, v57, v89
    v_add_f32 v58, v58, v90
    v_add_f32 v59, v59, v91
    v_mul_f32 v28, v28, v5
    v_mul_f32 v29, v29, v5
    v_mul_f32 v30, v30, v5
    v_mul_f32 v31, v31, v5
    v_mul_f32 v32, v32, v5
    v_mul_f32 v33, v33, v5
    v_mul_f32 v34, v34, v5
    v_mul_f32 v35, v35, v5
    v_mul_f32 v36, v36, v5
    v_mul_f32 v37, v37, v5
    v_mul_f32 v38, v38, v5
    v_mul_f32 v39, v39, v5
    v_mul_f32 v40, v40, v5
    v_mul_f32 v41, v41, v5
    v_mul_f32 v42, v42, v5
    v_mul_f32 v43, v43, v5
    v_mul_f32 v44, v44, v5
    v_mul_f32 v45, v45, v5
    v_mul_f32 v46, v46, v5
    v_mul_f32 v47, v47, v5
    v_mul_f32 v48, v48, v5
    v_mul_f32 v49, v49, v5
    v_mul_f32 v50, v50, v5
    v_mul_f32 v51, v51, v5
    v_mul_f32 v52, v52, v5
    v_mul_f32 v53, v53, v5
    v_mul_f32 v54, v54, v5
    v_mul_f32 v55, v55, v5
    v_mul_f32 v56, v56, v5
    v_mul_f32 v57, v57, v5
    v_mul_f32 v58, v58, v5
    v_mul_f32 v59, v59, v5
    ds_write_b128 v8, v[28:31] offset:0
    ds_write_b128 v8, v[32:35] offset:1024
    ds_write_b128 v8, v[36:39] offset:2048
    ds_write_b128 v8, v[40:43] offset:3072
    ds_write_b128 v8, v[44:47] offset:4096
    ds_write_b128 v8, v[48:51] offset:5120
    ds_write_b128 v8, v[52:55] offset:6144
    ds_write_b128 v8, v[56:59] offset:7168
    s_waitcnt lgkmcnt(0)
    ds_write_b32 v11, v125 offset:64
    s_branch KF_CEND
KF_P3A:
    s_waitcnt vmcnt(0)
    ds_write_b32 v11, v125 offset:16
    s_cmp_ge_u32 s35, 28
    s_cbranch_scc1 KF_CEND
    s_mov_b32 s63, 0
    s_branch KW4E
KW4:
    s_sleep 1
    s_add_u32 s63, s63, 1
    s_cmp_gt_u32 s63, 524288
    s_cbranch_scc1 KW4X
KW4E:
    ds_read_b32 v7, v10 offset:80
    s_waitcnt lgkmcnt(0)
    v_cmp_gt_u32 vcc, 1, v7
    s_nop 1
    s_cbranch_vccnz KW4
KW4X:
    buffer_load_dwordx4 v[60:63], v2, s[24:27], s44 offen offset:0
    buffer_load_dwordx4 v[64:67], v2, s[24:27], s44 offen offset:1024
    buffer_load_dwordx4 v[68:71], v2, s[24:27], s44 offen offset:2048
    buffer_load_dwordx4 v[72:75], v2, s[24:27], s44 offen offset:3072
    s_add_u32 s44, s44, 4096
    buffer_load_dwordx4 v[76:79], v2, s[24:27], s44 offen offset:0
    buffer_load_dwordx4 v[80:83], v2, s[24:27], s44 offen offset:1024
    buffer_load_dwordx4 v[84:87], v2, s[24:27], s44 offen offset:2048
    buffer_load_dwordx4 v[88:91], v2, s[24:27], s44 offen offset:3072
    s_add_u32 s44, s44, 4096
    buffer_load_dwordx4 v[92:95], v2, s[24:27], s44 offen offset:0
    buffer_load_dwordx4 v[96:99], v2, s[24:27], s44 offen offset:1024
    buffer_load_dwordx4 v[100:103], v2, s[24:27], s44 offen offset:2048
    buffer_load_dwordx4 v[104:107], v2, s[24:27], s44 offen offset:3072
    s_add_u32 s44, s44, 4096
    buffer_load_dwordx4 v[108:111], v2, s[24:27], s44 offen offset:0
    buffer_load_dwordx4 v[112:115], v2, s[24:27], s44 offen offset:1024
    buffer_load_dwordx4 v[116:119], v2, s[24:27], s44 offen offset:2048
    buffer_load_dwordx4 v[120:123], v2, s[24:27], s44 offen offset:3072
    buffer_load_dword v5, v9, s[24:27], s46 offen
    ds_read_b64_tr_b16 v[12:13], v3 offset:0
    ds_read_b64_tr_b16 v[14:15], v3 offset:1024
    ds_read_b64_tr_b16 v[16:17], v4 offset:0
    ds_read_b64_tr_b16 v[18:19], v4 offset:1024
    s_waitcnt vmcnt(16) lgkmcnt(0)
    v_mfma_f32_32x32x16_bf16 v[28:43], v[12:15], v[60:63], 0
    ds_read_b64_tr_b16 v[20:21], v3 offset:2048
    ds_read_b64_tr_b16 v[22:23], v3 offset:3072
    ds_read_b64_tr_b16 v[24:25], v4 offset:2048
    ds_read_b64_tr_b16 v[26:27], v4 offset:3072
    v_mfma_f32_32x32x16_bf16 v[44:59], v[16:19], v[60:63], 0
    s_waitcnt vmcnt(15) lgkmcnt(0)
    v_mfma_f32_32x32x16_bf16 v[28:43], v[20:23], v[64:67], v[28:43]
    ds_read_b64_tr_b16 v[12:13], v3 offset:3584
    ds_read_b64_tr_b16 v[14:15], v3 offset:4608
    ds_read_b64_tr_b16 v[16:17], v4 offset:3584
    ds_read_b64_tr_b16 v[18:19], v4 offset:4608
    v_mfma_f32_32x32x16_bf16 v[44:59], v[24:27], v[64:67], v[44:59]
    s_waitcnt vmcnt(14) lgkmcnt(0)
    v_mfma_f32_32x32x16_bf16 v[28:43], v[12:15], v[68:71], v[28:43]
    ds_read_b64_tr_b16 v[20:21], v3 offset:5632
    ds_read_b64_tr_b16 v[22:23], v3 offset:6656
    ds_read_b64_tr_b16 v[24:25], v4 offset:5632
    ds_read_b64_tr_b16 v[26:27], v4 offset:6656
    v_mfma_f32_32x32x16_bf16 v[44:59], v[16:19], v[68:71], v[44:59]
    s_waitcnt vmcnt(13) lgkmcnt(0)
    v_mfma_f32_32x32x16_bf16 v[28:43], v[20:23], v[72:75], v[28:43]
    ds_read_b64_tr_b16 v[12:13], v3 offset:7168
    ds_read_b64_tr_b16 v[14:15], v3 offset:8192
    ds_read_b64_tr_b16 v[16:17], v4 offset:7168
    ds_read_b64_tr_b16 v[18:19], v4 offset:8192
    v_mfma_f32_32x32x16_bf16 v[44:59], v[24:27], v[72:75], v[44:59]
    s_waitcnt vmcnt(12) lgkmcnt(0)
    v_mfma_f32_32x32x16_bf16 v[28:43], v[12:15], v[76:79], v[28:43]
    ds_read_b64_tr_b16 v[20:21], v3 offset:9216
    ds_read_b64_tr_b16 v[22:23], v3 offset:10240
    ds_read_b64_tr_b16 v[24:25], v4 offset:9216
    ds_read_b64_tr_b16 v[26:27], v4 offset:10240
    v_mfma_f32_32x32x16_bf16 v[44:59], v[16:19], v[76:79], v[44:59]
    s_waitcnt vmcnt(11) lgkmcnt(0)
    v_mfma_f32_32x32x16_bf16 v[28:43], v[20:23], v[80:83], v[28:43]
    ds_read_b64_tr_b16 v[12:13], v3 offset:10752
    ds_read_b64_tr_b16 v[14:15], v3 offset:11776
    ds_read_b64_tr_b16 v[16:17], v4 offset:10752
    ds_read_b64_tr_b16 v[18:19], v4 offset:11776
    v_mfma_f32_32x32x16_bf16 v[44:59], v[24:27], v[80:83], v[44:59]
    s_waitcnt vmcnt(10) lgkmcnt(0)
    v_mfma_f32_32x32x16_bf16 v[28:43], v[12:15], v[84:87], v[28:43]
    ds_read_b64_tr_b16 v[20:21], v3 offset:12800
    ds_read_b64_tr_b16 v[22:23], v3 offset:13824
    ds_read_b64_tr_b16 v[24:25], v4 offset:12800
    ds_read_b64_tr_b16 v[26:27], v4 offset:13824
    v_mfma_f32_32x32x16_bf16 v[44:59], v[16:19], v[84:87], v[44:59]
    s_waitcnt vmcnt(9) lgkmcnt(0)
    v_mfma_f32_32x32x16_bf16 v[28:43], v[20:23], v[88:91], v[28:43]
    ds_read_b64_tr_b16 v[12:13], v3 offset:14336
    ds_read_b64_tr_b16 v[14:15], v3 offset:15360
    ds_read_b64_tr_b16 v[16:17], v4 offset:14336
    ds_read_b64_tr_b16 v[18:19], v4 offset:15360
    v_mfma_f32_32x32x16_bf16 v[44:59], v[24:27], v[88:91], v[44:59]
    s_waitcnt vmcnt(8) lgkmcnt(0)
    v_mfma_f32_32x32x16_bf16 v[28:43], v[12:15], v[92:95], v[28:43]
    ds_read_b64_tr_b16 v[20:21], v3 offset:16384
    ds_read_b64_tr_b16 v[22:23], v3 offset:17408
    ds_read_b64_tr_b16 v[24:25], v4 offset:16384
    ds_read_b64_tr_b16 v[26:27], v4 offset:17408
    v_mfma_f32_32x32x16_bf16 v[44:59], v[16:19], v[92:95], v[44:59]
    s_waitcnt vmcnt(7) lgkmcnt(0)
    v_mfma_f32_32x32x16_bf16 v[28:43], v[20:23], v[96:99], v[28:43]
    ds_read_b64_tr_b16 v[12:13], v3 offset:17920
    ds_read_b64_tr_b16 v[14:15], v3 offset:18944
    ds_read_b64_tr_b16 v[16:17], v4 offset:17920
    ds_read_b64_tr_b16 v[18:19], v4 offset:18944
    v_mfma_f32_32x32x16_bf16 v[44:59], v[24:27], v[96:99], v[44:59]
    s_waitcnt vmcnt(6) lgkmcnt(0)
    v_mfma_f32_32x32x16_bf16 v[28:43], v[12:15], v[100:103], v[28:43]
    ds_read_b64_tr_b16 v[20:21], v3 offset:19968
    ds_read_b64_tr_b16 v[22:23], v3 offset:20992
    ds_read_b64_tr_b16 v[24:25], v4 offset:19968
    ds_read_b64_tr_b16 v[26:27], v4 offset:20992
    v_mfma_f32_32x32x16_bf16 v[44:59], v[16:19], v[100:103], v[44:59]
    s_waitcnt vmcnt(5) lgkmcnt(0)
    v_mfma_f32_32x32x16_bf16 v[28:43], v[20:23], v[104:107], v[28:43]
    ds_read_b64_tr_b16 v[12:13], v3 offset:21504
    ds_read_b64_tr_b16 v[14:15], v3 offset:22528
    ds_read_b64_tr_b16 v[16:17], v4 offset:21504
    ds_read_b64_tr_b16 v[18:19], v4 offset:22528
    v_mfma_f32_32x32x16_bf16 v[44:59], v[24:27], v[104:107], v[44:59]
    s_waitcnt vmcnt(4) lgkmcnt(0)
    v_mfma_f32_32x32x16_bf16 v[28:43], v[12:15], v[108:111], v[28:43]
    ds_read_b64_tr_b16 v[20:21], v3 offset:23552
    ds_read_b64_tr_b16 v[22:23], v3 offset:24576
    ds_read_b64_tr_b16 v[24:25], v4 offset:23552
    ds_read_b64_tr_b16 v[26:27], v4 offset:24576
    v_mfma_f32_32x32x16_bf16 v[44:59], v[16:19], v[108:111], v[44:59]
    s_waitcnt vmcnt(3) lgkmcnt(0)
    v_mfma_f32_32x32x16_bf16 v[28:43], v[20:23], v[112:115], v[28:43]
    ds_read_b64_tr_b16 v[12:13], v3 offset:25088
    ds_read_b64_tr_b16 v[14:15], v3 offset:26112
    ds_read_b64_tr_b16 v[16:17], v4 offset:25088
    ds_read_b64_tr_b16 v[18:19], v4 offset:26112
    v_mfma_f32_32x32x16_bf16 v[44:59], v[24:27], v[112:115], v[44:59]
    s_waitcnt vmcnt(2) lgkmcnt(0)
    v_mfma_f32_32x32x16_bf16 v[28:43], v[12:15], v[116:119], v[28:43]
    ds_read_b64_tr_b16 v[20:21], v3 offset:27136
    ds_read_b64_tr_b16 v[22:23], v3 offset:28160
    ds_read_b64_tr_b16 v[24:25], v4 offset:27136
    ds_read_b64_tr_b16 v[26:27], v4 offset:28160
    v_mfma_f32_32x32x16_bf16 v[44:59], v[16:19], v[116:119], v[44:59]
    s_waitcnt vmcnt(1) lgkmcnt(0)
    v_mfma_f32_32x32x16_bf16 v[28:43], v[20:23], v[120:123], v[28:43]
    v_mfma_f32_32x32x16_bf16 v[44:59], v[24:27], v[120:123], v[44:59]
    s_waitcnt vmcnt(0)
    s_lshl_b32 s41, s39, 12
    v_add_u32 v7, s41, v8
    v_add_u32 v13, 81920, v7
    v_xor_b32 v9, 4096, v13
    v_xor_b32 v1, 8, v11
    s_lshl_b32 s41, s37, 2
    s_add_u32 s41, s41, 163584
    v_mov_b32 v124, s41
    s_nop 3
    s_cmp_eq_u32 s39, 0
    s_cbranch_scc0 KF_P3A1
    ds_write_b128 v9, v[44:47] offset:0
    ds_write_b128 v9, v[48:51] offset:1024
    ds_write_b128 v9, v[52:55] offset:2048
    ds_write_b128 v9, v[56:59] offset:3072
    s_waitcnt lgkmcnt(0)
    ds_write_b32 v11, v125 offset:48
    s_mov_b32 s63, 0
    s_branch KW5E
KW5:
    s_sleep 1
    s_add_u32 s63, s63, 1
    s_cmp_gt_u32 s63, 524288
    s_cbranch_scc1 KW5X
KW5E:
    ds_read_b32 v12, v124 offset:64
    s_waitcnt lgkmcnt(0)
    v_cmp_gt_u32 vcc, 1, v12
    s_nop 1
    s_cbranch_vccnz KW5
KW5X:
    ds_read_b128 v[76:79], v7 offset:0
    ds_read_b128 v[80:83], v7 offset:1024
    ds_read_b128 v[84:87], v7 offset:2048
    ds_read_b128 v[88:91], v7 offset:3072
    s_mov_b32 s63, 0
    s_branch KW6E
KW6:
    s_sleep 1
    s_add_u32 s63, s63, 1
    s_cmp_gt_u32 s63, 524288
    s_cbranch_scc1 KW6X
KW6E:
    ds_read_b32 v12, v1 offset:48
    s_waitcnt lgkmcnt(0)
    v_cmp_gt_u32 vcc, 1, v12
    s_nop 1
    s_cbranch_vccnz KW6
KW6X:
    ds_read_b128 v[60:63], v13 offset:0
    ds_read_b128 v[64:67], v13 offset:1024
    ds_read_b128 v[68:71], v13 offset:2048
    ds_read_b128 v[72:75], v13 offset:3072
    s_waitcnt lgkmcnt(0)
    v_add_f32 v28, v28, v60
    v_add_f32 v29, v29, v61
    v_add_f32 v30, v30, v62
    v_add_f32 v31, v31, v63
    v_add_f32 v32, v32, v64
    v_add_f32 v33, v33, v65
    v_add_f32 v34, v34, v66
    v_add_f32 v35, v35, v67
    v_add_f32 v36, v36, v68
    v_add_f32 v37, v37, v69
    v_add_f32 v38, v38, v70
    v_add_f32 v39, v39, v71
    v_add_f32 v40, v40, v72
    v_add_f32 v41, v41, v73
    v_add_f32 v42, v42, v74
    v_add_f32 v43, v43, v75
    v_fma_f32 v28, v28, v5, v76
    v_fma_f32 v29, v29, v5, v77
    v_fma_f32 v30, v30, v5, v78
    v_fma_f32 v31, v31, v5, v79
    v_fma_f32 v32, v32, v5, v80
    v_fma_f32 v33, v33, v5, v81
    v_fma_f32 v34, v34, v5, v82
    v_fma_f32 v35, v35, v5, v83
    v_fma_f32 v36, v36, v5, v84
    v_fma_f32 v37, v37, v5, v85
    v_fma_f32 v38, v38, v5, v86
    v_fma_f32 v39, v39, v5, v87
    v_fma_f32 v40, v40, v5, v88
    v_fma_f32 v41, v41, v5, v89
    v_fma_f32 v42, v42, v5, v90
    v_fma_f32 v43, v43, v5, v91
    v_cvt_pk_bf16_f32 v28, v28, v29
    v_cvt_pk_bf16_f32 v29, v30, v31
    v_cvt_pk_bf16_f32 v30, v32, v33
    v_cvt_pk_bf16_f32 v31, v34, v35
    v_cvt_pk_bf16_f32 v32, v36, v37
    v_cvt_pk_bf16_f32 v33, v38, v39
    v_cvt_pk_bf16_f32 v34, v40, v41
    v_cvt_pk_bf16_f32 v35, v42, v43
    v_permlane32_swap_b32 v28, v30
    v_permlane32_swap_b32 v29, v31
    v_permlane32_swap_b32 v32, v34
    v_permlane32_swap_b32 v33, v35
    buffer_store_dwordx4 v[28:31], v6, s[28:31], s45 offen offset:0
    buffer_store_dwordx4 v[32:35], v6, s[28:31], s45 offen offset:32
    s_branch KF_CEND
KF_P3A1:
    ds_write_b128 v9, v[28:31] offset:0
    ds_write_b128 v9, v[32:35] offset:1024
    ds_write_b128 v9, v[36:39] offset:2048
    ds_write_b128 v9, v[40:43] offset:3072
    s_waitcnt lgkmcnt(0)
    ds_write_b32 v11, v125 offset:48
    s_mov_b32 s63, 0
    s_branch KW7E
KW7:
    s_sleep 1
    s_add_u32 s63, s63, 1
    s_cmp_gt_u32 s63, 524288
    s_cbranch_scc1 KW7X
KW7E:
    ds_read_b32 v12, v124 offset:64
    s_waitcnt lgkmcnt(0)
    v_cmp_gt_u32 vcc, 1, v12
    s_nop 1
    s_cbranch_vccnz KW7
KW7X:
    ds_read_b128 v[76:79], v7 offset:0
    ds_read_b128 v[80:83], v7 offset:1024
    ds_read_b128 v[84:87], v7 offset:2048
    ds_read_b128 v[88:91], v7 offset:3072
    s_mov_b32 s63, 0
    s_branch KW8E
KW8:
    s_sleep 1
    s_add_u32 s63, s63, 1
    s_cmp_gt_u32 s63, 524288
    s_cbranch_scc1 KW8X
KW8E:
    ds_read_b32 v12, v1 offset:48
    s_waitcnt lgkmcnt(0)
    v_cmp_gt_u32 vcc, 1, v12
    s_nop 1
    s_cbranch_vccnz KW8
KW8X:
    ds_read_b128 v[60:63], v13 offset:0
    ds_read_b128 v[64:67], v13 offset:1024
    ds_read_b128 v[68:71], v13 offset:2048
    ds_read_b128 v[72:75], v13 offset:3072
    s_waitcnt lgkmcnt(0)
    v_add_f32 v44, v44, v60
    v_add_f32 v45, v45, v61
    v_add_f32 v46, v46, v62
    v_add_f32 v47, v47, v63
    v_add_f32 v48, v48, v64
    v_add_f32 v49, v49, v65
    v_add_f32 v50, v50, v66
    v_add_f32 v51, v51, v67
    v_add_f32 v52, v52, v68
    v_add_f32 v53, v53, v69
    v_add_f32 v54, v54, v70
    v_add_f32 v55, v55, v71
    v_add_f32 v56, v56, v72
    v_add_f32 v57, v57, v73
    v_add_f32 v58, v58, v74
    v_add_f32 v59, v59, v75
    v_fma_f32 v44, v44, v5, v76
    v_fma_f32 v45, v45, v5, v77
    v_fma_f32 v46, v46, v5, v78
    v_fma_f32 v47, v47, v5, v79
    v_fma_f32 v48, v48, v5, v80
    v_fma_f32 v49, v49, v5, v81
    v_fma_f32 v50, v50, v5, v82
    v_fma_f32 v51, v51, v5, v83
    v_fma_f32 v52, v52, v5, v84
    v_fma_f32 v53, v53, v5, v85
    v_fma_f32 v54, v54, v5, v86
    v_fma_f32 v55, v55, v5, v87
    v_fma_f32 v56, v56, v5, v88
    v_fma_f32 v57, v57, v5, v89
    v_fma_f32 v58, v58, v5, v90
    v_fma_f32 v59, v59, v5, v91
    v_cvt_pk_bf16_f32 v44, v44, v45
    v_cvt_pk_bf16_f32 v45, v46, v47
    v_cvt_pk_bf16_f32 v46, v48, v49
    v_cvt_pk_bf16_f32 v47, v50, v51
    v_cvt_pk_bf16_f32 v48, v52, v53
    v_cvt_pk_bf16_f32 v49, v54, v55
    v_cvt_pk_bf16_f32 v50, v56, v57
    v_cvt_pk_bf16_f32 v51, v58, v59
    v_permlane32_swap_b32 v44, v46
    v_permlane32_swap_b32 v45, v47
    v_permlane32_swap_b32 v48, v50
    v_permlane32_swap_b32 v49, v51
    buffer_store_dwordx4 v[44:47], v6, s[28:31], s45 offen offset:0
    buffer_store_dwordx4 v[48:51], v6, s[28:31], s45 offen offset:32
KF_CEND:
    s_endpgm
KF_SLOW:
    s_mov_b32 exec_lo, 0
    v_mov_b32 v18, 0
    v_mov_b32 v19, 0
    s_mov_b64 exec, -1
    v_mov_b32 v5, 0xff800000
    s_mov_b32 s46, 0
KF_SLOWLOOP:
    buffer_load_dwordx4 v[20:23], v2, s[20:23], s46 offen
    buffer_load_dwordx4 v[24:27], v2, s[20:23], s46 offen offset:1024
    s_waitcnt vmcnt(0)
    v_mfma_f32_32x32x16_bf16 v[44:59], v[20:23], v[12:15], 0
    v_mfma_f32_32x32x16_bf16 v[44:59], v[24:27], v[16:19], v[44:59]
    s_nop 11
    v_max3_f32 v5, v5, v44, v45
    v_max3_f32 v5, v5, v46, v47
    v_max3_f32 v5, v5, v48, v49
    v_max3_f32 v5, v5, v50, v51
    v_max3_f32 v5, v5, v52, v53
    v_max3_f32 v5, v5, v54, v55
    v_max3_f32 v5, v5, v56, v57
    v_max3_f32 v5, v5, v58, v59
    s_add_u32 s46, s46, 4096
    s_cmp_lt_u32 s46, 0x40000
    s_cbranch_scc1 KF_SLOWLOOP
    v_mov_b32 v6, v5
    s_nop 1
    v_permlane32_swap_b32 v5, v6
    v_max_f32 v5, v5, v6
    s_mov_b32 s53, 1
    s_barrier
    s_branch KF_RESTART
KF_LOADER:
    s_sub_u32 s37, s36, 8
    v_lshrrev_b32 v3, 3, v0
    v_mul_u32_u24 v7, 896, v3
    v_and_b32 v4, 7, v0
    v_lshrrev_b32 v5, 4, v0
    v_xor_b32 v6, v4, v5
    v_lshl_add_u32 v8, v6, 4, v7
    v_xor_b32 v6, 4, v6
    v_lshl_add_u32 v9, v6, 4, v7
    s_lshl_b32 s40, s32, 7
    s_lshl_b32 s41, s37, 5
    s_add_u32 s40, s40, s41
    s_mul_i32 s44, s40, 896
    s_lshl_b32 s45, s37, 12
    s_add_u32 m0, s45, 0
    s_add_u32 s48, s44, 0
    buffer_load_dwordx4 v8, s[16:19], s48 offen lds
    s_add_u32 m0, s45, 1024
    s_add_u32 s48, s44, 7168
    buffer_load_dwordx4 v9, s[16:19], s48 offen lds
    s_add_u32 m0, s45, 2048
    s_add_u32 s48, s44, 14336
    buffer_load_dwordx4 v8, s[16:19], s48 offen lds
    s_add_u32 m0, s45, 3072
    s_add_u32 s48, s44, 21504
    buffer_load_dwordx4 v9, s[16:19], s48 offen lds
    s_mov_b32 s20, s66
    s_and_b32 s21, s67, 0xffff
    s_mov_b32 s22, 1204224
    s_mov_b32 s23, 0x00020000
    s_mov_b32 s8, s72
    s_and_b32 s9, s73, 0xffff
    s_mov_b32 s10, 1204224
    s_mov_b32 s11, 0x00020000
    v_bfe_u32 v5, v0, 4, 1
    v_lshlrev_b32 v5, 2, v5
    v_xor_b32 v4, v4, v5
    v_lshl_add_u32 v15, v4, 4, v7
    v_add_u32 v6, 0, v0
    v_mul_u32_u24 v7, 43691, v6
    v_lshrrev_b32 v7, 19, v7
    v_mul_u32_u24 v13, 12, v7
    v_sub_u32 v13, v6, v13
    v_mul_u32_u24 v7, 2688, v7
    v_lshl_add_u32 v10, v13, 4, v7
    v_add_u32 v6, 64, v0
    v_mul_u32_u24 v7, 43691, v6
    v_lshrrev_b32 v7, 19, v7
    v_mul_u32_u24 v13, 12, v7
    v_sub_u32 v13, v6, v13
    v_mul_u32_u24 v7, 2688, v7
    v_lshl_add_u32 v11, v13, 4, v7
    v_add_u32 v6, 128, v0
    v_mul_u32_u24 v7, 43691, v6
    v_lshrrev_b32 v7, 19, v7
    v_mul_u32_u24 v13, 12, v7
    v_sub_u32 v13, v6, v13
    v_mul_u32_u24 v7, 2688, v7
    v_lshl_add_u32 v12, v13, 4, v7
    s_mul_i32 s46, s37, 43008
    s_mul_i32 s42, s33, 168
    s_and_b32 s42, s42, 0xfffffff0
    s_add_u32 s46, s46, s42
    s_mul_i32 s47, s37, 3072
    s_add_u32 s47, s47, 114688
    s_add_u32 m0, s47, 0
    s_add_u32 s48, s46, 0
    buffer_load_dwordx4 v10, s[20:23], s48 offen lds
    s_add_u32 m0, s47, 1024
    s_add_u32 s48, s46, 0
    buffer_load_dwordx4 v11, s[20:23], s48 offen lds
    s_add_u32 m0, s47, 2048
    s_add_u32 s48, s46, 0
    buffer_load_dwordx4 v12, s[20:23], s48 offen lds
    s_add_u32 m0, s45, 16384
    s_add_u32 s48, s44, 128
    buffer_load_dwordx4 v8, s[16:19], s48 offen lds
    s_add_u32 m0, s45, 17408
    s_add_u32 s48, s44, 7296
    buffer_load_dwordx4 v9, s[16:19], s48 offen lds
    s_add_u32 m0, s45, 18432
    s_add_u32 s48, s44, 14464
    buffer_load_dwordx4 v8, s[16:19], s48 offen lds
    s_add_u32 m0, s45, 19456
    s_add_u32 s48, s44, 21632
    buffer_load_dwordx4 v9, s[16:19], s48 offen lds
    s_add_u32 m0, s47, 12288
    s_add_u32 s48, s46, 172032
    buffer_load_dwordx4 v10, s[20:23], s48 offen lds
    s_add_u32 m0, s47, 13312
    s_add_u32 s48, s46, 172032
    buffer_load_dwordx4 v11, s[20:23], s48 offen lds
    s_add_u32 m0, s47, 14336
    s_add_u32 s48, s46, 172032
    buffer_load_dwordx4 v12, s[20:23], s48 offen lds
    s_waitcnt vmcnt(7)
    s_barrier
    s_add_u32 m0, s45, 32768
    s_add_u32 s48, s44, 256
    buffer_load_dwordx4 v8, s[16:19], s48 offen lds
    s_add_u32 m0, s45, 33792
    s_add_u32 s48, s44, 7424
    buffer_load_dwordx4 v9, s[16:19], s48 offen lds
    s_add_u32 m0, s45, 34816
    s_add_u32 s48, s44, 14592
    buffer_load_dwordx4 v8, s[16:19], s48 offen lds
    s_add_u32 m0, s45, 35840
    s_add_u32 s48, s44, 21760
    buffer_load_dwordx4 v9, s[16:19], s48 offen lds
    s_add_u32 m0, s47, 24576
    s_add_u32 s48, s46, 344064
    buffer_load_dwordx4 v10, s[20:23], s48 offen lds
    s_add_u32 m0, s47, 25600
    s_add_u32 s48, s46, 344064
    buffer_load_dwordx4 v11, s[20:23], s48 offen lds
    s_add_u32 m0, s47, 26624
    s_add_u32 s48, s46, 344064
    buffer_load_dwordx4 v12, s[20:23], s48 offen lds
    s_waitcnt vmcnt(7)
    s_barrier
    s_add_u32 m0, s45, 49152
    s_add_u32 s48, s44, 384
    buffer_load_dwordx4 v8, s[16:19], s48 offen lds
    s_add_u32 m0, s45, 50176
    s_add_u32 s48, s44, 7552
    buffer_load_dwordx4 v9, s[16:19], s48 offen lds
    s_add_u32 m0, s45, 51200
    s_add_u32 s48, s44, 14720
    buffer_load_dwordx4 v8, s[16:19], s48 offen lds
    s_add_u32 m0, s45, 52224
    s_add_u32 s48, s44, 21888
    buffer_load_dwordx4 v9, s[16:19], s48 offen lds
    s_add_u32 m0, s47, 0
    s_add_u32 s48, s46, 516096
    buffer_load_dwordx4 v10, s[20:23], s48 offen lds
    s_add_u32 m0, s47, 1024
    s_add_u32 s48, s46, 516096
    buffer_load_dwordx4 v11, s[20:23], s48 offen lds
    s_add_u32 m0, s47, 2048
    s_add_u32 s48, s46, 516096
    buffer_load_dwordx4 v12, s[20:23], s48 offen lds
    s_waitcnt vmcnt(7)
    s_barrier
    s_add_u32 m0, s45, 65536
    s_add_u32 s48, s44, 512
    buffer_load_dwordx4 v8, s[16:19], s48 offen lds
    s_add_u32 m0, s45, 66560
    s_add_u32 s48, s44, 7680
    buffer_load_dwordx4 v9, s[16:19], s48 offen lds
    s_add_u32 m0, s45, 67584
    s_add_u32 s48, s44, 14848
    buffer_load_dwordx4 v8, s[16:19], s48 offen lds
    s_add_u32 m0, s45, 68608
    s_add_u32 s48, s44, 22016
    buffer_load_dwordx4 v9, s[16:19], s48 offen lds
    s_add_u32 m0, s47, 12288
    s_add_u32 s48, s46, 688128
    buffer_load_dwordx4 v10, s[20:23], s48 offen lds
    s_add_u32 m0, s47, 13312
    s_add_u32 s48, s46, 688128
    buffer_load_dwordx4 v11, s[20:23], s48 offen lds
    s_add_u32 m0, s47, 14336
    s_add_u32 s48, s46, 688128
    buffer_load_dwordx4 v12, s[20:23], s48 offen lds
    s_waitcnt vmcnt(7)
    s_barrier
    s_add_u32 m0, s45, 81920
    s_add_u32 s48, s44, 640
    buffer_load_dwordx4 v8, s[16:19], s48 offen lds
    s_add_u32 m0, s45, 82944
    s_add_u32 s48, s44, 7808
    buffer_load_dwordx4 v9, s[16:19], s48 offen lds
    s_add_u32 m0, s45, 83968
    s_add_u32 s48, s44, 14976
    buffer_load_dwordx4 v8, s[16:19], s48 offen lds
    s_add_u32 m0, s45, 84992
    s_add_u32 s48, s44, 22144
    buffer_load_dwordx4 v9, s[16:19], s48 offen lds
    s_add_u32 m0, s47, 24576
    s_add_u32 s48, s46, 860160
    buffer_load_dwordx4 v10, s[20:23], s48 offen lds
    s_add_u32 m0, s47, 25600
    s_add_u32 s48, s46, 860160
    buffer_load_dwordx4 v11, s[20:23], s48 offen lds
    s_add_u32 m0, s47, 26624
    s_add_u32 s48, s46, 860160
    buffer_load_dwordx4 v12, s[20:23], s48 offen lds
    s_waitcnt vmcnt(7)
    s_barrier
    s_add_u32 m0, s45, 98304
    s_add_u32 s48, s44, 768
    buffer_load_dwordx4 v8, s[16:19], s48 offen lds
    s_add_u32 m0, s45, 99328
    s_add_u32 s48, s44, 7936
    buffer_load_dwordx4 v9, s[16:19], s48 offen lds
    s_add_u32 m0, s45, 100352
    s_add_u32 s48, s44, 15104
    buffer_load_dwordx4 v8, s[16:19], s48 offen lds
    s_add_u32 m0, s45, 101376
    s_add_u32 s48, s44, 22272
    buffer_load_dwordx4 v9, s[16:19], s48 offen lds
    s_add_u32 m0, s47, 0
    s_add_u32 s48, s46, 1032192
    buffer_load_dwordx4 v10, s[20:23], s48 offen lds
    s_add_u32 m0, s47, 1024
    s_add_u32 s48, s46, 1032192
    buffer_load_dwordx4 v11, s[20:23], s48 offen lds
    s_add_u32 m0, s47, 2048
    s_add_u32 s48, s46, 1032192
    buffer_load_dwordx4 v12, s[20:23], s48 offen lds
    s_waitcnt vmcnt(7)
    s_barrier
    s_add_u32 m0, s47, 12288
    s_add_u32 s48, s46, 0
    buffer_load_dwordx4 v10, s[8:11], s48 offen lds
    s_add_u32 m0, s47, 13312
    s_add_u32 s48, s46, 0
    buffer_load_dwordx4 v11, s[8:11], s48 offen lds
    s_add_u32 m0, s47, 14336
    s_add_u32 s48, s46, 0
    buffer_load_dwordx4 v12, s[8:11], s48 offen lds
    s_waitcnt vmcnt(3)
    s_barrier
    s_add_u32 m0, s47, 24576
    s_add_u32 s48, s46, 172032
    buffer_load_dwordx4 v10, s[8:11], s48 offen lds
    s_add_u32 m0, s47, 25600
    s_add_u32 s48, s46, 172032
    buffer_load_dwordx4 v11, s[8:11], s48 offen lds
    s_add_u32 m0, s47, 26624
    s_add_u32 s48, s46, 172032
    buffer_load_dwordx4 v12, s[8:11], s48 offen lds
    s_mov_b32 s28, s76
    s_and_b32 s29, s77, 0xffff
    s_mov_b32 s30, 896
    s_mov_b32 s31, 0x00020000
    s_lshl_b32 s40, s51, 7
    s_lshl_b32 s41, s50, 3
    s_add_u32 s40, s40, s41
    s_lshl_b32 s41, s37, 1
    s_add_u32 s54, s40, s41
    s_mul_i32 s55, s54, 896
    v_mov_b32 v6, 0x40000000
    v_cmp_gt_u32 vcc, 56, v0
    s_nop 1
    v_cndmask_b32 v1, v6, v2, vcc
    buffer_load_dwordx4 v[20:23], v1, s[16:19], s55 offen
    buffer_load_dwordx4 v[24:27], v1, s[16:19], s55 offen offset:896
    buffer_load_dwordx4 v[28:31], v1, s[28:31], 0 offen
    v_mov_b32 v14, 0
    s_waitcnt vmcnt(6)
    s_barrier
    s_add_u32 m0, s47, 0
    s_add_u32 s48, s46, 344064
    buffer_load_dwordx4 v10, s[8:11], s48 offen lds
    s_add_u32 m0, s47, 1024
    s_add_u32 s48, s46, 344064
    buffer_load_dwordx4 v11, s[8:11], s48 offen lds
    s_add_u32 m0, s47, 2048
    s_add_u32 s48, s46, 344064
    buffer_load_dwordx4 v12, s[8:11], s48 offen lds
    s_waitcnt vmcnt(6)
    s_barrier
    s_add_u32 m0, s47, 12288
    s_add_u32 s48, s46, 516096
    buffer_load_dwordx4 v10, s[8:11], s48 offen lds
    s_add_u32 m0, s47, 13312
    s_add_u32 s48, s46, 516096
    buffer_load_dwordx4 v11, s[8:11], s48 offen lds
    s_add_u32 m0, s47, 14336
    s_add_u32 s48, s46, 516096
    buffer_load_dwordx4 v12, s[8:11], s48 offen lds
    s_waitcnt vmcnt(3)
    s_barrier
    s_add_u32 m0, s47, 24576
    s_add_u32 s48, s46, 688128
    buffer_load_dwordx4 v10, s[8:11], s48 offen lds
    s_add_u32 m0, s47, 25600
    s_add_u32 s48, s46, 688128
    buffer_load_dwordx4 v11, s[8:11], s48 offen lds
    s_add_u32 m0, s47, 26624
    s_add_u32 s48, s46, 688128
    buffer_load_dwordx4 v12, s[8:11], s48 offen lds
    s_waitcnt vmcnt(9)
    v_mov_b32 v32, 0
    v_lshlrev_b32 v34, 16, v20
    v_lshlrev_b32 v35, 16, v28
    v_fmac_f32 v32, v34, v35
    v_and_b32 v34, 0xffff0000, v20
    v_and_b32 v35, 0xffff0000, v28
    v_fmac_f32 v32, v34, v35
    v_lshlrev_b32 v34, 16, v21
    v_lshlrev_b32 v35, 16, v29
    v_fmac_f32 v32, v34, v35
    v_and_b32 v34, 0xffff0000, v21
    v_and_b32 v35, 0xffff0000, v29
    v_fmac_f32 v32, v34, v35
    v_lshlrev_b32 v34, 16, v22
    v_lshlrev_b32 v35, 16, v30
    v_fmac_f32 v32, v34, v35
    v_and_b32 v34, 0xffff0000, v22
    v_and_b32 v35, 0xffff0000, v30
    v_fmac_f32 v32, v34, v35
    v_lshlrev_b32 v34, 16, v23
    v_lshlrev_b32 v35, 16, v31
    v_fmac_f32 v32, v34, v35
    v_and_b32 v34, 0xffff0000, v23
    v_and_b32 v35, 0xffff0000, v31
    v_fmac_f32 v32, v34, v35
    s_nop 1
    v_add_f32_dpp v32, v32, v32 row_ror:8 row_mask:0xf bank_mask:0xf
    s_nop 1
    v_add_f32_dpp v32, v32, v32 row_ror:4 row_mask:0xf bank_mask:0xf
    s_nop 1
    v_add_f32_dpp v32, v32, v32 row_ror:2 row_mask:0xf bank_mask:0xf
    s_nop 1
    v_add_f32_dpp v32, v32, v32 row_ror:1 row_mask:0xf bank_mask:0xf
    s_nop 0
    v_readlane_b32 s40, v32, 0
    v_readlane_b32 s41, v32, 16
    v_readlane_b32 s42, v32, 32
    v_readlane_b32 s43, v32, 48
    v_mov_b32 v32, s40
    v_add_f32 v32, s41, v32
    v_add_f32 v32, s42, v32
    v_add_f32 v32, s43, v32
    v_mul_f32 v32, 3216550459, v32
    v_exp_f32 v32, v32
    s_nop 0
    v_add_f32 v32, 1.0, v32
    v_rcp_f32 v32, v32
    v_mov_b32 v33, 0
    v_lshlrev_b32 v34, 16, v24
    v_lshlrev_b32 v35, 16, v28
    v_fmac_f32 v33, v34, v35
    v_and_b32 v34, 0xffff0000, v24
    v_and_b32 v35, 0xffff0000, v28
    v_fmac_f32 v33, v34, v35
    v_lshlrev_b32 v34, 16, v25
    v_lshlrev_b32 v35, 16, v29
    v_fmac_f32 v33, v34, v35
    v_and_b32 v34, 0xffff0000, v25
    v_and_b32 v35, 0xffff0000, v29
    v_fmac_f32 v33, v34, v35
    v_lshlrev_b32 v34, 16, v26
    v_lshlrev_b32 v35, 16, v30
    v_fmac_f32 v33, v34, v35
    v_and_b32 v34, 0xffff0000, v26
    v_and_b32 v35, 0xffff0000, v30
    v_fmac_f32 v33, v34, v35
    v_lshlrev_b32 v34, 16, v27
    v_lshlrev_b32 v35, 16, v31
    v_fmac_f32 v33, v34, v35
    v_and_b32 v34, 0xffff0000, v27
    v_and_b32 v35, 0xffff0000, v31
    v_fmac_f32 v33, v34, v35
    s_nop 1
    v_add_f32_dpp v33, v33, v33 row_ror:8 row_mask:0xf bank_mask:0xf
    s_nop 1
    v_add_f32_dpp v33, v33, v33 row_ror:4 row_mask:0xf bank_mask:0xf
    s_nop 1
    v_add_f32_dpp v33, v33, v33 row_ror:2 row_mask:0xf bank_mask:0xf
    s_nop 1
    v_add_f32_dpp v33, v33, v33 row_ror:1 row_mask:0xf bank_mask:0xf
    s_nop 0
    v_readlane_b32 s40, v33, 0
    v_readlane_b32 s41, v33, 16
    v_readlane_b32 s42, v33, 32
    v_readlane_b32 s43, v33, 48
    v_mov_b32 v33, s40
    v_add_f32 v33, s41, v33
    v_add_f32 v33, s42, v33
    v_add_f32 v33, s43, v33
    v_mul_f32 v33, 3216550459, v33
    v_exp_f32 v33, v33
    s_nop 0
    v_add_f32 v33, 1.0, v33
    v_rcp_f32 v33, v33
    s_lshl_b32 s40, s54, 2
    s_add_u32 s40, s40, 16777216
    s_mov_b64 exec, 1
    buffer_store_dwordx2 v[32:33], v14, s[24:27], s40 offen sc1
    s_mov_b64 exec, -1
    s_waitcnt vmcnt(4)
    s_barrier
    s_add_u32 m0, s47, 0
    s_add_u32 s48, s46, 860160
    buffer_load_dwordx4 v10, s[8:11], s48 offen lds
    s_add_u32 m0, s47, 1024
    s_add_u32 s48, s46, 860160
    buffer_load_dwordx4 v11, s[8:11], s48 offen lds
    s_add_u32 m0, s47, 2048
    s_add_u32 s48, s46, 860160
    buffer_load_dwordx4 v12, s[8:11], s48 offen lds
    s_waitcnt vmcnt(4)
    s_barrier
    s_add_u32 m0, s47, 12288
    s_add_u32 s48, s46, 1032192
    buffer_load_dwordx4 v10, s[8:11], s48 offen lds
    s_add_u32 m0, s47, 13312
    s_add_u32 s48, s46, 1032192
    buffer_load_dwordx4 v11, s[8:11], s48 offen lds
    s_add_u32 m0, s47, 14336
    s_add_u32 s48, s46, 1032192
    buffer_load_dwordx4 v12, s[8:11], s48 offen lds
    s_lshl_b32 s40, s50, 18
    s_add_u32 s40, s40, 2097152
    s_add_u32 s20, s82, s40
    s_addc_u32 s21, s83, 0
    s_and_b32 s21, s21, 0xffff
    s_mov_b32 s22, 0x40000
    s_mov_b32 s23, 0x00020000
    s_mov_b32 s28, s68
    s_and_b32 s29, s69, 0xffff
    s_mov_b32 s30, 401408
    s_mov_b32 s31, 0x00020000
    s_lshr_b32 s42, s35, 2
    s_lshl_b32 s42, s42, 7
    s_mul_i32 s44, s37, 100352
    s_add_u32 s44, s44, s42
    s_mul_i32 s55, s37, 14336
    s_lshl_b32 s39, s51, 2
    s_add_u32 s39, s39, s37
    s_lshl_b32 s43, s50, 6
    s_add_u32 s43, s43, s39
    s_lshl_b32 s40, s39, 4
    s_add_u32 s40, s40, s50
    s_lshl_b32 s49, s40, 11
    s_add_u32 s49, s49, 14680064
    s_waitcnt vmcnt(3)
    s_barrier
    s_lshl_b32 s40, s37, 11
    s_add_u32 m0, s40, 151552
    s_lshl_b32 s41, s43, 11
    buffer_load_dwordx4 v2, s[24:27], s41 offen lds
    buffer_load_dwordx4 v2, s[24:27], s41 offen offset:1024 lds
    s_add_u32 s46, s51, 0
    s_and_b32 s46, s46, 15
    s_lshl_b32 s46, s46, 14
    s_add_u32 s46, s46, s45
    s_add_u32 m0, s45, 0
    s_nop 0
    buffer_load_dwordx4 v2, s[20:23], s46 offen offset:0 lds
    buffer_load_dwordx4 v2, s[20:23], s46 offen offset:1024 lds
    buffer_load_dwordx4 v2, s[20:23], s46 offen offset:2048 lds
    buffer_load_dwordx4 v2, s[20:23], s46 offen offset:3072 lds
    s_add_u32 s46, s51, 1
    s_and_b32 s46, s46, 15
    s_lshl_b32 s46, s46, 14
    s_add_u32 s46, s46, s45
    s_add_u32 m0, s45, 16384
    s_nop 0
    buffer_load_dwordx4 v2, s[20:23], s46 offen offset:0 lds
    buffer_load_dwordx4 v2, s[20:23], s46 offen offset:1024 lds
    buffer_load_dwordx4 v2, s[20:23], s46 offen offset:2048 lds
    buffer_load_dwordx4 v2, s[20:23], s46 offen offset:3072 lds
    s_waitcnt vmcnt(10)
    s_barrier
    s_add_u32 s46, s51, 2
    s_and_b32 s46, s46, 15
    s_lshl_b32 s46, s46, 14
    s_add_u32 s46, s46, s45
    s_add_u32 m0, s45, 32768
    s_nop 0
    buffer_load_dwordx4 v2, s[20:23], s46 offen offset:0 lds
    buffer_load_dwordx4 v2, s[20:23], s46 offen offset:1024 lds
    buffer_load_dwordx4 v2, s[20:23], s46 offen offset:2048 lds
    buffer_load_dwordx4 v2, s[20:23], s46 offen offset:3072 lds
    s_setprio 2
    s_waitcnt vmcnt(8)
    s_barrier
    s_waitcnt vmcnt(4)
    s_barrier
    s_add_u32 s46, s51, 3
    s_and_b32 s46, s46, 15
    s_lshl_b32 s46, s46, 14
    s_add_u32 s46, s46, s45
    s_add_u32 m0, s45, 49152
    s_nop 0
    buffer_load_dwordx4 v2, s[20:23], s46 offen offset:0 lds
    buffer_load_dwordx4 v2, s[20:23], s46 offen offset:1024 lds
    buffer_load_dwordx4 v2, s[20:23], s46 offen offset:2048 lds
    buffer_load_dwordx4 v2, s[20:23], s46 offen offset:3072 lds
    s_add_u32 s46, s51, 4
    s_and_b32 s46, s46, 15
    s_lshl_b32 s46, s46, 14
    s_add_u32 s46, s46, s45
    s_add_u32 m0, s45, 65536
    s_nop 0
    buffer_load_dwordx4 v2, s[20:23], s46 offen offset:0 lds
    buffer_load_dwordx4 v2, s[20:23], s46 offen offset:1024 lds
    buffer_load_dwordx4 v2, s[20:23], s46 offen offset:2048 lds
    buffer_load_dwordx4 v2, s[20:23], s46 offen offset:3072 lds
    s_waitcnt vmcnt(8)
    s_barrier
    s_add_u32 s46, s51, 5
    s_and_b32 s46, s46, 15
    s_lshl_b32 s46, s46, 14
    s_add_u32 s46, s46, s45
    s_add_u32 m0, s45, 0
    s_nop 0
    buffer_load_dwordx4 v2, s[20:23], s46 offen offset:0 lds
    buffer_load_dwordx4 v2, s[20:23], s46 offen offset:1024 lds
    buffer_load_dwordx4 v2, s[20:23], s46 offen offset:2048 lds
    buffer_load_dwordx4 v2, s[20:23], s46 offen offset:3072 lds
    s_add_u32 m0, s55, 98304
    s_add_u32 s48, s44, 0
    buffer_load_dwordx4 v15, s[28:31], s48 offen lds
    s_add_u32 m0, s55, 99328
    s_add_u32 s48, s44, 7168
    buffer_load_dwordx4 v15, s[28:31], s48 offen lds
    s_add_u32 m0, s55, 100352
    s_add_u32 s48, s44, 14336
    buffer_load_dwordx4 v15, s[28:31], s48 offen lds
    s_waitcnt vmcnt(11)
    s_barrier
    s_add_u32 s46, s51, 6
    s_and_b32 s46, s46, 15
    s_lshl_b32 s46, s46, 14
    s_add_u32 s46, s46, s45
    s_add_u32 m0, s45, 16384
    s_nop 0
    buffer_load_dwordx4 v2, s[20:23], s46 offen offset:0 lds
    buffer_load_dwordx4 v2, s[20:23], s46 offen offset:1024 lds
    buffer_load_dwordx4 v2, s[20:23], s46 offen offset:2048 lds
    buffer_load_dwordx4 v2, s[20:23], s46 offen offset:3072 lds
    s_add_u32 m0, s55, 101376
    s_add_u32 s48, s44, 21504
    buffer_load_dwordx4 v15, s[28:31], s48 offen lds
    s_add_u32 m0, s55, 102400
    s_add_u32 s48, s44, 28672
    buffer_load_dwordx4 v15, s[28:31], s48 offen lds
    s_add_u32 m0, s55, 103424
    s_add_u32 s48, s44, 35840
    buffer_load_dwordx4 v15, s[28:31], s48 offen lds
    s_waitcnt vmcnt(14)
    s_barrier
    s_add_u32 s46, s51, 7
    s_and_b32 s46, s46, 15
    s_lshl_b32 s46, s46, 14
    s_add_u32 s46, s46, s45
    s_add_u32 m0, s45, 32768
    s_nop 0
    buffer_load_dwordx4 v2, s[20:23], s46 offen offset:0 lds
    buffer_load_dwordx4 v2, s[20:23], s46 offen offset:1024 lds
    buffer_load_dwordx4 v2, s[20:23], s46 offen offset:2048 lds
    buffer_load_dwordx4 v2, s[20:23], s46 offen offset:3072 lds
    s_add_u32 m0, s55, 104448
    s_add_u32 s48, s44, 43008
    buffer_load_dwordx4 v15, s[28:31], s48 offen lds
    s_add_u32 m0, s55, 105472
    s_add_u32 s48, s44, 50176
    buffer_load_dwordx4 v15, s[28:31], s48 offen lds
    s_add_u32 m0, s55, 106496
    s_add_u32 s48, s44, 57344
    buffer_load_dwordx4 v15, s[28:31], s48 offen lds
    s_waitcnt vmcnt(17)
    s_barrier
    s_add_u32 s46, s51, 8
    s_and_b32 s46, s46, 15
    s_lshl_b32 s46, s46, 14
    s_add_u32 s46, s46, s45
    s_add_u32 m0, s45, 49152
    s_nop 0
    buffer_load_dwordx4 v2, s[20:23], s46 offen offset:0 lds
    buffer_load_dwordx4 v2, s[20:23], s46 offen offset:1024 lds
    buffer_load_dwordx4 v2, s[20:23], s46 offen offset:2048 lds
    buffer_load_dwordx4 v2, s[20:23], s46 offen offset:3072 lds
    s_add_u32 m0, s55, 107520
    s_add_u32 s48, s44, 64512
    buffer_load_dwordx4 v15, s[28:31], s48 offen lds
    s_add_u32 m0, s55, 108544
    s_add_u32 s48, s44, 71680
    buffer_load_dwordx4 v15, s[28:31], s48 offen lds
    s_add_u32 m0, s55, 109568
    s_add_u32 s48, s44, 78848
    buffer_load_dwordx4 v15, s[28:31], s48 offen lds
    s_waitcnt vmcnt(17)
    s_barrier
    s_add_u32 s46, s51, 9
    s_and_b32 s46, s46, 15
    s_lshl_b32 s46, s46, 14
    s_add_u32 s46, s46, s45
    s_add_u32 m0, s45, 65536
    s_nop 0
    buffer_load_dwordx4 v2, s[20:23], s46 offen offset:0 lds
    buffer_load_dwordx4 v2, s[20:23], s46 offen offset:1024 lds
    buffer_load_dwordx4 v2, s[20:23], s46 offen offset:2048 lds
    buffer_load_dwordx4 v2, s[20:23], s46 offen offset:3072 lds
    s_add_u32 m0, s55, 110592
    s_add_u32 s48, s44, 86016
    buffer_load_dwordx4 v15, s[28:31], s48 offen lds
    s_add_u32 m0, s55, 111616
    s_add_u32 s48, s44, 93184
    buffer_load_dwordx4 v15, s[28:31], s48 offen lds
    s_add_u32 m0, s55, 112640
    s_add_u32 s48, s44, 100352
    buffer_load_dwordx4 v15, s[28:31], s48 offen lds
    s_waitcnt vmcnt(17)
    s_barrier
    s_add_u32 s46, s51, 10
    s_and_b32 s46, s46, 15
    s_lshl_b32 s46, s46, 14
    s_add_u32 s46, s46, s45
    s_add_u32 m0, s45, 0
    s_nop 0
    buffer_load_dwordx4 v2, s[20:23], s46 offen offset:0 lds
    buffer_load_dwordx4 v2, s[20:23], s46 offen offset:1024 lds
    buffer_load_dwordx4 v2, s[20:23], s46 offen offset:2048 lds
    buffer_load_dwordx4 v2, s[20:23], s46 offen offset:3072 lds
    v_mov_b32 v16, 163716
    s_mov_b32 s48, 0
KF_LBW:
    ds_read_b32 v17, v16
    s_waitcnt lgkmcnt(0)
    v_readfirstlane_b32 s40, v17
    s_add_u32 s48, s48, 1
    s_cmp_gt_u32 s48, 1000
    s_cbranch_scc1 KF_LBW2
    s_cmp_eq_u32 s40, 0
    s_cbranch_scc1 KF_LBW
KF_LBW2:
    s_lshl_b32 s40, s43, 11
    s_add_u32 s40, s40, 6291456
    buffer_load_dwordx4 v[20:23], v2, s[24:27], s40 offen
    buffer_load_dwordx4 v[24:27], v2, s[24:27], s40 offen offset:1024
    s_lshl_b32 s40, s43, 12
    s_add_u32 s40, s40, 8388608
    s_sub_u32 s41, s40, 4096
    s_cmp_eq_u32 s39, 0
    s_cselect_b32 s41, s40, s41
    s_cselect_b32 s54, 0, -1
    buffer_load_dwordx4 v[28:31], v2, s[24:27], s40 offen
    buffer_load_dwordx4 v[44:47], v2, s[24:27], s41 offen
    buffer_load_dwordx4 v[32:35], v2, s[24:27], s40 offen offset:1024
    buffer_load_dwordx4 v[48:51], v2, s[24:27], s41 offen offset:1024
    buffer_load_dwordx4 v[36:39], v2, s[24:27], s40 offen offset:2048
    buffer_load_dwordx4 v[40:43], v2, s[24:27], s40 offen offset:3072
    buffer_load_dwordx4 v[52:55], v2, s[24:27], s41 offen offset:3072
    s_waitcnt vmcnt(23)
    s_barrier
    s_add_u32 s46, s51, 11
    s_and_b32 s46, s46, 15
    s_lshl_b32 s46, s46, 14
    s_add_u32 s46, s46, s45
    s_add_u32 m0, s45, 16384
    s_nop 0
    buffer_load_dwordx4 v2, s[20:23], s46 offen offset:0 lds
    buffer_load_dwordx4 v2, s[20:23], s46 offen offset:1024 lds
    buffer_load_dwordx4 v2, s[20:23], s46 offen offset:2048 lds
    buffer_load_dwordx4 v2, s[20:23], s46 offen offset:3072 lds
    s_waitcnt vmcnt(20)
    s_barrier
    s_add_u32 s46, s51, 12
    s_and_b32 s46, s46, 15
    s_lshl_b32 s46, s46, 14
    s_add_u32 s46, s46, s45
    s_add_u32 m0, s45, 32768
    s_nop 0
    buffer_load_dwordx4 v2, s[20:23], s46 offen offset:0 lds
    buffer_load_dwordx4 v2, s[20:23], s46 offen offset:1024 lds
    buffer_load_dwordx4 v2, s[20:23], s46 offen offset:2048 lds
    buffer_load_dwordx4 v2, s[20:23], s46 offen offset:3072 lds
    s_waitcnt vmcnt(8)
    v_mfma_f32_32x32x16_bf16 v[56:71], v[28:31], v[20:23], 0
    v_mfma_f32_32x32x16_bf16 v[72:87], v[44:47], v[20:23], 0
    v_mfma_f32_32x32x16_bf16 v[56:71], v[32:35], v[24:27], v[56:71]
    v_mfma_f32_32x32x16_bf16 v[72:87], v[48:51], v[24:27], v[72:87]
    v_mov_b32 v6, 0xff800000
    s_waitcnt vmcnt(17)
    s_barrier
    s_add_u32 s46, s51, 13
    s_and_b32 s46, s46, 15
    s_lshl_b32 s46, s46, 14
    s_add_u32 s46, s46, s45
    s_add_u32 m0, s45, 49152
    s_nop 0
    buffer_load_dwordx4 v2, s[20:23], s46 offen offset:0 lds
    buffer_load_dwordx4 v2, s[20:23], s46 offen offset:1024 lds
    buffer_load_dwordx4 v2, s[20:23], s46 offen offset:2048 lds
    buffer_load_dwordx4 v2, s[20:23], s46 offen offset:3072 lds
    s_mov_b32 s56, 21845
    s_mov_b32 s57, 349520
    v_cndmask_b32 v56, v6, v56, s[56:57]
    s_mov_b32 s56, 43690
    s_mov_b32 s57, 699040
    v_cndmask_b32 v57, v6, v57, s[56:57]
    s_mov_b32 s56, 87380
    s_mov_b32 s57, 1398080
    v_cndmask_b32 v58, v6, v58, s[56:57]
    s_mov_b32 s56, 174760
    s_mov_b32 s57, 2796160
    v_cndmask_b32 v59, v6, v59, s[56:57]
    s_mov_b32 s56, 5592320
    s_mov_b32 s57, 89477120
    v_cndmask_b32 v60, v6, v60, s[56:57]
    s_mov_b32 s56, 11184640
    s_mov_b32 s57, 178954240
    v_cndmask_b32 v61, v6, v61, s[56:57]
    s_mov_b32 s56, 22369280
    s_mov_b32 s57, 357908480
    v_cndmask_b32 v62, v6, v62, s[56:57]
    s_mov_b32 s56, 44738560
    s_mov_b32 s57, 715816960
    v_cndmask_b32 v63, v6, v63, s[56:57]
    s_mov_b32 s56, 1431633920
    s_mov_b32 s57, 1431306240
    v_cndmask_b32 v64, v6, v64, s[56:57]
    s_mov_b32 s56, 2863267840
    s_mov_b32 s57, 2862612480
    v_cndmask_b32 v65, v6, v65, s[56:57]
    s_mov_b32 s56, 1431568384
    s_mov_b32 s57, 1430257664
    v_cndmask_b32 v66, v6, v66, s[56:57]
    s_mov_b32 s56, 2863136768
    s_mov_b32 s57, 2860515328
    v_cndmask_b32 v67, v6, v67, s[56:57]
    s_mov_b32 s56, 1426063360
    s_mov_b32 s57, 1342177280
    v_cndmask_b32 v68, v6, v68, s[56:57]
    s_mov_b32 s56, 2852126720
    s_mov_b32 s57, 2684354560
    v_cndmask_b32 v69, v6, v69, s[56:57]
    s_mov_b32 s56, 1409286144
    s_mov_b32 s57, 1073741824
    v_cndmask_b32 v70, v6, v70, s[56:57]
    s_mov_b32 s56, 2818572288
    s_mov_b32 s57, 2147483648
    v_cndmask_b32 v71, v6, v71, s[56:57]
    s_and_b32 s56, s54, 0
    s_and_b32 s57, s54, 5
    v_cndmask_b32 v80, v6, v80, s[56:57]
    s_and_b32 s56, s54, 0
    s_and_b32 s57, s54, 10
    v_cndmask_b32 v81, v6, v81, s[56:57]
    s_and_b32 s56, s54, 1
    s_and_b32 s57, s54, 21
    v_cndmask_b32 v82, v6, v82, s[56:57]
    s_and_b32 s56, s54, 2
    s_and_b32 s57, s54, 42
    v_cndmask_b32 v83, v6, v83, s[56:57]
    s_and_b32 s56, s54, 85
    s_and_b32 s57, s54, 1365
    v_cndmask_b32 v84, v6, v84, s[56:57]
    s_and_b32 s56, s54, 170
    s_and_b32 s57, s54, 2730
    v_cndmask_b32 v85, v6, v85, s[56:57]
    s_and_b32 s56, s54, 341
    s_and_b32 s57, s54, 5461
    v_cndmask_b32 v86, v6, v86, s[56:57]
    s_and_b32 s56, s54, 682
    s_and_b32 s57, s54, 10922
    v_cndmask_b32 v87, v6, v87, s[56:57]
    v_max3_f32 v3, v56, v57, v58
    v_max3_f32 v3, v3, v59, v60
    v_max3_f32 v3, v3, v61, v62
    v_max3_f32 v3, v3, v63, v64
    v_max3_f32 v3, v3, v65, v66
    v_max3_f32 v3, v3, v67, v68
    v_max3_f32 v3, v3, v69, v70
    v_max3_f32 v3, v3, v71, v80
    v_max3_f32 v3, v3, v81, v82
    v_max3_f32 v3, v3, v83, v84
    v_max3_f32 v3, v3, v85, v86
    v_max_f32 v3, v3, v87
    v_mov_b32 v4, v3
    s_nop 1
    v_permlane32_swap_b32 v3, v4
    v_max_f32 v3, v3, v4
    v_sub_f32 v56, v56, v3
    v_sub_f32 v57, v57, v3
    v_sub_f32 v58, v58, v3
    v_sub_f32 v59, v59, v3
    v_sub_f32 v60, v60, v3
    v_sub_f32 v61, v61, v3
    v_sub_f32 v62, v62, v3
    v_sub_f32 v63, v63, v3
    v_sub_f32 v64, v64, v3
    v_sub_f32 v65, v65, v3
    v_sub_f32 v66, v66, v3
    v_sub_f32 v67, v67, v3
    v_sub_f32 v68, v68, v3
    v_sub_f32 v69, v69, v3
    v_sub_f32 v70, v70, v3
    v_sub_f32 v71, v71, v3
    v_sub_f32 v80, v80, v3
    v_sub_f32 v81, v81, v3
    v_sub_f32 v82, v82, v3
    v_sub_f32 v83, v83, v3
    v_sub_f32 v84, v84, v3
    v_sub_f32 v85, v85, v3
    v_sub_f32 v86, v86, v3
    v_sub_f32 v87, v87, v3
    s_waitcnt vmcnt(8)
    s_barrier
    s_add_u32 s46, s51, 14
    s_and_b32 s46, s46, 15
    s_lshl_b32 s46, s46, 14
    s_add_u32 s46, s46, s45
    s_add_u32 m0, s45, 65536
    s_nop 0
    buffer_load_dwordx4 v2, s[20:23], s46 offen offset:0 lds
    buffer_load_dwordx4 v2, s[20:23], s46 offen offset:1024 lds
    buffer_load_dwordx4 v2, s[20:23], s46 offen offset:2048 lds
    buffer_load_dwordx4 v2, s[20:23], s46 offen offset:3072 lds
    v_exp_f32 v56, v56
    v_exp_f32 v57, v57
    v_exp_f32 v58, v58
    v_exp_f32 v59, v59
    v_exp_f32 v60, v60
    v_exp_f32 v61, v61
    v_exp_f32 v62, v62
    v_exp_f32 v63, v63
    v_exp_f32 v64, v64
    v_exp_f32 v65, v65
    v_exp_f32 v66, v66
    v_exp_f32 v67, v67
    v_exp_f32 v68, v68
    v_exp_f32 v69, v69
    v_exp_f32 v70, v70
    v_exp_f32 v71, v71
    v_exp_f32 v80, v80
    v_exp_f32 v81, v81
    v_exp_f32 v82, v82
    v_exp_f32 v83, v83
    v_exp_f32 v84, v84
    v_exp_f32 v85, v85
    v_exp_f32 v86, v86
    v_exp_f32 v87, v87
    v_cvt_pk_bf16_f32 v88, v56, v57
    v_cvt_pk_bf16_f32 v89, v58, v59
    v_cvt_pk_bf16_f32 v90, v60, v61
    v_cvt_pk_bf16_f32 v91, v62, v63
    v_cvt_pk_bf16_f32 v92, v64, v65
    v_cvt_pk_bf16_f32 v93, v66, v67
    v_cvt_pk_bf16_f32 v94, v68, v69
    v_cvt_pk_bf16_f32 v95, v70, v71
    v_cvt_pk_bf16_f32 v96, v80, v81
    v_cvt_pk_bf16_f32 v97, v82, v83
    v_cvt_pk_bf16_f32 v98, v84, v85
    v_cvt_pk_bf16_f32 v99, v86, v87
    v_mfma_f32_32x32x16_bf16 v[100:115], v[36:39], v[88:91], 0
    v_mfma_f32_32x32x16_bf16 v[100:115], v[40:43], v[92:95], v[100:115]
    v_mfma_f32_32x32x16_bf16 v[100:115], v[52:55], v[96:99], v[100:115]
    s_waitcnt vmcnt(8)
    s_barrier
    s_add_u32 s46, s51, 15
    s_and_b32 s46, s46, 15
    s_lshl_b32 s46, s46, 14
    s_add_u32 s46, s46, s45
    s_add_u32 m0, s45, 0
    s_nop 0
    buffer_load_dwordx4 v2, s[20:23], s46 offen offset:0 lds
    buffer_load_dwordx4 v2, s[20:23], s46 offen offset:1024 lds
    buffer_load_dwordx4 v2, s[20:23], s46 offen offset:2048 lds
    buffer_load_dwordx4 v2, s[20:23], s46 offen offset:3072 lds
    v_mov_b32 v4, v112
    v_mov_b32 v5, v112
    s_nop 1
    v_permlane32_swap_b32 v4, v5
    v_rcp_f32 v5, v5
    s_nop 0
    v_mul_f32 v100, v100, v5
    v_mul_f32 v101, v101, v5
    v_mul_f32 v102, v102, v5
    v_mul_f32 v103, v103, v5
    v_mul_f32 v104, v104, v5
    v_mul_f32 v105, v105, v5
    v_mul_f32 v106, v106, v5
    v_mul_f32 v107, v107, v5
    v_mul_f32 v108, v108, v5
    v_mul_f32 v109, v109, v5
    v_mul_f32 v110, v110, v5
    v_mul_f32 v111, v111, v5
    v_mul_f32 v112, v112, v5
    v_mul_f32 v113, v113, v5
    v_mul_f32 v114, v114, v5
    v_mul_f32 v115, v115, v5
    v_cvt_pk_bf16_f32 v100, v100, v101
    v_cvt_pk_bf16_f32 v101, v102, v103
    v_cvt_pk_bf16_f32 v102, v104, v105
    v_cvt_pk_bf16_f32 v103, v106, v107
    v_cvt_pk_bf16_f32 v104, v108, v109
    v_cvt_pk_bf16_f32 v105, v110, v111
    v_cvt_pk_bf16_f32 v106, v112, v113
    v_cvt_pk_bf16_f32 v107, v114, v115
    s_mov_b32 exec_lo, 0
    v_mov_b32 v106, 0
    v_mov_b32 v107, 0
    s_mov_b64 exec, -1
    buffer_store_dwordx4 v[100:103], v2, s[24:27], s49 offen sc1
    buffer_store_dwordx4 v[104:107], v2, s[24:27], s49 offen offset:1024 sc1
    s_waitcnt vmcnt(10)
    s_barrier
    s_mov_b32 s28, s74
    s_and_b32 s29, s75, 0xffff
    s_mov_b32 s30, 401408
    s_mov_b32 s31, 0x00020000
    s_lshr_b32 s42, s35, 2
    s_lshl_b32 s42, s42, 7
    s_mul_i32 s40, s37, 28672
    s_add_u32 s40, s40, s42
    s_mul_i32 s41, s37, 4096
    s_add_u32 m0, s41, 16384
    s_add_u32 s48, s40, 0
    buffer_load_dwordx4 v15, s[28:31], s48 offen lds
    s_add_u32 m0, s41, 17408
    s_add_u32 s48, s40, 7168
    buffer_load_dwordx4 v15, s[28:31], s48 offen lds
    s_add_u32 m0, s41, 18432
    s_add_u32 s48, s40, 14336
    buffer_load_dwordx4 v15, s[28:31], s48 offen lds
    s_add_u32 m0, s41, 19456
    s_add_u32 s48, s40, 21504
    buffer_load_dwordx4 v15, s[28:31], s48 offen lds
    s_waitcnt vmcnt(10)
    s_waitcnt vmcnt(4)
    s_barrier
    s_mul_i32 s40, s37, 28672
    s_add_u32 s40, s40, s42
    s_mul_i32 s41, s37, 4096
    s_add_u32 m0, s41, 32768
    s_add_u32 s48, s40, 114688
    buffer_load_dwordx4 v15, s[28:31], s48 offen lds
    s_add_u32 m0, s41, 33792
    s_add_u32 s48, s40, 121856
    buffer_load_dwordx4 v15, s[28:31], s48 offen lds
    s_add_u32 m0, s41, 34816
    s_add_u32 s48, s40, 129024
    buffer_load_dwordx4 v15, s[28:31], s48 offen lds
    s_add_u32 m0, s41, 35840
    s_add_u32 s48, s40, 136192
    buffer_load_dwordx4 v15, s[28:31], s48 offen lds
    s_waitcnt vmcnt(10)
    s_barrier
    s_mul_i32 s40, s37, 28672
    s_add_u32 s40, s40, s42
    s_mul_i32 s41, s37, 4096
    s_add_u32 m0, s41, 49152
    s_add_u32 s48, s40, 229376
    buffer_load_dwordx4 v15, s[28:31], s48 offen lds
    s_add_u32 m0, s41, 50176
    s_add_u32 s48, s40, 236544
    buffer_load_dwordx4 v15, s[28:31], s48 offen lds
    s_add_u32 m0, s41, 51200
    s_add_u32 s48, s40, 243712
    buffer_load_dwordx4 v15, s[28:31], s48 offen lds
    s_add_u32 m0, s41, 52224
    s_add_u32 s48, s40, 250880
    buffer_load_dwordx4 v15, s[28:31], s48 offen lds
    s_barrier
    s_cmp_lg_u32 s53, 0
    s_cbranch_scc1 KF_LNOFALL
    v_and_b32 v16, 7, v0
    v_lshlrev_b32 v16, 2, v16
    v_add_u32 v16, 163776, v16
    ds_read_b32 v16, v16
    s_waitcnt lgkmcnt(0)
    v_cmp_ne_u32 vcc, 0, v16
    s_nop 1
    s_cbranch_vccz KF_LNOFALL
    s_mov_b32 s53, 1
    s_barrier
    s_branch KF_LRESTART
KF_LNOFALL:
    s_cmp_ge_u32 s35, 28
    s_cbranch_scc1 KF_END
    s_mul_i32 s40, s37, 21504
    s_add_u32 s40, s40, s42
    s_mul_i32 s41, s37, 3072
    s_add_u32 m0, s41, 65536
    s_add_u32 s48, s40, 344064
    buffer_load_dwordx4 v15, s[28:31], s48 offen lds
    s_add_u32 m0, s41, 66560
    s_add_u32 s48, s40, 351232
    buffer_load_dwordx4 v15, s[28:31], s48 offen lds
    s_add_u32 m0, s41, 67584
    s_add_u32 s48, s40, 358400
    buffer_load_dwordx4 v15, s[28:31], s48 offen lds
    s_lshl_b32 s40, s37, 2
    s_add_u32 s40, s40, 163584
    v_mov_b32 v16, s40
    v_mov_b32 v17, 1
    s_waitcnt vmcnt(0)
    ds_write_b32 v16, v17 offset:32
    s_endpgm
KF_LRESTART:
    s_waitcnt vmcnt(0)
    s_add_u32 s46, s51, 0
    s_and_b32 s46, s46, 15
    s_lshl_b32 s46, s46, 14
    s_add_u32 s46, s46, s45
    s_add_u32 m0, s45, 0
    s_nop 0
    buffer_load_dwordx4 v2, s[20:23], s46 offen offset:0 lds
    buffer_load_dwordx4 v2, s[20:23], s46 offen offset:1024 lds
    buffer_load_dwordx4 v2, s[20:23], s46 offen offset:2048 lds
    buffer_load_dwordx4 v2, s[20:23], s46 offen offset:3072 lds
    s_add_u32 s46, s51, 1
    s_and_b32 s46, s46, 15
    s_lshl_b32 s46, s46, 14
    s_add_u32 s46, s46, s45
    s_add_u32 m0, s45, 16384
    s_nop 0
    buffer_load_dwordx4 v2, s[20:23], s46 offen offset:0 lds
    buffer_load_dwordx4 v2, s[20:23], s46 offen offset:1024 lds
    buffer_load_dwordx4 v2, s[20:23], s46 offen offset:2048 lds
    buffer_load_dwordx4 v2, s[20:23], s46 offen offset:3072 lds
    s_waitcnt vmcnt(4)
    s_barrier
    s_add_u32 s46, s51, 2
    s_and_b32 s46, s46, 15
    s_lshl_b32 s46, s46, 14
    s_add_u32 s46, s46, s45
    s_add_u32 m0, s45, 32768
    s_nop 0
    buffer_load_dwordx4 v2, s[20:23], s46 offen offset:0 lds
    buffer_load_dwordx4 v2, s[20:23], s46 offen offset:1024 lds
    buffer_load_dwordx4 v2, s[20:23], s46 offen offset:2048 lds
    buffer_load_dwordx4 v2, s[20:23], s46 offen offset:3072 lds
    s_waitcnt vmcnt(4)
    s_barrier
    s_add_u32 s46, s51, 3
    s_and_b32 s46, s46, 15
    s_lshl_b32 s46, s46, 14
    s_add_u32 s46, s46, s45
    s_add_u32 m0, s45, 49152
    s_nop 0
    buffer_load_dwordx4 v2, s[20:23], s46 offen offset:0 lds
    buffer_load_dwordx4 v2, s[20:23], s46 offen offset:1024 lds
    buffer_load_dwordx4 v2, s[20:23], s46 offen offset:2048 lds
    buffer_load_dwordx4 v2, s[20:23], s46 offen offset:3072 lds
    s_add_u32 s46, s51, 4
    s_and_b32 s46, s46, 15
    s_lshl_b32 s46, s46, 14
    s_add_u32 s46, s46, s45
    s_add_u32 m0, s45, 65536
    s_nop 0
    buffer_load_dwordx4 v2, s[20:23], s46 offen offset:0 lds
    buffer_load_dwordx4 v2, s[20:23], s46 offen offset:1024 lds
    buffer_load_dwordx4 v2, s[20:23], s46 offen offset:2048 lds
    buffer_load_dwordx4 v2, s[20:23], s46 offen offset:3072 lds
    s_waitcnt vmcnt(8)
    s_barrier
    s_add_u32 s46, s51, 5
    s_and_b32 s46, s46, 15
    s_lshl_b32 s46, s46, 14
    s_add_u32 s46, s46, s45
    s_add_u32 m0, s45, 0
    s_nop 0
    buffer_load_dwordx4 v2, s[20:23], s46 offen offset:0 lds
    buffer_load_dwordx4 v2, s[20:23], s46 offen offset:1024 lds
    buffer_load_dwordx4 v2, s[20:23], s46 offen offset:2048 lds
    buffer_load_dwordx4 v2, s[20:23], s46 offen offset:3072 lds
    s_waitcnt vmcnt(8)
    s_barrier
    s_add_u32 s46, s51, 6
    s_and_b32 s46, s46, 15
    s_lshl_b32 s46, s46, 14
    s_add_u32 s46, s46, s45
    s_add_u32 m0, s45, 16384
    s_nop 0
    buffer_load_dwordx4 v2, s[20:23], s46 offen offset:0 lds
    buffer_load_dwordx4 v2, s[20:23], s46 offen offset:1024 lds
    buffer_load_dwordx4 v2, s[20:23], s46 offen offset:2048 lds
    buffer_load_dwordx4 v2, s[20:23], s46 offen offset:3072 lds
    s_waitcnt vmcnt(8)
    s_barrier
    s_add_u32 s46, s51, 7
    s_and_b32 s46, s46, 15
    s_lshl_b32 s46, s46, 14
    s_add_u32 s46, s46, s45
    s_add_u32 m0, s45, 32768
    s_nop 0
    buffer_load_dwordx4 v2, s[20:23], s46 offen offset:0 lds
    buffer_load_dwordx4 v2, s[20:23], s46 offen offset:1024 lds
    buffer_load_dwordx4 v2, s[20:23], s46 offen offset:2048 lds
    buffer_load_dwordx4 v2, s[20:23], s46 offen offset:3072 lds
    s_waitcnt vmcnt(8)
    s_barrier
    s_add_u32 s46, s51, 8
    s_and_b32 s46, s46, 15
    s_lshl_b32 s46, s46, 14
    s_add_u32 s46, s46, s45
    s_add_u32 m0, s45, 49152
    s_nop 0
    buffer_load_dwordx4 v2, s[20:23], s46 offen offset:0 lds
    buffer_load_dwordx4 v2, s[20:23], s46 offen offset:1024 lds
    buffer_load_dwordx4 v2, s[20:23], s46 offen offset:2048 lds
    buffer_load_dwordx4 v2, s[20:23], s46 offen offset:3072 lds
    s_waitcnt vmcnt(8)
    s_barrier
    s_add_u32 s46, s51, 9
    s_and_b32 s46, s46, 15
    s_lshl_b32 s46, s46, 14
    s_add_u32 s46, s46, s45
    s_add_u32 m0, s45, 65536
    s_nop 0
    buffer_load_dwordx4 v2, s[20:23], s46 offen offset:0 lds
    buffer_load_dwordx4 v2, s[20:23], s46 offen offset:1024 lds
    buffer_load_dwordx4 v2, s[20:23], s46 offen offset:2048 lds
    buffer_load_dwordx4 v2, s[20:23], s46 offen offset:3072 lds
    s_waitcnt vmcnt(8)
    s_barrier
    s_add_u32 s46, s51, 10
    s_and_b32 s46, s46, 15
    s_lshl_b32 s46, s46, 14
    s_add_u32 s46, s46, s45
    s_add_u32 m0, s45, 0
    s_nop 0
    buffer_load_dwordx4 v2, s[20:23], s46 offen offset:0 lds
    buffer_load_dwordx4 v2, s[20:23], s46 offen offset:1024 lds
    buffer_load_dwordx4 v2, s[20:23], s46 offen offset:2048 lds
    buffer_load_dwordx4 v2, s[20:23], s46 offen offset:3072 lds
    s_waitcnt vmcnt(8)
    s_barrier
    s_add_u32 s46, s51, 11
    s_and_b32 s46, s46, 15
    s_lshl_b32 s46, s46, 14
    s_add_u32 s46, s46, s45
    s_add_u32 m0, s45, 16384
    s_nop 0
    buffer_load_dwordx4 v2, s[20:23], s46 offen offset:0 lds
    buffer_load_dwordx4 v2, s[20:23], s46 offen offset:1024 lds
    buffer_load_dwordx4 v2, s[20:23], s46 offen offset:2048 lds
    buffer_load_dwordx4 v2, s[20:23], s46 offen offset:3072 lds
    s_waitcnt vmcnt(8)
    s_barrier
    s_add_u32 s46, s51, 12
    s_and_b32 s46, s46, 15
    s_lshl_b32 s46, s46, 14
    s_add_u32 s46, s46, s45
    s_add_u32 m0, s45, 32768
    s_nop 0
    buffer_load_dwordx4 v2, s[20:23], s46 offen offset:0 lds
    buffer_load_dwordx4 v2, s[20:23], s46 offen offset:1024 lds
    buffer_load_dwordx4 v2, s[20:23], s46 offen offset:2048 lds
    buffer_load_dwordx4 v2, s[20:23], s46 offen offset:3072 lds
    s_waitcnt vmcnt(8)
    s_barrier
    s_add_u32 s46, s51, 13
    s_and_b32 s46, s46, 15
    s_lshl_b32 s46, s46, 14
    s_add_u32 s46, s46, s45
    s_add_u32 m0, s45, 49152
    s_nop 0
    buffer_load_dwordx4 v2, s[20:23], s46 offen offset:0 lds
    buffer_load_dwordx4 v2, s[20:23], s46 offen offset:1024 lds
    buffer_load_dwordx4 v2, s[20:23], s46 offen offset:2048 lds
    buffer_load_dwordx4 v2, s[20:23], s46 offen offset:3072 lds
    s_waitcnt vmcnt(8)
    s_barrier
    s_add_u32 s46, s51, 14
    s_and_b32 s46, s46, 15
    s_lshl_b32 s46, s46, 14
    s_add_u32 s46, s46, s45
    s_add_u32 m0, s45, 65536
    s_nop 0
    buffer_load_dwordx4 v2, s[20:23], s46 offen offset:0 lds
    buffer_load_dwordx4 v2, s[20:23], s46 offen offset:1024 lds
    buffer_load_dwordx4 v2, s[20:23], s46 offen offset:2048 lds
    buffer_load_dwordx4 v2, s[20:23], s46 offen offset:3072 lds
    s_waitcnt vmcnt(8)
    s_barrier
    s_add_u32 s46, s51, 15
    s_and_b32 s46, s46, 15
    s_lshl_b32 s46, s46, 14
    s_add_u32 s46, s46, s45
    s_add_u32 m0, s45, 0
    s_nop 0
    buffer_load_dwordx4 v2, s[20:23], s46 offen offset:0 lds
    buffer_load_dwordx4 v2, s[20:23], s46 offen offset:1024 lds
    buffer_load_dwordx4 v2, s[20:23], s46 offen offset:2048 lds
    buffer_load_dwordx4 v2, s[20:23], s46 offen offset:3072 lds
    s_waitcnt vmcnt(8)
    s_barrier
    s_mov_b32 s28, s74
    s_and_b32 s29, s75, 0xffff
    s_mov_b32 s30, 401408
    s_mov_b32 s31, 0x00020000
    s_lshr_b32 s42, s35, 2
    s_lshl_b32 s42, s42, 7
    s_mul_i32 s40, s37, 28672
    s_add_u32 s40, s40, s42
    s_mul_i32 s41, s37, 4096
    s_add_u32 m0, s41, 16384
    s_add_u32 s48, s40, 0
    buffer_load_dwordx4 v15, s[28:31], s48 offen lds
    s_add_u32 m0, s41, 17408
    s_add_u32 s48, s40, 7168
    buffer_load_dwordx4 v15, s[28:31], s48 offen lds
    s_add_u32 m0, s41, 18432
    s_add_u32 s48, s40, 14336
    buffer_load_dwordx4 v15, s[28:31], s48 offen lds
    s_add_u32 m0, s41, 19456
    s_add_u32 s48, s40, 21504
    buffer_load_dwordx4 v15, s[28:31], s48 offen lds
    s_waitcnt vmcnt(8)
    s_barrier
    s_mul_i32 s40, s37, 28672
    s_add_u32 s40, s40, s42
    s_mul_i32 s41, s37, 4096
    s_add_u32 m0, s41, 32768
    s_add_u32 s48, s40, 114688
    buffer_load_dwordx4 v15, s[28:31], s48 offen lds
    s_add_u32 m0, s41, 33792
    s_add_u32 s48, s40, 121856
    buffer_load_dwordx4 v15, s[28:31], s48 offen lds
    s_add_u32 m0, s41, 34816
    s_add_u32 s48, s40, 129024
    buffer_load_dwordx4 v15, s[28:31], s48 offen lds
    s_add_u32 m0, s41, 35840
    s_add_u32 s48, s40, 136192
    buffer_load_dwordx4 v15, s[28:31], s48 offen lds
    s_waitcnt vmcnt(8)
    s_barrier
    s_mul_i32 s40, s37, 28672
    s_add_u32 s40, s40, s42
    s_mul_i32 s41, s37, 4096
    s_add_u32 m0, s41, 49152
    s_add_u32 s48, s40, 229376
    buffer_load_dwordx4 v15, s[28:31], s48 offen lds
    s_add_u32 m0, s41, 50176
    s_add_u32 s48, s40, 236544
    buffer_load_dwordx4 v15, s[28:31], s48 offen lds
    s_add_u32 m0, s41, 51200
    s_add_u32 s48, s40, 243712
    buffer_load_dwordx4 v15, s[28:31], s48 offen lds
    s_add_u32 m0, s41, 52224
    s_add_u32 s48, s40, 250880
    buffer_load_dwordx4 v15, s[28:31], s48 offen lds
    s_barrier
    s_branch KF_LNOFALL
KF_SYNC:
    s_mov_b32 s56, s80
    s_and_b32 s57, s81, 0xffff
    s_mov_b32 s58, 256
    s_mov_b32 s59, 0x00020000
    v_mov_b32 v14, 0
    v_lshlrev_b32 v19, 2, v0
    v_mov_b32 v16, 0
    v_mov_b32 v24, 0
    v_mov_b32 v21, 163712
    v_add_u32 v20, 163584, v19
    ds_write_b32 v20, v14
    v_and_b32 v20, 3, v0
    v_lshlrev_b32 v20, 2, v20
    v_add_u32 v20, 163584, v20
    v_mov_b32 v23, 163584
    v_mov_b32 v24, 1
    s_waitcnt lgkmcnt(0)
    s_cmp_lg_u32 s2, 0
    s_cbranch_scc1 KF_NOTAGW
    s_memrealtime s[40:41]
    s_waitcnt lgkmcnt(0)
    s_lshl_b32 s40, s40, 4
    s_or_b32 s40, s40, 0x80000000
    v_mov_b32 v17, s40
    s_mov_b64 exec, 1
    buffer_store_dword v17, v14, s[56:59], 0 offen sc1
    s_mov_b64 exec, -1
KF_NOTAGW:
    buffer_load_dword v16, v14, s[56:59], 0 offen sc1
    s_barrier
    s_barrier
    s_barrier
    s_barrier
    s_barrier
    s_mov_b32 s49, 0
KF_TAGW:
    s_waitcnt vmcnt(0)
    v_readfirstlane_b32 s52, v16
    s_add_u32 s49, s49, 1
    s_cmp_gt_u32 s49, 131072
    s_cbranch_scc1 KF_TAGOK
    s_cmp_lg_u32 s52, 0
    s_cbranch_scc1 KF_TAGOK
    buffer_load_dword v16, v14, s[56:59], 0 offen sc1
    s_branch KF_TAGW
KF_TAGOK:
    v_mov_b32 v18, s52
    s_mul_i32 s40, s33, 3
    v_add_u32 v22, s40, v0
    v_and_b32 v17, 15, v22
    v_lshlrev_b32 v17, 8, v17
    v_lshrrev_b32 v22, 4, v22
    v_lshl_add_u32 v17, v22, 6, v17
    s_lshl_b32 s40, s32, 2
    s_add_u32 s40, s40, 16793600
    s_lshl_b32 s41, s50, 8
    s_add_u32 s41, s41, 16793600
    s_lshl_b32 s42, 1, s51
    s_lshr_b32 s43, s42, 1
    s_or_b32 s43, s43, s42
    s_or_b32 s44, s42, 0xffff0000
    s_mov_b32 s45, 0xffff
    s_lshl_b32 s46, s43, 16
    s_or_b32 s46, s46, s42
    s_mov_b32 s47, s43
    s_barrier
    s_barrier
    s_barrier
    s_barrier
    s_barrier
    s_mov_b64 exec, 7
    buffer_store_dword v18, v17, s[24:27], s40 offen sc1
    s_mov_b64 exec, -1
    s_barrier
    s_barrier
    s_mov_b32 s49, 0
KF_POLL1:
    buffer_load_dword v16, v19, s[24:27], s41 offen sc1
    s_waitcnt vmcnt(0)
    v_cmp_ne_u32 vcc, s52, v16
    s_add_u32 s49, s49, 1
    s_cmp_gt_u32 s49, 131072
    s_cbranch_scc1 KF_POLL1OK
    s_and_b64 s[42:43], vcc, s[44:45]
    s_cbranch_scc1 KF_POLL1
KF_POLL1OK:
    s_barrier
    s_barrier
    s_add_u32 s40, s40, 4096
    s_add_u32 s41, s41, 4096
    s_barrier
    s_barrier
    s_barrier
    s_barrier
    s_mov_b64 exec, 7
    buffer_store_dword v18, v17, s[24:27], s40 offen sc1
    s_mov_b64 exec, -1
    s_barrier
    s_barrier
    buffer_load_dword v16, v19, s[24:27], s41 offen sc1
    s_barrier
    s_mov_b32 s49, 0
    s_branch KF_POLLBP
KF_POLLB:
    buffer_load_dword v16, v19, s[24:27], s41 offen sc1
KF_POLLBP:
    s_waitcnt vmcnt(0)
    v_cmp_ne_u32 vcc, s52, v16
    s_add_u32 s49, s49, 1
    s_cmp_gt_u32 s49, 131072
    s_cbranch_scc1 KF_POLLBOK
    s_and_b64 s[42:43], vcc, s[46:47]
    s_cbranch_scc1 KF_POLLB
KF_POLLBOK:
    v_mov_b32 v22, 1
    ds_write_b32 v21, v22 offset:4
    s_waitcnt lgkmcnt(0)
    s_lshl_b32 s40, s51, 8
    s_lshl_b32 s41, s50, 2
    s_add_u32 s40, s40, s41
    s_add_u32 s40, s40, 16805888
    s_lshl_b32 s41, s34, 1
    s_bfe_u32 s42, s35, 0x10001
    s_add_u32 s41, s41, s42
    s_lshl_b32 s41, s41, 8
    s_add_u32 s41, s41, 16805888
    s_barrier
    s_barrier
    s_barrier
    s_barrier
    s_barrier
    s_barrier
    s_barrier
    s_barrier
    s_mov_b64 exec, 1
    buffer_store_dword v18, v14, s[24:27], s40 offen sc1
    s_mov_b64 exec, -1
    s_barrier
    s_mov_b32 s44, 0xffff
    s_mov_b32 s45, 0
KF_SR:
    s_barrier
    s_cmp_lg_u32 s53, 0
    s_cbranch_scc1 KF_SNOFALL
    v_and_b32 v16, 7, v0
    v_lshlrev_b32 v16, 2, v16
    v_add_u32 v16, 163776, v16
    ds_read_b32 v16, v16
    s_waitcnt lgkmcnt(0)
    v_cmp_ne_u32 vcc, 0, v16
    s_nop 1
    s_cbranch_vccz KF_SNOFALL
    s_mov_b32 s53, 1
    s_barrier
    s_branch KF_SRESTART
KF_SNOFALL:
    buffer_load_dword v16, v19, s[24:27], s41 offen sc1
    s_sub_u32 s40, s40, 4096
    s_waitcnt vmcnt(0)
    v_cmp_ne_u32 vcc, s52, v16
    s_mov_b32 s62, 0
    s_and_b32 s42, vcc_lo, 0xffff
    s_cbranch_scc1 KF_B2LATE
    ds_write_b32 v23, v24 offset:84
    s_mov_b32 s62, 1
KF_B2LATE:
    s_mov_b32 s63, 0
    s_branch KW9E
KW9:
    s_sleep 1
    s_add_u32 s63, s63, 1
    s_cmp_gt_u32 s63, 524288
    s_cbranch_scc1 KW9X
KW9E:
    ds_read_b32 v17, v20 offset:16
    s_waitcnt lgkmcnt(0)
    v_cmp_gt_u32 vcc, 1, v17
    s_nop 1
    s_cbranch_vccnz KW9
KW9X:
    s_mov_b64 exec, 1
    buffer_store_dword v18, v14, s[24:27], s40 offen sc1
    s_mov_b64 exec, -1
    s_cmp_ge_u32 s35, 28
    s_cbranch_scc1 KF_END
    s_cmp_eq_u32 s62, 1
    s_cbranch_scc1 KF_B2OK
    s_mov_b32 s49, 0
KF_POLLB2:
    buffer_load_dword v16, v19, s[24:27], s41 offen sc1
    s_waitcnt vmcnt(0)
    v_cmp_ne_u32 vcc, s52, v16
    s_add_u32 s49, s49, 1
    s_cmp_gt_u32 s49, 131072
    s_cbranch_scc1 KF_POLLB2OK
    s_and_b64 s[42:43], vcc, s[44:45]
    s_cbranch_scc1 KF_POLLB2
KF_POLLB2OK:
    ds_write_b32 v23, v24 offset:84
KF_B2OK:
    s_sub_u32 s41, s41, 4096
    s_mov_b32 s49, 0
KF_POLL2:
    buffer_load_dword v16, v19, s[24:27], s41 offen sc1
    s_waitcnt vmcnt(0)
    v_cmp_ne_u32 vcc, s52, v16
    s_add_u32 s49, s49, 1
    s_cmp_gt_u32 s49, 131072
    s_cbranch_scc1 KF_POLL2OK
    s_and_b64 s[42:43], vcc, s[44:45]
    s_cbranch_scc1 KF_POLL2
KF_POLL2OK:
    ds_write_b32 v23, v24 offset:80
KF_END:
    s_endpgm
KF_SRESTART:
    s_barrier
    s_barrier
    s_barrier
    s_barrier
    s_barrier
    s_barrier
    s_barrier
    s_barrier
    s_barrier
    s_barrier
    s_barrier
    s_barrier
    s_barrier
    s_barrier
    s_barrier
    s_barrier
    s_branch KF_SR
KF_TEND:
    s_endpgm
.section .rodata,"a"
.p2align 6
.amdhsa_kernel gated_mix__mha_block__sliding_local_dilated__prompt_kernel
  .amdhsa_next_free_vgpr 126
  .amdhsa_next_free_sgpr 84
  .amdhsa_accum_offset 128
  .amdhsa_group_segment_fixed_size 0
  .amdhsa_kernarg_size 80
  .amdhsa_user_sgpr_count 2
  .amdhsa_user_sgpr_kernarg_segment_ptr 1
  .amdhsa_system_sgpr_workgroup_id_x 1
.end_amdhsa_kernel
```
